```python
import torch

def _softmax(x, axis=-1):
    return torch.softmax(x, dim=axis)

def _gelu(x):
    return torch.nn.functional.gelu(x, approximate='tanh')

def _silu(x):
    return torch.nn.functional.silu(x)

def _sigmoid(x):
    return torch.sigmoid(x)

def _layernorm(x, axis=-1, eps=1e-05):
    m = x.mean(dim=axis, keepdim=True)
    v = x.var(dim=axis, keepdim=True, unbiased=False)
    return (x - m) / torch.sqrt(v + eps)

def _scatter_add(tgt, idx, src, axis=0):
    return tgt.clone().index_add_(axis, idx, src)

def _segment_sum(src, seg, n):
    out = torch.zeros((n,) + src.shape[1:], dtype=src.dtype)
    return out.index_add_(0, seg, src)

def _pad(x, pw):
    flat = tuple((v for pair in reversed(pw) for v in pair))
    return torch.nn.functional.pad(x, flat)
kernel_name = 'adaLN_cond__ssm_conv_s4d__glu_gated_geglu__prompt'

def setup_inputs():

    _w = lambda a: (lambda t: t.to(torch.bfloat16) if t.is_floating_point() else t)(torch.as_tensor(a))

    def _A_setup():
        Bsz, L, D, N = (1, 2048, 640, 128)
        return {'u': _w((lambda *s: torch.randn(*s, dtype=torch.bfloat16) * 0.05)(Bsz, L, D)), 'log_A_real': _w((lambda *s: torch.randn(*s, dtype=torch.bfloat16) * 3.2)(D, N) * 0.5), 'A_imag': _w((lambda *s: torch.randn(*s, dtype=torch.bfloat16) * 0.05)(D, N) * 3.14), 'C_real': _w((lambda *s: torch.randn(*s, dtype=torch.bfloat16) * 0.4)(D, N) / N ** 0.5), 'C_imag': _w((lambda *s: torch.randn(*s, dtype=torch.bfloat16) * 0.4)(D, N) / N ** 0.5), 'log_dt': _w((lambda *s: torch.randn(*s, dtype=torch.bfloat16) * 0.05)(D) * 0.5 - 4.0), 'D_skip': _w((lambda *s: torch.randn(*s, dtype=torch.bfloat16) * 0.05)(D))}
    _A_in = _A_setup()

    def _B_setup():
        B, S, Dm, Df = (1, 2048, 640, 1728)
        return {'x': _w((lambda *s: torch.randn(*s, dtype=torch.bfloat16) * 0.05)(B, S, Dm)), 'w_gate': _w((lambda *s: torch.randn(*s, dtype=torch.bfloat16) * 0.8)(Dm, Df) * Dm ** (-0.5)), 'w_up': _w((lambda *s: torch.randn(*s, dtype=torch.bfloat16) * 0.8)(Dm, Df) * Dm ** (-0.5)), 'w_down': _w((lambda *s: torch.randn(*s, dtype=torch.bfloat16) * 0.8)(Df, Dm) * Df ** (-0.5))}
    _B_in = _B_setup()
    return {'A_u': _A_in['u'], 'A_log_A_real': _A_in['log_A_real'], 'A_A_imag': _A_in['A_imag'], 'A_C_real': _A_in['C_real'], 'A_C_imag': _A_in['C_imag'], 'A_log_dt': _A_in['log_dt'], 'A_D_skip': _A_in['D_skip'], 'B_x': _B_in['x'], 'B_w_gate': _B_in['w_gate'], 'B_w_up': _B_in['w_up'], 'B_w_down': _B_in['w_down'], 'c': _w((lambda *s: torch.randn(*s, dtype=torch.bfloat16) * 0.2)(1, 640) * 8.0), 'w_mod': _w((lambda *s: torch.randn(*s, dtype=torch.bfloat16) * 0.2)(640, 6 * 640) * 640 ** (-0.5) * 8.0)}

def reference(A_u, A_log_A_real, A_A_imag, A_C_real, A_C_imag, A_log_dt, A_D_skip, B_x, B_w_gate, B_w_up, B_w_down, c, w_mod):

    def _A_ref(u, log_A_real, A_imag, C_real, C_imag, log_dt, D_skip):
        L = u.shape[1]
        dt = torch.exp(log_dt)
        A = -torch.exp(log_A_real) + 1j * A_imag
        C = (C_real + 1j * C_imag) * dt[:, None]
        pos = (lambda x, dt: x.to(dt))(torch.arange(L), log_dt.dtype)
        P = torch.exp((A * dt[:, None])[:, :, None] * pos[None, None, :])
        K = 2.0 * torch.einsum('dn,dnl->dl', C, P).real
        L2 = 2 * L
        u_t = (lambda x, *d: x.permute(*d))(u, 0, 2, 1)
        Kf = (lambda x, *a, **k: torch.fft.rfft(x.float(), *a, **k))(K, L2)
        Uf = (lambda x, *a, **k: torch.fft.rfft(x.float(), *a, **k))(u_t, L2)
        y = (lambda x, *a, **k: torch.fft.irfft(x, *a, **k).to(torch.bfloat16))(Uf * Kf[None, :, :], L2)[:, :, :L]
        y = (lambda x, *d: x.permute(*d))(y, 0, 2, 1)
        return y + u * D_skip[None, None, :]

    def _B_ref(x, w_gate, w_up, w_down):
        g = torch.einsum('bsd,df->bsf', x, w_gate)
        u = torch.einsum('bsd,df->bsf', x, w_up)
        h = _gelu(g) * u
        return torch.einsum('bsf,fd->bsd', h, w_down)
    x = A_u
    mod = (_silu(c) @ w_mod).reshape(c.shape[0], 6, 1, -1)
    sa, ca, ga, sb, cb, gb = (mod[:, 0].clone(), mod[:, 1].clone(), mod[:, 2].clone(), mod[:, 3].clone(), mod[:, 4].clone(), mod[:, 5].clone())
    h = _layernorm(x, axis=-1) * (1 + ca) + sa
    x = x + ga * _A_ref(h, A_log_A_real, A_A_imag, A_C_real, A_C_imag, A_log_dt, A_D_skip)
    h = _layernorm(x, axis=-1) * (1 + cb) + sb
    x = x + gb * _B_ref(h, B_w_gate, B_w_up, B_w_down)
    return x
```

```asm
; @launch grid=(256,1,1) block=(256,1,1) lds=163840
.amdgcn_target "amdgcn-amd-amdhsa--gfx950"
.text
.globl adaLN_cond__ssm_conv_s4d__glu_gated_geglu__prompt_kernel
.p2align 8
.type adaLN_cond__ssm_conv_s4d__glu_gated_geglu__prompt_kernel,@function
adaLN_cond__ssm_conv_s4d__glu_gated_geglu__prompt_kernel:
    s_cmp_ge_u32 s2, 256
    s_cbranch_scc1 L_exit
    s_nop 0
    s_load_dwordx16 s[64:79], s[0:1], 0
    s_load_dwordx16 s[80:95], s[0:1], 64
    s_getpc_b64 s[98:99]
L_pc:
    s_sub_u32 s28, s98, (L_pc-adaLN_cond__ssm_conv_s4d__glu_gated_geglu__prompt_kernel)
    s_subb_u32 s29, s99, 0
    s_mov_b32 s30, (L_codeend-adaLN_cond__ssm_conv_s4d__glu_gated_geglu__prompt_kernel)
    s_mov_b32 s31, 0x00020000
    v_lshlrev_b32 v253, 7, v0
    s_mov_b32 s98, 0
    buffer_load_dword v254, v253, s[28:31], s98 offen
    s_mov_b32 s98, 32768
    buffer_load_dword v254, v253, s[28:31], s98 offen
    v_lshrrev_b32_e64 v1, 6, v0
    s_nop 0
    v_readfirstlane_b32 s4, v1
    v_and_b32 v1, 63, v0
    s_waitcnt lgkmcnt(0)
    s_mov_b32 s8, s94
    s_mov_b32 s9, s95
    s_mov_b32 s10, 0x2000000
    s_mov_b32 s11, 0x00020000
    s_cmp_eq_u32 s2, 128
    s_cbranch_scc0 L_noinit_1
    v_mov_b32 v4, 0
    v_mov_b32 v5, 0
    v_mov_b32 v6, 0
    v_mov_b32 v7, 0
    v_lshlrev_b32 v2, 4, v0
    s_mov_b32 s96, 5373952
    buffer_store_dwordx4 v[4:7], v2, s[8:11], s96 offen sc1
    s_add_u32 s96, s96, 4096
    buffer_store_dwordx4 v[4:7], v2, s[8:11], s96 offen sc1
    s_add_u32 s96, s96, 4096
    buffer_store_dwordx4 v[4:7], v2, s[8:11], s96 offen sc1
    s_waitcnt vmcnt(0)
    s_barrier
    s_cmp_eq_u32 s4, 0
    s_cbranch_scc0 L_w0_2
    s_mov_b32 s28, s92
    s_mov_b32 s29, s93
    s_mov_b32 s30, 0x100
    s_mov_b32 s31, 0x00020000
    v_mov_b32 v4, 1
    v_mov_b32 v5, 0
    s_mov_b64 s[36:37], exec
    s_mov_b64 exec, 1
    buffer_store_dword v4, v5, s[28:31], 0 offen sc1
    s_mov_b64 exec, s[36:37]
L_w0_2:
L_noinit_1:
    s_cmp_ge_u32 s2, 160
    s_cbranch_scc1 L_prep_3
    s_and_b32 s40, s2, 7
    s_mul_i32 s40, s40, 20
    s_lshr_b32 s5, s2, 3
    s_add_u32 s40, s40, s5
    s_lshl_b32 s41, s40, 2
    s_add_u32 s41, s41, s4
    s_mul_i32 s42, s4, 21216
    s_mov_b32 s16, s74
    s_mov_b32 s17, s75
    s_mov_b32 s18, 0x500
    s_mov_b32 s19, 0x00020000
    s_lshl_b32 s5, s41, 8
    s_lshl_b32 s6, s41, 1
    v_lshlrev_b32 v8, 1, v1
    v_mov_b32 v9, 0
    buffer_load_ushort v108, v9, s[16:19], s6 offen
    s_mov_b32 s20, s66
    s_mov_b32 s21, s67
    s_mov_b32 s22, 0x28000
    s_mov_b32 s23, 0x00020000
    buffer_load_ushort v100, v8, s[20:23], s5 offen offset:0 nt
    buffer_load_ushort v104, v8, s[20:23], s5 offen offset:128 nt
    s_mov_b32 s20, s68
    s_mov_b32 s21, s69
    s_mov_b32 s22, 0x28000
    s_mov_b32 s23, 0x00020000
    buffer_load_ushort v101, v8, s[20:23], s5 offen offset:0 nt
    buffer_load_ushort v105, v8, s[20:23], s5 offen offset:128 nt
    s_mov_b32 s20, s70
    s_mov_b32 s21, s71
    s_mov_b32 s22, 0x28000
    s_mov_b32 s23, 0x00020000
    buffer_load_ushort v102, v8, s[20:23], s5 offen offset:0 nt
    buffer_load_ushort v106, v8, s[20:23], s5 offen offset:128 nt
    s_mov_b32 s20, s72
    s_mov_b32 s21, s73
    s_mov_b32 s22, 0x28000
    s_mov_b32 s23, 0x00020000
    buffer_load_ushort v103, v8, s[20:23], s5 offen offset:0 nt
    buffer_load_ushort v107, v8, s[20:23], s5 offen offset:128 nt
    s_cmp_ge_u32 s2, 128
    s_cbranch_scc1 L_modl_5
    s_mov_b32 s12, s64
    s_mov_b32 s13, s65
    s_mov_b32 s14, 0x280000
    s_mov_b32 s15, 0x00020000
    v_lshrrev_b32 v2, 4, v1
    v_and_b32 v3, 15, v1
    s_lshl_b32 s5, s2, 4
    s_lshl_b32 s6, s4, 2
    s_add_u32 s5, s5, s6
    s_mul_i32 s5, s5, 1280
    v_mul_u32_u24 v4, 1280, v2
    v_lshl_add_u32 v4, v3, 3, v4
    buffer_load_dwordx2 v[10:11], v4, s[12:15], s5 offen offset:0 nt
    buffer_load_dwordx2 v[12:13], v4, s[12:15], s5 offen offset:128 nt
    buffer_load_dwordx2 v[14:15], v4, s[12:15], s5 offen offset:256 nt
    buffer_load_dwordx2 v[16:17], v4, s[12:15], s5 offen offset:384 nt
    buffer_load_dwordx2 v[18:19], v4, s[12:15], s5 offen offset:512 nt
    buffer_load_dwordx2 v[20:21], v4, s[12:15], s5 offen offset:640 nt
    buffer_load_dwordx2 v[22:23], v4, s[12:15], s5 offen offset:768 nt
    buffer_load_dwordx2 v[24:25], v4, s[12:15], s5 offen offset:896 nt
    buffer_load_dwordx2 v[26:27], v4, s[12:15], s5 offen offset:1024 nt
    buffer_load_dwordx2 v[28:29], v4, s[12:15], s5 offen offset:1152 nt
    v_lshrrev_b32_e64 v2, 4, v1
    v_and_b32 v3, 15, v1
    s_lshl_b32 s6, s4, 2
    v_mul_u32_u24 v74, 136, v3
    v_add_u32_e64 v6, s6, v2
    v_lshl_add_u32 v74, v6, 3, v74
    v_lshrrev_b32_e64 v6, 4, v1
    v_bfe_u32 v7, v1, 2, 2
    v_and_b32 v8, 3, v1
    v_lshrrev_b32 v9, 1, v8
    v_lshl_add_u32 v9, v6, 1, v9
    s_mul_i32 s6, s4, 40
    v_add_u32 v9, s6, v9
    v_mul_u32_u24 v9, 136, v9
    v_and_b32_e64 v2, 1, v8
    v_lshl_add_u32 v2, v2, 3, v7
    v_lshl_add_u32 v75, v2, 3, v9
    v_lshrrev_b32_e64 v2, 1, v7
    v_lshl_add_u32 v2, v6, 1, v2
    v_lshlrev_b32_e64 v2, 7, v2
    v_lshl_add_u32 v2, v8, 5, v2
    v_and_b32_e64 v3, 1, v7
    v_lshl_add_u32 v76, v3, 4, v2
    s_mul_i32 s32, s2, 20480
    s_mul_i32 s6, s4, 5120
    s_add_u32 s32, s32, s6
    s_add_u32 s33, s32, 4096
    v_lshrrev_b32 v2, 3, v1
    s_mul_i32 s6, s4, 40
    v_add_u32 v2, s6, v2
    v_mul_u32_u24 v2, 136, v2
    v_and_b32_e64 v3, 7, v1
    v_lshl_add_u32 v2, v3, 4, v2
    v_add_u32 v82, 131072, v2
    s_mul_i32 s62, s2, 20480
    s_mul_i32 s6, s4, 5120
    s_add_u32 s62, s62, s6
    s_add_u32 s62, s62, 20185088
    s_lshl_b32 s6, s4, 15
    v_lshrrev_b32 v77, 2, v1
    v_and_b32 v78, 3, v1
    v_lshlrev_b32 v78, 2, v78
    v_add_u32 v78, s6, v78
    v_xor_b32_e64 v79, 0, v77
    v_lshl_add_u32 v224, v79, 4, v78
    v_xor_b32_e64 v79, 1, v77
    v_lshl_add_u32 v225, v79, 4, v78
    v_xor_b32_e64 v79, 2, v77
    v_lshl_add_u32 v226, v79, 4, v78
    v_xor_b32_e64 v79, 3, v77
    v_lshl_add_u32 v227, v79, 4, v78
    v_xor_b32_e64 v79, 4, v77
    v_lshl_add_u32 v228, v79, 4, v78
    v_xor_b32_e64 v79, 5, v77
    v_lshl_add_u32 v229, v79, 4, v78
    v_xor_b32_e64 v79, 6, v77
    v_lshl_add_u32 v230, v79, 4, v78
    v_xor_b32_e64 v79, 7, v77
    v_lshl_add_u32 v231, v79, 4, v78
    v_xor_b32_e64 v79, 8, v77
    v_lshl_add_u32 v232, v79, 4, v78
    v_xor_b32_e64 v79, 9, v77
    v_lshl_add_u32 v233, v79, 4, v78
    v_xor_b32_e64 v79, 10, v77
    v_lshl_add_u32 v234, v79, 4, v78
    v_xor_b32_e64 v79, 11, v77
    v_lshl_add_u32 v235, v79, 4, v78
    v_xor_b32_e64 v79, 12, v77
    v_lshl_add_u32 v236, v79, 4, v78
    v_xor_b32_e64 v79, 13, v77
    v_lshl_add_u32 v237, v79, 4, v78
    v_xor_b32_e64 v79, 14, v77
    v_lshl_add_u32 v238, v79, 4, v78
    v_xor_b32_e64 v79, 15, v77
    v_lshl_add_u32 v239, v79, 4, v78
    v_and_b32 v77, 15, v1
    v_lshrrev_b32 v78, 4, v1
    v_lshlrev_b32 v80, 8, v77
    v_add_u32 v80, s6, v80
    v_add_u32 v79, 0, v78
    v_xor_b32 v79, v79, v77
    v_lshl_add_u32 v240, v79, 4, v80
    v_add_u32 v79, 4, v78
    v_xor_b32 v79, v79, v77
    v_lshl_add_u32 v241, v79, 4, v80
    v_add_u32 v79, 8, v78
    v_xor_b32 v79, v79, v77
    v_lshl_add_u32 v242, v79, 4, v80
    v_add_u32 v79, 12, v78
    v_xor_b32 v79, v79, v77
    v_lshl_add_u32 v243, v79, 4, v80
    s_add_u32 s5, s42, 16640
    v_and_b32 v79, 1, v78
    v_lshrrev_b32 v80, 1, v78
    v_lshlrev_b32_e64 v244, 4, v77
    v_lshl_add_u32 v244, v79, 3, v244
    v_lshl_add_u32 v244, v80, 8, v244
    v_add_u32 v244, s5, v244
    v_lshlrev_b32 v245, 2, v77
    v_lshlrev_b32 v246, 1, v77
    v_cmp_gt_u32 vcc, 2, v78
    s_nop 1
    v_cndmask_b32 v245, v246, v245, vcc
    v_lshl_add_u32 v245, v78, 6, v245
    v_add_u32 v245, 256, v245
    v_mov_b32 v246, 32
    v_mov_b32 v81, 2
    v_cndmask_b32 v246, v246, v81, vcc
    v_add_u32 v246, v246, v245
    v_lshlrev_b32 v245, 1, v245
    v_lshlrev_b32 v246, 1, v246
    v_add_u32 v245, s5, v245
    v_add_u32 v246, s5, v246
    v_lshl_add_u32 v247, v78, 6, v77
    v_lshlrev_b32_e64 v247, 1, v247
    s_add_u32 s6, s5, 1024
    v_add_u32 v247, s6, v247
    v_lshrrev_b32 v79, 1, v1
    v_mul_u32_u24 v248, 4160, v79
    v_and_b32_e64 v79, 1, v1
    v_lshl_add_u32 v248, v79, 4, v248
    v_add_u32 v248, s42, v248
    v_lshlrev_b32 v249, 4, v1
    s_add_u32 s6, s42, 32
    v_add_u32 v249, s6, v249
    v_lshlrev_b32 v250, 4, v1
    v_lshlrev_b32 v79, 3, v1
    v_add_u32 v79, 256, v79
    v_cmp_gt_u32 vcc, 32, v1
    s_nop 1
    v_cndmask_b32 v250, v79, v250, vcc
    v_add_u32 v250, s5, v250
    v_mov_b32 v94, 0x1000100
    v_mov_b32 v80, 0x3020100
    v_cndmask_b32_e64 v94, v94, v80, vcc
    v_mov_b32 v95, 0x5040302
    v_mov_b32 v80, 0x7060504
    v_cndmask_b32_e64 v95, v95, v80, vcc
    v_mov_b32 v96, 0x1000100
    v_mov_b32 v80, 0x7060504
    v_cndmask_b32 v96, v96, v80, vcc
    v_lshlrev_b32 v251, 2, v1
    s_add_u32 s6, s5, 768
    v_add_u32 v251, s6, v251
    v_lshrrev_b32 v252, 1, v1
    v_lshlrev_b32_e64 v252, 2, v252
    s_add_u32 s6, s5, 1024
    v_add_u32 v252, s6, v252
    v_and_b32 v79, 1, v1
    v_cmp_eq_u32_e64 vcc, 0, v79
    v_mov_b32 v97, 0x3020302
    v_mov_b32 v80, 0x1000100
    v_cndmask_b32_e64 v97, v97, v80, vcc
    v_mov_b32 v98, 0x5040504
    v_mov_b32 v80, 0x3020100
    v_cndmask_b32_e64 v98, v98, v80, vcc
    v_mov_b32 v99, 0x5040504
    v_mov_b32 v80, 0x3020302
    v_cndmask_b32 v99, v99, v80, vcc
    s_waitcnt vmcnt(0)
    v_add_u32 v2, 131072, v74
    ds_write_b64 v2, v[10:11] offset:0
    ds_write_b64 v2, v[12:13] offset:2176
    ds_write_b64 v2, v[14:15] offset:4352
    ds_write_b64 v2, v[16:17] offset:6528
    ds_write_b64 v2, v[18:19] offset:8704
    ds_write_b64 v2, v[20:21] offset:10880
    ds_write_b64 v2, v[22:23] offset:13056
    ds_write_b64 v2, v[24:25] offset:15232
    ds_write_b64 v2, v[26:27] offset:17408
    ds_write_b64 v2, v[28:29] offset:19584
    v_lshlrev_b32_e64 v30, 16, v10
    v_and_b32 v31, 0xffff0000, v10
    v_lshlrev_b32_e64 v32, 16, v11
    v_and_b32 v33, 0xffff0000, v11
    v_lshlrev_b32_e64 v34, 16, v12
    v_and_b32 v35, 0xffff0000, v12
    v_lshlrev_b32_e64 v36, 16, v13
    v_and_b32 v37, 0xffff0000, v13
    v_lshlrev_b32_e64 v38, 16, v14
    v_and_b32 v39, 0xffff0000, v14
    v_lshlrev_b32_e64 v40, 16, v15
    v_and_b32 v41, 0xffff0000, v15
    v_lshlrev_b32_e64 v42, 16, v16
    v_and_b32 v43, 0xffff0000, v16
    v_lshlrev_b32_e64 v44, 16, v17
    v_and_b32 v45, 0xffff0000, v17
    v_lshlrev_b32_e64 v46, 16, v18
    v_and_b32 v47, 0xffff0000, v18
    v_lshlrev_b32_e64 v48, 16, v19
    v_and_b32 v49, 0xffff0000, v19
    v_lshlrev_b32_e64 v50, 16, v20
    v_and_b32 v51, 0xffff0000, v20
    v_lshlrev_b32_e64 v52, 16, v21
    v_and_b32 v53, 0xffff0000, v21
    v_lshlrev_b32_e64 v54, 16, v22
    v_and_b32 v55, 0xffff0000, v22
    v_lshlrev_b32_e64 v56, 16, v23
    v_and_b32 v57, 0xffff0000, v23
    v_lshlrev_b32_e64 v58, 16, v24
    v_and_b32 v59, 0xffff0000, v24
    v_lshlrev_b32_e64 v60, 16, v25
    v_and_b32 v61, 0xffff0000, v25
    v_lshlrev_b32_e64 v62, 16, v26
    v_and_b32 v63, 0xffff0000, v26
    v_lshlrev_b32_e64 v64, 16, v27
    v_and_b32 v65, 0xffff0000, v27
    v_lshlrev_b32_e64 v66, 16, v28
    v_and_b32 v67, 0xffff0000, v28
    v_lshlrev_b32_e64 v68, 16, v29
    v_and_b32 v69, 0xffff0000, v29
    v_pk_add_f32 v[70:71], v[30:31], v[32:33]
    v_pk_mul_f32 v[84:85], v[30:31], v[30:31]
    v_pk_add_f32 v[72:73], v[34:35], v[36:37]
    v_pk_mul_f32 v[86:87], v[34:35], v[34:35]
    v_pk_fma_f32 v[84:85], v[32:33], v[32:33], v[84:85]
    v_pk_fma_f32 v[86:87], v[36:37], v[36:37], v[86:87]
    v_pk_add_f32 v[70:71], v[70:71], v[38:39]
    v_pk_fma_f32 v[84:85], v[38:39], v[38:39], v[84:85]
    v_pk_add_f32 v[72:73], v[72:73], v[40:41]
    v_pk_fma_f32 v[86:87], v[40:41], v[40:41], v[86:87]
    v_pk_add_f32 v[70:71], v[70:71], v[42:43]
    v_pk_fma_f32 v[84:85], v[42:43], v[42:43], v[84:85]
    v_pk_add_f32 v[72:73], v[72:73], v[44:45]
    v_pk_fma_f32 v[86:87], v[44:45], v[44:45], v[86:87]
    v_pk_add_f32 v[70:71], v[70:71], v[46:47]
    v_pk_fma_f32 v[84:85], v[46:47], v[46:47], v[84:85]
    v_pk_add_f32 v[72:73], v[72:73], v[48:49]
    v_pk_fma_f32 v[86:87], v[48:49], v[48:49], v[86:87]
    v_pk_add_f32 v[70:71], v[70:71], v[50:51]
    v_pk_fma_f32 v[84:85], v[50:51], v[50:51], v[84:85]
    v_pk_add_f32 v[72:73], v[72:73], v[52:53]
    v_pk_fma_f32 v[86:87], v[52:53], v[52:53], v[86:87]
    v_pk_add_f32 v[70:71], v[70:71], v[54:55]
    v_pk_fma_f32 v[84:85], v[54:55], v[54:55], v[84:85]
    v_pk_add_f32 v[72:73], v[72:73], v[56:57]
    v_pk_fma_f32 v[86:87], v[56:57], v[56:57], v[86:87]
    v_pk_add_f32 v[70:71], v[70:71], v[58:59]
    v_pk_fma_f32 v[84:85], v[58:59], v[58:59], v[84:85]
    v_pk_add_f32 v[72:73], v[72:73], v[60:61]
    v_pk_fma_f32 v[86:87], v[60:61], v[60:61], v[86:87]
    v_pk_add_f32 v[70:71], v[70:71], v[62:63]
    v_pk_fma_f32 v[84:85], v[62:63], v[62:63], v[84:85]
    v_pk_add_f32 v[72:73], v[72:73], v[64:65]
    v_pk_fma_f32 v[86:87], v[64:65], v[64:65], v[86:87]
    v_pk_add_f32 v[70:71], v[70:71], v[66:67]
    v_pk_fma_f32 v[84:85], v[66:67], v[66:67], v[84:85]
    v_pk_add_f32 v[72:73], v[72:73], v[68:69]
    v_pk_fma_f32 v[86:87], v[68:69], v[68:69], v[86:87]
    v_pk_add_f32 v[70:71], v[70:71], v[72:73]
    v_pk_add_f32 v[84:85], v[84:85], v[86:87]
    v_add_f32 v70, v70, v71
    v_add_f32 v84, v84, v85
    s_nop 0
    v_add_f32_dpp v70, v70, v70 row_ror:8 row_mask:0xf bank_mask:0xf
    v_add_f32_dpp v84, v84, v84 row_ror:8 row_mask:0xf bank_mask:0xf
    s_nop 0
    v_add_f32_dpp v70, v70, v70 row_ror:4 row_mask:0xf bank_mask:0xf
    v_add_f32_dpp v84, v84, v84 row_ror:4 row_mask:0xf bank_mask:0xf
    s_nop 0
    v_add_f32_dpp v70, v70, v70 row_ror:2 row_mask:0xf bank_mask:0xf
    v_add_f32_dpp v84, v84, v84 row_ror:2 row_mask:0xf bank_mask:0xf
    s_nop 0
    v_add_f32_dpp v70, v70, v70 row_ror:1 row_mask:0xf bank_mask:0xf
    v_add_f32_dpp v84, v84, v84 row_ror:1 row_mask:0xf bank_mask:0xf
    v_mul_f32 v70, 0xbacccccd, v70
    v_mul_f32 v84, 0x3acccccd, v84
    v_fma_f32 v84, -v70, v70, v84
    v_max_f32_e64 v84, 0, v84
    v_add_f32 v84, 0x3727c5ac, v84
    v_rsq_f32 v72, v84
    s_nop 0
    v_mul_f32_e64 v73, v70, v72
    v_pk_fma_f32 v[30:31], v[30:31], v[72:73], v[72:73] op_sel:[0,0,1] op_sel_hi:[1,0,1]
    v_pk_fma_f32 v[32:33], v[32:33], v[72:73], v[72:73] op_sel:[0,0,1] op_sel_hi:[1,0,1]
    v_pk_fma_f32 v[34:35], v[34:35], v[72:73], v[72:73] op_sel:[0,0,1] op_sel_hi:[1,0,1]
    v_pk_fma_f32 v[36:37], v[36:37], v[72:73], v[72:73] op_sel:[0,0,1] op_sel_hi:[1,0,1]
    v_pk_fma_f32 v[38:39], v[38:39], v[72:73], v[72:73] op_sel:[0,0,1] op_sel_hi:[1,0,1]
    v_pk_fma_f32 v[40:41], v[40:41], v[72:73], v[72:73] op_sel:[0,0,1] op_sel_hi:[1,0,1]
    v_pk_fma_f32 v[42:43], v[42:43], v[72:73], v[72:73] op_sel:[0,0,1] op_sel_hi:[1,0,1]
    v_pk_fma_f32 v[44:45], v[44:45], v[72:73], v[72:73] op_sel:[0,0,1] op_sel_hi:[1,0,1]
    v_pk_fma_f32 v[46:47], v[46:47], v[72:73], v[72:73] op_sel:[0,0,1] op_sel_hi:[1,0,1]
    v_pk_fma_f32 v[48:49], v[48:49], v[72:73], v[72:73] op_sel:[0,0,1] op_sel_hi:[1,0,1]
    v_pk_fma_f32 v[50:51], v[50:51], v[72:73], v[72:73] op_sel:[0,0,1] op_sel_hi:[1,0,1]
    v_pk_fma_f32 v[52:53], v[52:53], v[72:73], v[72:73] op_sel:[0,0,1] op_sel_hi:[1,0,1]
    v_pk_fma_f32 v[54:55], v[54:55], v[72:73], v[72:73] op_sel:[0,0,1] op_sel_hi:[1,0,1]
    v_pk_fma_f32 v[56:57], v[56:57], v[72:73], v[72:73] op_sel:[0,0,1] op_sel_hi:[1,0,1]
    v_pk_fma_f32 v[58:59], v[58:59], v[72:73], v[72:73] op_sel:[0,0,1] op_sel_hi:[1,0,1]
    v_pk_fma_f32 v[60:61], v[60:61], v[72:73], v[72:73] op_sel:[0,0,1] op_sel_hi:[1,0,1]
    v_pk_fma_f32 v[62:63], v[62:63], v[72:73], v[72:73] op_sel:[0,0,1] op_sel_hi:[1,0,1]
    v_pk_fma_f32 v[64:65], v[64:65], v[72:73], v[72:73] op_sel:[0,0,1] op_sel_hi:[1,0,1]
    v_pk_fma_f32 v[66:67], v[66:67], v[72:73], v[72:73] op_sel:[0,0,1] op_sel_hi:[1,0,1]
    v_pk_fma_f32 v[68:69], v[68:69], v[72:73], v[72:73] op_sel:[0,0,1] op_sel_hi:[1,0,1]
    v_cvt_pk_bf16_f32 v10, v30, v31
    v_cvt_pk_bf16_f32 v11, v32, v33
    v_cvt_pk_bf16_f32 v12, v34, v35
    v_cvt_pk_bf16_f32 v13, v36, v37
    v_cvt_pk_bf16_f32 v14, v38, v39
    v_cvt_pk_bf16_f32 v15, v40, v41
    v_cvt_pk_bf16_f32 v16, v42, v43
    v_cvt_pk_bf16_f32 v17, v44, v45
    v_cvt_pk_bf16_f32 v18, v46, v47
    v_cvt_pk_bf16_f32 v19, v48, v49
    v_cvt_pk_bf16_f32 v20, v50, v51
    v_cvt_pk_bf16_f32 v21, v52, v53
    v_cvt_pk_bf16_f32 v22, v54, v55
    v_cvt_pk_bf16_f32 v23, v56, v57
    v_cvt_pk_bf16_f32 v24, v58, v59
    v_cvt_pk_bf16_f32 v25, v60, v61
    v_cvt_pk_bf16_f32 v26, v62, v63
    v_cvt_pk_bf16_f32 v27, v64, v65
    v_cvt_pk_bf16_f32 v28, v66, v67
    v_cvt_pk_bf16_f32 v29, v68, v69
    ds_write_b64 v74, v[10:11] offset:0
    ds_write_b64 v74, v[12:13] offset:2176
    ds_write_b64 v74, v[14:15] offset:4352
    ds_write_b64 v74, v[16:17] offset:6528
    ds_write_b64 v74, v[18:19] offset:8704
    ds_write_b64 v74, v[20:21] offset:10880
    ds_write_b64 v74, v[22:23] offset:13056
    ds_write_b64 v74, v[24:25] offset:15232
    ds_write_b64 v74, v[26:27] offset:17408
    ds_write_b64 v74, v[28:29] offset:19584
    s_waitcnt lgkmcnt(0)
    s_barrier
    ds_read_b64_tr_b16 v[10:11], v75 offset:0
    ds_read_b64_tr_b16 v[12:13], v75 offset:32
    ds_read_b64_tr_b16 v[14:15], v75 offset:1088
    ds_read_b64_tr_b16 v[16:17], v75 offset:1120
    ds_read_b64_tr_b16 v[18:19], v75 offset:2176
    ds_read_b64_tr_b16 v[20:21], v75 offset:2208
    ds_read_b64_tr_b16 v[22:23], v75 offset:3264
    ds_read_b64_tr_b16 v[24:25], v75 offset:3296
    ds_read_b64_tr_b16 v[26:27], v75 offset:4352
    ds_read_b64_tr_b16 v[28:29], v75 offset:4384
    s_waitcnt lgkmcnt(8)
    s_nop 0
    buffer_store_dwordx4 v[10:13], v76, s[8:11], s32 offen offset:0 sc1
    s_waitcnt lgkmcnt(6)
    buffer_store_dwordx4 v[14:17], v76, s[8:11], s32 offen offset:1024 sc1
    s_waitcnt lgkmcnt(4)
    buffer_store_dwordx4 v[18:21], v76, s[8:11], s32 offen offset:2048 sc1
    s_waitcnt lgkmcnt(2)
    buffer_store_dwordx4 v[22:25], v76, s[8:11], s32 offen offset:3072 sc1
    s_waitcnt lgkmcnt(0)
    buffer_store_dwordx4 v[26:29], v76, s[8:11], s33 offen sc1
    s_barrier
    s_and_b32 s35, s2, 7
    s_branch L_a1done_6
L_modl_5:
    s_and_b32 s35, s2, 7
    s_add_u32 s35, s35, 8
    s_cmp_lt_u32 s2, 136
    s_cbranch_scc1 L_nomod_7
    s_mov_b32 s12, s88
    s_mov_b32 s13, s89
    s_mov_b32 s14, 0x4b0000
    s_mov_b32 s15, 0x00020000
    s_mov_b32 s16, s86
    s_mov_b32 s17, s87
    s_mov_b32 s18, 0x500
    s_mov_b32 s19, 0x00020000
    s_sub_u32 s32, s2, 136
    s_lshr_b32 s33, s32, 1
    s_and_b32 s32, s32, 1
    s_mul_i32 s34, s32, 320
    s_mul_i32 s5, s4, 80
    s_add_u32 s34, s34, s5
    s_lshl_b32 s6, s34, 1
    s_mul_i32 s5, s34, 7680
    s_lshl_b32 s7, s33, 7
    s_add_u32 s5, s5, s7
    v_lshrrev_b32 v2, 3, v1
    v_and_b32 v3, 7, v1
    v_mul_u32_u24 v4, 7680, v2
    v_lshl_add_u32 v4, v3, 4, v4
    v_lshlrev_b32_e64 v5, 1, v2
    buffer_load_ushort v10, v5, s[16:19], s6 offen offset:0
    buffer_load_ushort v11, v5, s[16:19], s6 offen offset:16
    buffer_load_ushort v12, v5, s[16:19], s6 offen offset:32
    buffer_load_ushort v13, v5, s[16:19], s6 offen offset:48
    buffer_load_ushort v14, v5, s[16:19], s6 offen offset:64
    buffer_load_ushort v15, v5, s[16:19], s6 offen offset:80
    buffer_load_ushort v16, v5, s[16:19], s6 offen offset:96
    buffer_load_ushort v17, v5, s[16:19], s6 offen offset:112
    buffer_load_ushort v18, v5, s[16:19], s6 offen offset:128
    buffer_load_ushort v19, v5, s[16:19], s6 offen offset:144
    buffer_load_dwordx4 v[20:23], v4, s[12:15], s5 offen nt
    s_add_u32 s5, s5, 61440
    buffer_load_dwordx4 v[24:27], v4, s[12:15], s5 offen nt
    s_add_u32 s5, s5, 61440
    buffer_load_dwordx4 v[28:31], v4, s[12:15], s5 offen nt
    s_add_u32 s5, s5, 61440
    buffer_load_dwordx4 v[32:35], v4, s[12:15], s5 offen nt
    s_add_u32 s5, s5, 61440
    buffer_load_dwordx4 v[36:39], v4, s[12:15], s5 offen nt
    s_add_u32 s5, s5, 61440
    buffer_load_dwordx4 v[40:43], v4, s[12:15], s5 offen nt
    s_add_u32 s5, s5, 61440
    buffer_load_dwordx4 v[44:47], v4, s[12:15], s5 offen nt
    s_add_u32 s5, s5, 61440
    buffer_load_dwordx4 v[48:51], v4, s[12:15], s5 offen nt
    s_add_u32 s5, s5, 61440
    buffer_load_dwordx4 v[52:55], v4, s[12:15], s5 offen nt
    s_add_u32 s5, s5, 61440
    buffer_load_dwordx4 v[56:59], v4, s[12:15], s5 offen nt
    s_lshl_b32 s6, s4, 15
    v_lshrrev_b32 v77, 2, v1
    v_and_b32 v78, 3, v1
    v_lshlrev_b32 v78, 2, v78
    v_add_u32 v78, s6, v78
    v_xor_b32 v79, 0, v77
    v_lshl_add_u32 v224, v79, 4, v78
    v_xor_b32_e64 v79, 1, v77
    v_lshl_add_u32 v225, v79, 4, v78
    v_xor_b32_e64 v79, 2, v77
    v_lshl_add_u32 v226, v79, 4, v78
    v_xor_b32_e64 v79, 3, v77
    v_lshl_add_u32 v227, v79, 4, v78
    v_xor_b32_e64 v79, 4, v77
    v_lshl_add_u32 v228, v79, 4, v78
    v_xor_b32_e64 v79, 5, v77
    v_lshl_add_u32 v229, v79, 4, v78
    v_xor_b32_e64 v79, 6, v77
    v_lshl_add_u32 v230, v79, 4, v78
    v_xor_b32_e64 v79, 7, v77
    v_lshl_add_u32 v231, v79, 4, v78
    v_xor_b32_e64 v79, 8, v77
    v_lshl_add_u32 v232, v79, 4, v78
    v_xor_b32_e64 v79, 9, v77
    v_lshl_add_u32 v233, v79, 4, v78
    v_xor_b32_e64 v79, 10, v77
    v_lshl_add_u32 v234, v79, 4, v78
    v_xor_b32_e64 v79, 11, v77
    v_lshl_add_u32 v235, v79, 4, v78
    v_xor_b32_e64 v79, 12, v77
    v_lshl_add_u32 v236, v79, 4, v78
    v_xor_b32_e64 v79, 13, v77
    v_lshl_add_u32 v237, v79, 4, v78
    v_xor_b32_e64 v79, 14, v77
    v_lshl_add_u32 v238, v79, 4, v78
    v_xor_b32_e64 v79, 15, v77
    v_lshl_add_u32 v239, v79, 4, v78
    v_and_b32 v77, 15, v1
    v_lshrrev_b32 v78, 4, v1
    v_lshlrev_b32 v80, 8, v77
    v_add_u32 v80, s6, v80
    v_add_u32 v79, 0, v78
    v_xor_b32 v79, v79, v77
    v_lshl_add_u32 v240, v79, 4, v80
    v_add_u32 v79, 4, v78
    v_xor_b32 v79, v79, v77
    v_lshl_add_u32 v241, v79, 4, v80
    v_add_u32 v79, 8, v78
    v_xor_b32 v79, v79, v77
    v_lshl_add_u32 v242, v79, 4, v80
    v_add_u32 v79, 12, v78
    v_xor_b32 v79, v79, v77
    v_lshl_add_u32 v243, v79, 4, v80
    s_add_u32 s5, s42, 16640
    v_and_b32 v79, 1, v78
    v_lshrrev_b32 v80, 1, v78
    v_lshlrev_b32_e64 v244, 4, v77
    v_lshl_add_u32 v244, v79, 3, v244
    v_lshl_add_u32 v244, v80, 8, v244
    v_add_u32 v244, s5, v244
    v_lshlrev_b32 v245, 2, v77
    v_lshlrev_b32 v246, 1, v77
    v_cmp_gt_u32 vcc, 2, v78
    s_nop 1
    v_cndmask_b32 v245, v246, v245, vcc
    v_lshl_add_u32 v245, v78, 6, v245
    v_add_u32 v245, 256, v245
    v_mov_b32 v246, 32
    v_mov_b32 v81, 2
    v_cndmask_b32 v246, v246, v81, vcc
    v_add_u32 v246, v246, v245
    v_lshlrev_b32 v245, 1, v245
    v_lshlrev_b32 v246, 1, v246
    v_add_u32 v245, s5, v245
    v_add_u32 v246, s5, v246
    v_lshl_add_u32 v247, v78, 6, v77
    v_lshlrev_b32_e64 v247, 1, v247
    s_add_u32 s6, s5, 1024
    v_add_u32 v247, s6, v247
    v_lshrrev_b32 v79, 1, v1
    v_mul_u32_u24 v248, 4160, v79
    v_and_b32_e64 v79, 1, v1
    v_lshl_add_u32 v248, v79, 4, v248
    v_add_u32 v248, s42, v248
    v_lshlrev_b32 v249, 4, v1
    s_add_u32 s6, s42, 32
    v_add_u32 v249, s6, v249
    v_lshlrev_b32 v250, 4, v1
    v_lshlrev_b32 v79, 3, v1
    v_add_u32 v79, 256, v79
    v_cmp_gt_u32 vcc, 32, v1
    s_nop 1
    v_cndmask_b32 v250, v79, v250, vcc
    v_add_u32 v250, s5, v250
    v_mov_b32 v94, 0x1000100
    v_mov_b32 v80, 0x3020100
    v_cndmask_b32_e64 v94, v94, v80, vcc
    v_mov_b32 v95, 0x5040302
    v_mov_b32 v80, 0x7060504
    v_cndmask_b32_e64 v95, v95, v80, vcc
    v_mov_b32 v96, 0x1000100
    v_mov_b32 v80, 0x7060504
    v_cndmask_b32 v96, v96, v80, vcc
    v_lshlrev_b32 v251, 2, v1
    s_add_u32 s6, s5, 768
    v_add_u32 v251, s6, v251
    v_lshrrev_b32 v252, 1, v1
    v_lshlrev_b32_e64 v252, 2, v252
    s_add_u32 s6, s5, 1024
    v_add_u32 v252, s6, v252
    v_and_b32 v79, 1, v1
    v_cmp_eq_u32_e64 vcc, 0, v79
    v_mov_b32 v97, 0x3020302
    v_mov_b32 v80, 0x1000100
    v_cndmask_b32_e64 v97, v97, v80, vcc
    v_mov_b32 v98, 0x5040504
    v_mov_b32 v80, 0x3020100
    v_cndmask_b32_e64 v98, v98, v80, vcc
    v_mov_b32 v99, 0x5040504
    v_mov_b32 v80, 0x3020302
    v_cndmask_b32 v99, v99, v80, vcc
    s_waitcnt vmcnt(10)
    v_lshlrev_b32_e64 v10, 16, v10
    v_mul_f32 v70, 0xbfb8aa3b, v10
    v_exp_f32 v70, v70
    s_nop 0
    v_add_f32 v70, 1.0, v70
    v_rcp_f32 v70, v70
    s_nop 0
    v_mul_f32 v10, v10, v70
    v_cvt_pk_bf16_f32 v10, v10, v10
    v_lshlrev_b32 v10, 16, v10
    v_lshlrev_b32 v11, 16, v11
    v_mul_f32 v70, 0xbfb8aa3b, v11
    v_exp_f32 v70, v70
    s_nop 0
    v_add_f32 v70, 1.0, v70
    v_rcp_f32 v70, v70
    s_nop 0
    v_mul_f32 v11, v11, v70
    v_cvt_pk_bf16_f32 v11, v11, v11
    v_lshlrev_b32 v11, 16, v11
    v_lshlrev_b32 v12, 16, v12
    v_mul_f32 v70, 0xbfb8aa3b, v12
    v_exp_f32 v70, v70
    s_nop 0
    v_add_f32 v70, 1.0, v70
    v_rcp_f32 v70, v70
    s_nop 0
    v_mul_f32 v12, v12, v70
    v_cvt_pk_bf16_f32 v12, v12, v12
    v_lshlrev_b32 v12, 16, v12
    v_lshlrev_b32 v13, 16, v13
    v_mul_f32 v70, 0xbfb8aa3b, v13
    v_exp_f32 v70, v70
    s_nop 0
    v_add_f32 v70, 1.0, v70
    v_rcp_f32 v70, v70
    s_nop 0
    v_mul_f32 v13, v13, v70
    v_cvt_pk_bf16_f32 v13, v13, v13
    v_lshlrev_b32 v13, 16, v13
    v_lshlrev_b32 v14, 16, v14
    v_mul_f32 v70, 0xbfb8aa3b, v14
    v_exp_f32 v70, v70
    s_nop 0
    v_add_f32 v70, 1.0, v70
    v_rcp_f32 v70, v70
    s_nop 0
    v_mul_f32 v14, v14, v70
    v_cvt_pk_bf16_f32 v14, v14, v14
    v_lshlrev_b32 v14, 16, v14
    v_lshlrev_b32 v15, 16, v15
    v_mul_f32 v70, 0xbfb8aa3b, v15
    v_exp_f32 v70, v70
    s_nop 0
    v_add_f32 v70, 1.0, v70
    v_rcp_f32 v70, v70
    s_nop 0
    v_mul_f32 v15, v15, v70
    v_cvt_pk_bf16_f32 v15, v15, v15
    v_lshlrev_b32 v15, 16, v15
    v_lshlrev_b32 v16, 16, v16
    v_mul_f32 v70, 0xbfb8aa3b, v16
    v_exp_f32 v70, v70
    s_nop 0
    v_add_f32 v70, 1.0, v70
    v_rcp_f32 v70, v70
    s_nop 0
    v_mul_f32 v16, v16, v70
    v_cvt_pk_bf16_f32 v16, v16, v16
    v_lshlrev_b32 v16, 16, v16
    v_lshlrev_b32 v17, 16, v17
    v_mul_f32 v70, 0xbfb8aa3b, v17
    v_exp_f32 v70, v70
    s_nop 0
    v_add_f32 v70, 1.0, v70
    v_rcp_f32 v70, v70
    s_nop 0
    v_mul_f32 v17, v17, v70
    v_cvt_pk_bf16_f32 v17, v17, v17
    v_lshlrev_b32 v17, 16, v17
    v_lshlrev_b32 v18, 16, v18
    v_mul_f32 v70, 0xbfb8aa3b, v18
    v_exp_f32 v70, v70
    s_nop 0
    v_add_f32 v70, 1.0, v70
    v_rcp_f32 v70, v70
    s_nop 0
    v_mul_f32 v18, v18, v70
    v_cvt_pk_bf16_f32 v18, v18, v18
    v_lshlrev_b32 v18, 16, v18
    v_lshlrev_b32 v19, 16, v19
    v_mul_f32 v70, 0xbfb8aa3b, v19
    v_exp_f32 v70, v70
    s_nop 0
    v_add_f32 v70, 1.0, v70
    v_rcp_f32 v70, v70
    s_nop 0
    v_mul_f32 v19, v19, v70
    v_cvt_pk_bf16_f32 v19, v19, v19
    v_lshlrev_b32 v19, 16, v19
    s_waitcnt vmcnt(9)
    v_lshlrev_b32_e64 v70, 16, v20
    v_and_b32 v71, 0xffff0000, v20
    v_pk_mul_f32 v[60:61], v[70:71], v[10:11] op_sel_hi:[1,0]
    v_lshlrev_b32_e64 v70, 16, v21
    v_and_b32 v71, 0xffff0000, v21
    v_pk_mul_f32 v[62:63], v[70:71], v[10:11] op_sel_hi:[1,0]
    v_lshlrev_b32_e64 v70, 16, v22
    v_and_b32 v71, 0xffff0000, v22
    v_pk_mul_f32 v[64:65], v[70:71], v[10:11] op_sel_hi:[1,0]
    v_lshlrev_b32_e64 v70, 16, v23
    v_and_b32 v71, 0xffff0000, v23
    v_pk_mul_f32 v[66:67], v[70:71], v[10:11] op_sel_hi:[1,0]
    s_waitcnt vmcnt(8)
    v_lshlrev_b32 v70, 16, v24
    v_and_b32 v71, 0xffff0000, v24
    v_pk_fma_f32 v[60:61], v[70:71], v[10:11], v[60:61] op_sel:[0,1,0] op_sel_hi:[1,1,1]
    v_lshlrev_b32_e64 v70, 16, v25
    v_and_b32 v71, 0xffff0000, v25
    v_pk_fma_f32 v[62:63], v[70:71], v[10:11], v[62:63] op_sel:[0,1,0] op_sel_hi:[1,1,1]
    v_lshlrev_b32_e64 v70, 16, v26
    v_and_b32 v71, 0xffff0000, v26
    v_pk_fma_f32 v[64:65], v[70:71], v[10:11], v[64:65] op_sel:[0,1,0] op_sel_hi:[1,1,1]
    v_lshlrev_b32_e64 v70, 16, v27
    v_and_b32 v71, 0xffff0000, v27
    v_pk_fma_f32 v[66:67], v[70:71], v[10:11], v[66:67] op_sel:[0,1,0] op_sel_hi:[1,1,1]
    s_waitcnt vmcnt(7)
    v_lshlrev_b32 v70, 16, v28
    v_and_b32 v71, 0xffff0000, v28
    v_pk_fma_f32 v[60:61], v[70:71], v[12:13], v[60:61] op_sel_hi:[1,0,1]
    v_lshlrev_b32_e64 v70, 16, v29
    v_and_b32 v71, 0xffff0000, v29
    v_pk_fma_f32 v[62:63], v[70:71], v[12:13], v[62:63] op_sel_hi:[1,0,1]
    v_lshlrev_b32_e64 v70, 16, v30
    v_and_b32 v71, 0xffff0000, v30
    v_pk_fma_f32 v[64:65], v[70:71], v[12:13], v[64:65] op_sel_hi:[1,0,1]
    v_lshlrev_b32_e64 v70, 16, v31
    v_and_b32 v71, 0xffff0000, v31
    v_pk_fma_f32 v[66:67], v[70:71], v[12:13], v[66:67] op_sel_hi:[1,0,1]
    s_waitcnt vmcnt(6)
    v_lshlrev_b32 v70, 16, v32
    v_and_b32 v71, 0xffff0000, v32
    v_pk_fma_f32 v[60:61], v[70:71], v[12:13], v[60:61] op_sel:[0,1,0] op_sel_hi:[1,1,1]
    v_lshlrev_b32_e64 v70, 16, v33
    v_and_b32 v71, 0xffff0000, v33
    v_pk_fma_f32 v[62:63], v[70:71], v[12:13], v[62:63] op_sel:[0,1,0] op_sel_hi:[1,1,1]
    v_lshlrev_b32_e64 v70, 16, v34
    v_and_b32 v71, 0xffff0000, v34
    v_pk_fma_f32 v[64:65], v[70:71], v[12:13], v[64:65] op_sel:[0,1,0] op_sel_hi:[1,1,1]
    v_lshlrev_b32_e64 v70, 16, v35
    v_and_b32 v71, 0xffff0000, v35
    v_pk_fma_f32 v[66:67], v[70:71], v[12:13], v[66:67] op_sel:[0,1,0] op_sel_hi:[1,1,1]
    s_waitcnt vmcnt(5)
    v_lshlrev_b32 v70, 16, v36
    v_and_b32 v71, 0xffff0000, v36
    v_pk_fma_f32 v[60:61], v[70:71], v[14:15], v[60:61] op_sel_hi:[1,0,1]
    v_lshlrev_b32_e64 v70, 16, v37
    v_and_b32 v71, 0xffff0000, v37
    v_pk_fma_f32 v[62:63], v[70:71], v[14:15], v[62:63] op_sel_hi:[1,0,1]
    v_lshlrev_b32_e64 v70, 16, v38
    v_and_b32 v71, 0xffff0000, v38
    v_pk_fma_f32 v[64:65], v[70:71], v[14:15], v[64:65] op_sel_hi:[1,0,1]
    v_lshlrev_b32_e64 v70, 16, v39
    v_and_b32 v71, 0xffff0000, v39
    v_pk_fma_f32 v[66:67], v[70:71], v[14:15], v[66:67] op_sel_hi:[1,0,1]
    s_waitcnt vmcnt(4)
    v_lshlrev_b32 v70, 16, v40
    v_and_b32 v71, 0xffff0000, v40
    v_pk_fma_f32 v[60:61], v[70:71], v[14:15], v[60:61] op_sel:[0,1,0] op_sel_hi:[1,1,1]
    v_lshlrev_b32_e64 v70, 16, v41
    v_and_b32 v71, 0xffff0000, v41
    v_pk_fma_f32 v[62:63], v[70:71], v[14:15], v[62:63] op_sel:[0,1,0] op_sel_hi:[1,1,1]
    v_lshlrev_b32_e64 v70, 16, v42
    v_and_b32 v71, 0xffff0000, v42
    v_pk_fma_f32 v[64:65], v[70:71], v[14:15], v[64:65] op_sel:[0,1,0] op_sel_hi:[1,1,1]
    v_lshlrev_b32_e64 v70, 16, v43
    v_and_b32 v71, 0xffff0000, v43
    v_pk_fma_f32 v[66:67], v[70:71], v[14:15], v[66:67] op_sel:[0,1,0] op_sel_hi:[1,1,1]
    s_waitcnt vmcnt(3)
    v_lshlrev_b32 v70, 16, v44
    v_and_b32 v71, 0xffff0000, v44
    v_pk_fma_f32 v[60:61], v[70:71], v[16:17], v[60:61] op_sel_hi:[1,0,1]
    v_lshlrev_b32_e64 v70, 16, v45
    v_and_b32 v71, 0xffff0000, v45
    v_pk_fma_f32 v[62:63], v[70:71], v[16:17], v[62:63] op_sel_hi:[1,0,1]
    v_lshlrev_b32_e64 v70, 16, v46
    v_and_b32 v71, 0xffff0000, v46
    v_pk_fma_f32 v[64:65], v[70:71], v[16:17], v[64:65] op_sel_hi:[1,0,1]
    v_lshlrev_b32_e64 v70, 16, v47
    v_and_b32 v71, 0xffff0000, v47
    v_pk_fma_f32 v[66:67], v[70:71], v[16:17], v[66:67] op_sel_hi:[1,0,1]
    s_waitcnt vmcnt(2)
    v_lshlrev_b32 v70, 16, v48
    v_and_b32 v71, 0xffff0000, v48
    v_pk_fma_f32 v[60:61], v[70:71], v[16:17], v[60:61] op_sel:[0,1,0] op_sel_hi:[1,1,1]
    v_lshlrev_b32_e64 v70, 16, v49
    v_and_b32 v71, 0xffff0000, v49
    v_pk_fma_f32 v[62:63], v[70:71], v[16:17], v[62:63] op_sel:[0,1,0] op_sel_hi:[1,1,1]
    v_lshlrev_b32_e64 v70, 16, v50
    v_and_b32 v71, 0xffff0000, v50
    v_pk_fma_f32 v[64:65], v[70:71], v[16:17], v[64:65] op_sel:[0,1,0] op_sel_hi:[1,1,1]
    v_lshlrev_b32_e64 v70, 16, v51
    v_and_b32 v71, 0xffff0000, v51
    v_pk_fma_f32 v[66:67], v[70:71], v[16:17], v[66:67] op_sel:[0,1,0] op_sel_hi:[1,1,1]
    s_waitcnt vmcnt(1)
    v_lshlrev_b32 v70, 16, v52
    v_and_b32 v71, 0xffff0000, v52
    v_pk_fma_f32 v[60:61], v[70:71], v[18:19], v[60:61] op_sel_hi:[1,0,1]
    v_lshlrev_b32_e64 v70, 16, v53
    v_and_b32 v71, 0xffff0000, v53
    v_pk_fma_f32 v[62:63], v[70:71], v[18:19], v[62:63] op_sel_hi:[1,0,1]
    v_lshlrev_b32_e64 v70, 16, v54
    v_and_b32 v71, 0xffff0000, v54
    v_pk_fma_f32 v[64:65], v[70:71], v[18:19], v[64:65] op_sel_hi:[1,0,1]
    v_lshlrev_b32_e64 v70, 16, v55
    v_and_b32 v71, 0xffff0000, v55
    v_pk_fma_f32 v[66:67], v[70:71], v[18:19], v[66:67] op_sel_hi:[1,0,1]
    s_waitcnt vmcnt(0)
    v_lshlrev_b32 v70, 16, v56
    v_and_b32 v71, 0xffff0000, v56
    v_pk_fma_f32 v[60:61], v[70:71], v[18:19], v[60:61] op_sel:[0,1,0] op_sel_hi:[1,1,1]
    v_lshlrev_b32_e64 v70, 16, v57
    v_and_b32 v71, 0xffff0000, v57
    v_pk_fma_f32 v[62:63], v[70:71], v[18:19], v[62:63] op_sel:[0,1,0] op_sel_hi:[1,1,1]
    v_lshlrev_b32_e64 v70, 16, v58
    v_and_b32 v71, 0xffff0000, v58
    v_pk_fma_f32 v[64:65], v[70:71], v[18:19], v[64:65] op_sel:[0,1,0] op_sel_hi:[1,1,1]
    v_lshlrev_b32_e64 v70, 16, v59
    v_and_b32 v71, 0xffff0000, v59
    v_pk_fma_f32 v[66:67], v[70:71], v[18:19], v[66:67] op_sel:[0,1,0] op_sel_hi:[1,1,1]
    v_add_f32_dpp v60, v60, v60 row_ror:8 row_mask:0xf bank_mask:0xf
    v_add_f32_dpp v61, v61, v61 row_ror:8 row_mask:0xf bank_mask:0xf
    v_add_f32_dpp v62, v62, v62 row_ror:8 row_mask:0xf bank_mask:0xf
    v_add_f32_dpp v63, v63, v63 row_ror:8 row_mask:0xf bank_mask:0xf
    v_add_f32_dpp v64, v64, v64 row_ror:8 row_mask:0xf bank_mask:0xf
    v_add_f32_dpp v65, v65, v65 row_ror:8 row_mask:0xf bank_mask:0xf
    v_add_f32_dpp v66, v66, v66 row_ror:8 row_mask:0xf bank_mask:0xf
    v_add_f32_dpp v67, v67, v67 row_ror:8 row_mask:0xf bank_mask:0xf
    v_mov_b32 v70, v60
    s_nop 1
    v_permlane16_swap_b32 v70, v60
    v_add_f32 v60, v60, v70
    v_mov_b32 v70, v60
    s_nop 1
    v_permlane32_swap_b32 v70, v60
    v_add_f32 v60, v60, v70
    v_mov_b32 v71, v61
    s_nop 1
    v_permlane16_swap_b32 v71, v61
    v_add_f32 v61, v61, v71
    v_mov_b32 v71, v61
    s_nop 1
    v_permlane32_swap_b32 v71, v61
    v_add_f32 v61, v61, v71
    v_mov_b32 v70, v62
    s_nop 1
    v_permlane16_swap_b32 v70, v62
    v_add_f32 v62, v62, v70
    v_mov_b32 v70, v62
    s_nop 1
    v_permlane32_swap_b32 v70, v62
    v_add_f32 v62, v62, v70
    v_mov_b32 v71, v63
    s_nop 1
    v_permlane16_swap_b32 v71, v63
    v_add_f32 v63, v63, v71
    v_mov_b32 v71, v63
    s_nop 1
    v_permlane32_swap_b32 v71, v63
    v_add_f32 v63, v63, v71
    v_mov_b32 v70, v64
    s_nop 1
    v_permlane16_swap_b32 v70, v64
    v_add_f32 v64, v64, v70
    v_mov_b32 v70, v64
    s_nop 1
    v_permlane32_swap_b32 v70, v64
    v_add_f32 v64, v64, v70
    v_mov_b32 v71, v65
    s_nop 1
    v_permlane16_swap_b32 v71, v65
    v_add_f32 v65, v65, v71
    v_mov_b32 v71, v65
    s_nop 1
    v_permlane32_swap_b32 v71, v65
    v_add_f32 v65, v65, v71
    v_mov_b32 v70, v66
    s_nop 1
    v_permlane16_swap_b32 v70, v66
    v_add_f32 v66, v66, v70
    v_mov_b32 v70, v66
    s_nop 1
    v_permlane32_swap_b32 v70, v66
    v_add_f32 v66, v66, v70
    v_mov_b32 v71, v67
    s_nop 1
    v_permlane16_swap_b32 v71, v67
    v_add_f32 v67, v67, v71
    v_mov_b32 v71, v67
    s_nop 1
    v_permlane32_swap_b32 v71, v67
    v_add_f32 v67, v67, v71
    v_and_b32 v3, 7, v1
    s_lshl_b32 s5, s4, 8
    v_lshlrev_b32_e64 v6, 5, v3
    v_add_u32 v6, s5, v6
    s_mov_b64 s[36:37], exec
    s_mov_b64 exec, 0xff
    ds_write_b128 v6, v[60:63]
    ds_write_b128 v6, v[64:67] offset:16
    s_mov_b64 exec, s[36:37]
    s_waitcnt lgkmcnt(0)
    s_barrier
    s_cmp_eq_u32 s4, 0
    s_cbranch_scc0 L_w0_8
    v_lshlrev_b32 v6, 2, v1
    ds_read_b32 v70, v6 offset:0
    ds_read_b32 v71, v6 offset:256
    ds_read_b32 v72, v6 offset:512
    ds_read_b32 v73, v6 offset:768
    s_mul_i32 s32, s32, 15360
    s_lshl_b32 s33, s33, 8
    s_add_u32 s32, s32, s33
    s_add_u32 s32, s32, 5242880
    s_waitcnt lgkmcnt(0)
    v_add_f32 v70, v70, v71
    v_add_f32 v72, v72, v73
    v_add_f32 v70, v70, v72
    buffer_store_dword v70, v6, s[8:11], s32 offen sc1
L_w0_8:
    s_barrier
    s_branch L_a1done_6
L_nomod_7:
    s_lshl_b32 s6, s4, 15
    v_lshrrev_b32 v77, 2, v1
    v_and_b32 v78, 3, v1
    v_lshlrev_b32 v78, 2, v78
    v_add_u32 v78, s6, v78
    v_xor_b32 v79, 0, v77
    v_lshl_add_u32 v224, v79, 4, v78
    v_xor_b32_e64 v79, 1, v77
    v_lshl_add_u32 v225, v79, 4, v78
    v_xor_b32_e64 v79, 2, v77
    v_lshl_add_u32 v226, v79, 4, v78
    v_xor_b32_e64 v79, 3, v77
    v_lshl_add_u32 v227, v79, 4, v78
    v_xor_b32_e64 v79, 4, v77
    v_lshl_add_u32 v228, v79, 4, v78
    v_xor_b32_e64 v79, 5, v77
    v_lshl_add_u32 v229, v79, 4, v78
    v_xor_b32_e64 v79, 6, v77
    v_lshl_add_u32 v230, v79, 4, v78
    v_xor_b32_e64 v79, 7, v77
    v_lshl_add_u32 v231, v79, 4, v78
    v_xor_b32_e64 v79, 8, v77
    v_lshl_add_u32 v232, v79, 4, v78
    v_xor_b32_e64 v79, 9, v77
    v_lshl_add_u32 v233, v79, 4, v78
    v_xor_b32_e64 v79, 10, v77
    v_lshl_add_u32 v234, v79, 4, v78
    v_xor_b32_e64 v79, 11, v77
    v_lshl_add_u32 v235, v79, 4, v78
    v_xor_b32_e64 v79, 12, v77
    v_lshl_add_u32 v236, v79, 4, v78
    v_xor_b32_e64 v79, 13, v77
    v_lshl_add_u32 v237, v79, 4, v78
    v_xor_b32_e64 v79, 14, v77
    v_lshl_add_u32 v238, v79, 4, v78
    v_xor_b32_e64 v79, 15, v77
    v_lshl_add_u32 v239, v79, 4, v78
    v_and_b32 v77, 15, v1
    v_lshrrev_b32 v78, 4, v1
    v_lshlrev_b32 v80, 8, v77
    v_add_u32 v80, s6, v80
    v_add_u32 v79, 0, v78
    v_xor_b32 v79, v79, v77
    v_lshl_add_u32 v240, v79, 4, v80
    v_add_u32 v79, 4, v78
    v_xor_b32 v79, v79, v77
    v_lshl_add_u32 v241, v79, 4, v80
    v_add_u32 v79, 8, v78
    v_xor_b32 v79, v79, v77
    v_lshl_add_u32 v242, v79, 4, v80
    v_add_u32 v79, 12, v78
    v_xor_b32 v79, v79, v77
    v_lshl_add_u32 v243, v79, 4, v80
    s_add_u32 s5, s42, 16640
    v_and_b32 v79, 1, v78
    v_lshrrev_b32 v80, 1, v78
    v_lshlrev_b32_e64 v244, 4, v77
    v_lshl_add_u32 v244, v79, 3, v244
    v_lshl_add_u32 v244, v80, 8, v244
    v_add_u32 v244, s5, v244
    v_lshlrev_b32 v245, 2, v77
    v_lshlrev_b32 v246, 1, v77
    v_cmp_gt_u32 vcc, 2, v78
    s_nop 1
    v_cndmask_b32 v245, v246, v245, vcc
    v_lshl_add_u32 v245, v78, 6, v245
    v_add_u32 v245, 256, v245
    v_mov_b32 v246, 32
    v_mov_b32 v81, 2
    v_cndmask_b32 v246, v246, v81, vcc
    v_add_u32 v246, v246, v245
    v_lshlrev_b32 v245, 1, v245
    v_lshlrev_b32 v246, 1, v246
    v_add_u32 v245, s5, v245
    v_add_u32 v246, s5, v246
    v_lshl_add_u32 v247, v78, 6, v77
    v_lshlrev_b32_e64 v247, 1, v247
    s_add_u32 s6, s5, 1024
    v_add_u32 v247, s6, v247
    v_lshrrev_b32 v79, 1, v1
    v_mul_u32_u24 v248, 4160, v79
    v_and_b32_e64 v79, 1, v1
    v_lshl_add_u32 v248, v79, 4, v248
    v_add_u32 v248, s42, v248
    v_lshlrev_b32 v249, 4, v1
    s_add_u32 s6, s42, 32
    v_add_u32 v249, s6, v249
    v_lshlrev_b32 v250, 4, v1
    v_lshlrev_b32 v79, 3, v1
    v_add_u32 v79, 256, v79
    v_cmp_gt_u32 vcc, 32, v1
    s_nop 1
    v_cndmask_b32 v250, v79, v250, vcc
    v_add_u32 v250, s5, v250
    v_mov_b32 v94, 0x1000100
    v_mov_b32 v80, 0x3020100
    v_cndmask_b32_e64 v94, v94, v80, vcc
    v_mov_b32 v95, 0x5040302
    v_mov_b32 v80, 0x7060504
    v_cndmask_b32_e64 v95, v95, v80, vcc
    v_mov_b32 v96, 0x1000100
    v_mov_b32 v80, 0x7060504
    v_cndmask_b32 v96, v96, v80, vcc
    v_lshlrev_b32 v251, 2, v1
    s_add_u32 s6, s5, 768
    v_add_u32 v251, s6, v251
    v_lshrrev_b32 v252, 1, v1
    v_lshlrev_b32_e64 v252, 2, v252
    s_add_u32 s6, s5, 1024
    v_add_u32 v252, s6, v252
    v_and_b32 v79, 1, v1
    v_cmp_eq_u32_e64 vcc, 0, v79
    v_mov_b32 v97, 0x3020302
    v_mov_b32 v80, 0x1000100
    v_cndmask_b32_e64 v97, v97, v80, vcc
    v_mov_b32 v98, 0x5040504
    v_mov_b32 v80, 0x3020100
    v_cndmask_b32_e64 v98, v98, v80, vcc
    v_mov_b32 v99, 0x5040504
    v_mov_b32 v80, 0x3020302
    v_cndmask_b32 v99, v99, v80, vcc
    s_waitcnt vmcnt(0)
L_a1done_6:
    s_cmp_eq_u32 s4, 0
    s_cbranch_scc0 L_w0_9
    s_mov_b32 s28, s92
    s_mov_b32 s29, s93
    s_mov_b32 s30, 0x100
    s_mov_b32 s31, 0x00020000
    v_mov_b32_e64 v254, 0
    buffer_load_dword v253, v254, s[28:31], 0 offen sc1
L_w0_9:
    v_lshlrev_b32_e64 v108, 16, v108
    v_mul_f32 v108, 0x3fb8aa3b, v108
    v_exp_f32 v108, v108
    v_lshlrev_b32 v100, 16, v100
    v_lshlrev_b32 v101, 16, v101
    v_lshlrev_b32 v102, 16, v102
    v_lshlrev_b32 v103, 16, v103
    v_lshlrev_b32 v104, 16, v104
    v_lshlrev_b32 v105, 16, v105
    v_lshlrev_b32 v106, 16, v106
    v_lshlrev_b32_e64 v107, 16, v107
    v_cvt_pk_bf16_f32 v108, v108, v108
    v_lshlrev_b32_e64 v108, 16, v108
    v_mul_f32 v138, 0x3fb8aa3b, v100
    v_mul_f32 v182, 0x3fb8aa3b, v104
    v_mul_f32 v140, v101, v108
    v_mul_f32 v184, v105, v108
    v_exp_f32 v138, v138
    v_exp_f32 v182, v182
    v_mul_f32 v134, v102, v108
    v_mul_f32 v178, v106, v108
    v_mul_f32 v155, 0x3e22f983, v140
    v_mul_f32 v199, 0x3e22f983, v184
    v_cvt_pk_bf16_f32 v138, v138, v138
    v_cvt_pk_bf16_f32 v182, v182, v182
    v_mul_f32 v135, v103, v108
    v_mul_f32 v179, v107, v108
    v_lshlrev_b32 v138, 16, v138
    v_lshlrev_b32 v182, 16, v182
    v_add_f32 v134, v134, v134
    v_add_f32 v178, v178, v178
    v_mul_f32 v138, v138, v108
    v_mul_f32 v182, v182, v108
    v_add_f32 v135, v135, v135
    v_add_f32 v179, v179, v179
    v_mul_f32 v154, 0xbfb8aa3b, v138
    v_mul_f32 v198, 0xbfb8aa3b, v182
    v_mul_f32 v139, 0x3f800000, v155
    v_mul_f32 v183, 0x3f800000, v199
    v_mul_f32 v141, 0x41000000, v155
    v_mul_f32 v185, 0x41000000, v199
    v_mul_f32 v143, 0x43000000, v155
    v_mul_f32 v187, 0x43000000, v199
    v_mul_f32 v138, 0x3f800000, v154
    v_mul_f32 v182, 0x3f800000, v198
    v_mul_f32 v140, 0x41000000, v154
    v_mul_f32 v184, 0x41000000, v198
    v_mul_f32 v142, 0x43000000, v154
    v_mul_f32 v186, 0x43000000, v198
    v_fract_f32 v139, v139
    v_fract_f32 v183, v183
    v_fract_f32 v141, v141
    v_fract_f32 v185, v185
    v_fract_f32 v143, v143
    v_fract_f32 v187, v187
    v_exp_f32 v138, v138
    v_exp_f32 v182, v182
    v_exp_f32 v140, v140
    v_exp_f32 v184, v184
    v_exp_f32 v142, v142
    v_exp_f32 v186, v186
    v_cos_f32 v112, v139
    v_cos_f32 v156, v183
    v_cos_f32 v126, v141
    v_cos_f32 v170, v185
    v_cos_f32 v128, v143
    v_cos_f32 v172, v187
    v_sin_f32 v113, v139
    v_sin_f32 v157, v183
    v_sin_f32 v127, v141
    v_sin_f32 v171, v185
    v_sin_f32 v129, v143
    v_sin_f32 v173, v187
    v_pk_mul_f32 v[112:113], v[112:113], v[138:139] op_sel_hi:[1,0]
    v_pk_mul_f32 v[156:157], v[156:157], v[182:183] op_sel_hi:[1,0]
    v_pk_mul_f32 v[126:127], v[126:127], v[140:141] op_sel_hi:[1,0]
    v_pk_mul_f32 v[170:171], v[170:171], v[184:185] op_sel_hi:[1,0]
    v_pk_mul_f32 v[128:129], v[128:129], v[142:143] op_sel_hi:[1,0]
    v_pk_mul_f32 v[172:173], v[172:173], v[186:187] op_sel_hi:[1,0]
    v_pk_mul_f32 v[138:139], v[112:113], v[112:113] op_sel:[0,0] op_sel_hi:[0,1]
    v_pk_mul_f32 v[182:183], v[156:157], v[156:157] op_sel:[0,0] op_sel_hi:[0,1]
    v_pk_fma_f32 v[114:115], v[112:113], v[112:113], v[138:139] op_sel:[1,1,0] op_sel_hi:[1,0,1] neg_lo:[1,0,0]
    v_pk_fma_f32 v[158:159], v[156:157], v[156:157], v[182:183] op_sel:[1,1,0] op_sel_hi:[1,0,1] neg_lo:[1,0,0]
    v_pk_mul_f32 v[144:145], v[128:129], v[128:129] op_sel:[0,0] op_sel_hi:[0,1]
    v_pk_mul_f32 v[188:189], v[172:173], v[172:173] op_sel:[0,0] op_sel_hi:[0,1]
    v_pk_mul_f32 v[142:143], v[134:135], v[126:127] op_sel:[0,0] op_sel_hi:[0,1]
    v_pk_mul_f32 v[186:187], v[178:179], v[170:171] op_sel:[0,0] op_sel_hi:[0,1]
    v_pk_fma_f32 v[130:131], v[128:129], v[128:129], v[144:145] op_sel:[1,1,0] op_sel_hi:[1,0,1] neg_lo:[1,0,0]
    v_pk_fma_f32 v[174:175], v[172:173], v[172:173], v[188:189] op_sel:[1,1,0] op_sel_hi:[1,0,1] neg_lo:[1,0,0]
    v_pk_mul_f32 v[140:141], v[114:115], v[112:113] op_sel:[0,0] op_sel_hi:[0,1]
    v_pk_mul_f32 v[184:185], v[158:159], v[156:157] op_sel:[0,0] op_sel_hi:[0,1]
    v_pk_fma_f32 v[116:117], v[114:115], v[112:113], v[140:141] op_sel:[1,1,0] op_sel_hi:[1,0,1] neg_lo:[1,0,0]
    v_pk_fma_f32 v[160:161], v[158:159], v[156:157], v[184:185] op_sel:[1,1,0] op_sel_hi:[1,0,1] neg_lo:[1,0,0]
    v_pk_fma_f32 v[136:137], v[134:135], v[126:127], v[142:143] op_sel:[1,1,0] op_sel_hi:[1,0,1] neg_lo:[1,0,0]
    v_pk_fma_f32 v[180:181], v[178:179], v[170:171], v[186:187] op_sel:[1,1,0] op_sel_hi:[1,0,1] neg_lo:[1,0,0]
    v_pk_mul_f32 v[138:139], v[114:115], v[114:115] op_sel:[0,0] op_sel_hi:[0,1]
    v_pk_mul_f32 v[182:183], v[158:159], v[158:159] op_sel:[0,0] op_sel_hi:[0,1]
    v_pk_fma_f32 v[118:119], v[114:115], v[114:115], v[138:139] op_sel:[1,1,0] op_sel_hi:[1,0,1] neg_lo:[1,0,0]
    v_pk_fma_f32 v[162:163], v[158:159], v[158:159], v[182:183] op_sel:[1,1,0] op_sel_hi:[1,0,1] neg_lo:[1,0,0]
    v_cvt_pk_bf16_f32 v150, v134, v135
    v_cvt_pk_bf16_f32 v194, v178, v179
    v_cvt_pk_bf16_f32 v152, v112, -v113
    v_cvt_pk_bf16_f32 v196, v156, -v157
    ds_write2st64_b32 v225, v152, v196 offset0:17 offset1:81
    v_pk_mul_f32 v[140:141], v[118:119], v[112:113] op_sel:[0,0] op_sel_hi:[0,1]
    v_pk_mul_f32 v[184:185], v[162:163], v[156:157] op_sel:[0,0] op_sel_hi:[0,1]
    ds_write2st64_b32 v224, v150, v194 offset0:0 offset1:64
    v_pk_fma_f32 v[120:121], v[118:119], v[112:113], v[140:141] op_sel:[1,1,0] op_sel_hi:[1,0,1] neg_lo:[1,0,0]
    v_pk_fma_f32 v[164:165], v[162:163], v[156:157], v[184:185] op_sel:[1,1,0] op_sel_hi:[1,0,1] neg_lo:[1,0,0]
    v_cvt_pk_bf16_f32 v153, v114, -v115
    v_cvt_pk_bf16_f32 v197, v158, -v159
    v_pk_mul_f32 v[142:143], v[136:137], v[126:127] op_sel:[0,0] op_sel_hi:[0,1]
    v_pk_mul_f32 v[186:187], v[180:181], v[170:171] op_sel:[0,0] op_sel_hi:[0,1]
    ds_write2st64_b32 v226, v153, v197 offset0:18 offset1:82
    v_pk_mul_f32 v[138:139], v[116:117], v[116:117] op_sel:[0,0] op_sel_hi:[0,1]
    v_pk_mul_f32 v[182:183], v[160:161], v[160:161] op_sel:[0,0] op_sel_hi:[0,1]
    v_pk_fma_f32 v[122:123], v[116:117], v[116:117], v[138:139] op_sel:[1,1,0] op_sel_hi:[1,0,1] neg_lo:[1,0,0]
    v_pk_fma_f32 v[166:167], v[160:161], v[160:161], v[182:183] op_sel:[1,1,0] op_sel_hi:[1,0,1] neg_lo:[1,0,0]
    v_pk_fma_f32 v[134:135], v[136:137], v[126:127], v[142:143] op_sel:[1,1,0] op_sel_hi:[1,0,1] neg_lo:[1,0,0]
    v_pk_fma_f32 v[178:179], v[180:181], v[170:171], v[186:187] op_sel:[1,1,0] op_sel_hi:[1,0,1] neg_lo:[1,0,0]
    v_cvt_pk_bf16_f32 v152, v116, -v117
    v_cvt_pk_bf16_f32 v196, v160, -v161
    ds_write2st64_b32 v227, v152, v196 offset0:19 offset1:83
    v_cvt_pk_bf16_f32 v151, v136, v137
    v_cvt_pk_bf16_f32 v195, v180, v181
    v_pk_mul_f32 v[140:141], v[118:119], v[116:117] op_sel:[0,0] op_sel_hi:[0,1]
    v_pk_mul_f32 v[184:185], v[162:163], v[160:161] op_sel:[0,0] op_sel_hi:[0,1]
    v_pk_fma_f32 v[124:125], v[118:119], v[116:117], v[140:141] op_sel:[1,1,0] op_sel_hi:[1,0,1] neg_lo:[1,0,0]
    v_pk_fma_f32 v[168:169], v[162:163], v[160:161], v[184:185] op_sel:[1,1,0] op_sel_hi:[1,0,1] neg_lo:[1,0,0]
    v_mov_b32 v153, 0x3f80
    v_mov_b32 v197, 0x3f80
    ds_write2st64_b32 v225, v151, v195 offset0:1 offset1:65
    ds_write2st64_b32 v224, v153, v197 offset0:16 offset1:80
    v_cvt_pk_bf16_f32 v153, v118, -v119
    v_cvt_pk_bf16_f32 v197, v162, -v163
    v_pk_mul_f32 v[142:143], v[134:135], v[126:127] op_sel:[0,0] op_sel_hi:[0,1]
    v_pk_mul_f32 v[186:187], v[178:179], v[170:171] op_sel:[0,0] op_sel_hi:[0,1]
    ds_write2st64_b32 v228, v153, v197 offset0:20 offset1:84
    v_cvt_pk_bf16_f32 v152, v120, -v121
    v_cvt_pk_bf16_f32 v196, v164, -v165
    ds_write2st64_b32 v229, v152, v196 offset0:21 offset1:85
    v_pk_fma_f32 v[136:137], v[134:135], v[126:127], v[142:143] op_sel:[1,1,0] op_sel_hi:[1,0,1] neg_lo:[1,0,0]
    v_pk_fma_f32 v[180:181], v[178:179], v[170:171], v[186:187] op_sel:[1,1,0] op_sel_hi:[1,0,1] neg_lo:[1,0,0]
    v_cvt_pk_bf16_f32 v153, v122, -v123
    v_cvt_pk_bf16_f32 v197, v166, -v167
    ds_write2st64_b32 v230, v153, v197 offset0:22 offset1:86
    v_cvt_pk_bf16_f32 v152, v124, -v125
    v_cvt_pk_bf16_f32 v196, v168, -v169
    v_cvt_pk_bf16_f32 v150, v134, v135
    v_cvt_pk_bf16_f32 v194, v178, v179
    ds_write2st64_b32 v231, v152, v196 offset0:23 offset1:87
    v_cvt_pk_bf16_f32 v153, v128, -v129
    v_cvt_pk_bf16_f32 v197, v172, -v173
    ds_write2st64_b32 v226, v150, v194 offset0:2 offset1:66
    ds_write2st64_b32 v232, v153, v197 offset0:24 offset1:88
    v_pk_mul_f32 v[138:139], v[128:129], v[112:113] op_sel:[0,0] op_sel_hi:[0,1]
    v_pk_mul_f32 v[182:183], v[172:173], v[156:157] op_sel:[0,0] op_sel_hi:[0,1]
    v_pk_fma_f32 v[146:147], v[128:129], v[112:113], v[138:139] op_sel:[1,1,0] op_sel_hi:[1,0,1] neg_lo:[1,0,0]
    v_pk_fma_f32 v[190:191], v[172:173], v[156:157], v[182:183] op_sel:[1,1,0] op_sel_hi:[1,0,1] neg_lo:[1,0,0]
    v_pk_mul_f32 v[142:143], v[136:137], v[126:127] op_sel:[0,0] op_sel_hi:[0,1]
    v_pk_mul_f32 v[186:187], v[180:181], v[170:171] op_sel:[0,0] op_sel_hi:[0,1]
    s_waitcnt vmcnt(0)
    s_cmp_eq_u32 s4, 0
    s_cbranch_scc0 L_w0_10
    v_cmp_eq_u32 vcc, 0, v253
    s_nop 0
    s_cbranch_vccz L_inok_11
    s_mov_b32 s28, s92
    s_mov_b32 s29, s93
    s_mov_b32 s30, 0x100
    s_mov_b32 s31, 0x00020000
    v_mov_b32 v254, 0
    s_mov_b64 s[36:37], exec
    s_mov_b64 exec, 0x1
    s_mov_b32 s97, 0
L_poll_12:
    buffer_load_dword v253, v254, s[28:31], 0 offen sc1
    s_waitcnt vmcnt(0)
    v_cmp_eq_u32 vcc, 0, v253
    s_nop 0
    s_cbranch_vccz L_polld_13
    s_add_u32 s97, s97, 1
    s_cmp_lt_u32 s97, 262144
    s_cbranch_scc1 L_poll_12
L_polld_13:
    s_mov_b64 exec, s[36:37]
L_inok_11:
L_w0_10:
    s_cmp_ge_u32 s2, 136
    s_cbranch_scc1 L_arr_15
    s_cmp_ge_u32 s2, 128
    s_cbranch_scc1 L_noarr_14
L_arr_15:
    s_waitcnt vmcnt(0)
    s_barrier
    s_cmp_eq_u32 s4, 0
    s_cbranch_scc0 L_w0_16
    s_lshl_b32 s96, s35, 7
    s_add_u32 s96, s96, 5373952
    v_mov_b32_e64 v2, 1
    v_mov_b32 v3, 0
    s_mov_b64 s[36:37], exec
    s_mov_b64 exec, 1
    buffer_atomic_add v2, v3, s[8:11], s96 offen sc1
    s_mov_b64 exec, s[36:37]
L_w0_16:
L_noarr_14:
    v_cvt_pk_bf16_f32 v152, v146, -v147
    v_cvt_pk_bf16_f32 v196, v190, -v191
    ds_write2st64_b32 v233, v152, v196 offset0:25 offset1:89
    v_pk_fma_f32 v[134:135], v[136:137], v[126:127], v[142:143] op_sel:[1,1,0] op_sel_hi:[1,0,1] neg_lo:[1,0,0]
    v_pk_fma_f32 v[178:179], v[180:181], v[170:171], v[186:187] op_sel:[1,1,0] op_sel_hi:[1,0,1] neg_lo:[1,0,0]
    v_pk_mul_f32 v[140:141], v[128:129], v[114:115] op_sel:[0,0] op_sel_hi:[0,1]
    v_pk_mul_f32 v[184:185], v[172:173], v[158:159] op_sel:[0,0] op_sel_hi:[0,1]
    v_pk_fma_f32 v[148:149], v[128:129], v[114:115], v[140:141] op_sel:[1,1,0] op_sel_hi:[1,0,1] neg_lo:[1,0,0]
    v_pk_fma_f32 v[192:193], v[172:173], v[158:159], v[184:185] op_sel:[1,1,0] op_sel_hi:[1,0,1] neg_lo:[1,0,0]
    v_cvt_pk_bf16_f32 v153, v148, -v149
    v_cvt_pk_bf16_f32 v197, v192, -v193
    v_cvt_pk_bf16_f32 v151, v136, v137
    v_cvt_pk_bf16_f32 v195, v180, v181
    ds_write2st64_b32 v234, v153, v197 offset0:26 offset1:90
    v_pk_mul_f32 v[138:139], v[128:129], v[116:117] op_sel:[0,0] op_sel_hi:[0,1]
    v_pk_mul_f32 v[182:183], v[172:173], v[160:161] op_sel:[0,0] op_sel_hi:[0,1]
    ds_write2st64_b32 v227, v151, v195 offset0:3 offset1:67
    v_pk_fma_f32 v[146:147], v[128:129], v[116:117], v[138:139] op_sel:[1,1,0] op_sel_hi:[1,0,1] neg_lo:[1,0,0]
    v_pk_fma_f32 v[190:191], v[172:173], v[160:161], v[182:183] op_sel:[1,1,0] op_sel_hi:[1,0,1] neg_lo:[1,0,0]
    v_cvt_pk_bf16_f32 v152, v146, -v147
    v_cvt_pk_bf16_f32 v196, v190, -v191
    ds_write2st64_b32 v235, v152, v196 offset0:27 offset1:91
    v_pk_mul_f32 v[142:143], v[134:135], v[126:127] op_sel:[0,0] op_sel_hi:[0,1]
    v_pk_mul_f32 v[186:187], v[178:179], v[170:171] op_sel:[0,0] op_sel_hi:[0,1]
    v_pk_mul_f32 v[140:141], v[128:129], v[118:119] op_sel:[0,0] op_sel_hi:[0,1]
    v_pk_mul_f32 v[184:185], v[172:173], v[162:163] op_sel:[0,0] op_sel_hi:[0,1]
    v_pk_fma_f32 v[148:149], v[128:129], v[118:119], v[140:141] op_sel:[1,1,0] op_sel_hi:[1,0,1] neg_lo:[1,0,0]
    v_pk_fma_f32 v[192:193], v[172:173], v[162:163], v[184:185] op_sel:[1,1,0] op_sel_hi:[1,0,1] neg_lo:[1,0,0]
    v_pk_fma_f32 v[136:137], v[134:135], v[126:127], v[142:143] op_sel:[1,1,0] op_sel_hi:[1,0,1] neg_lo:[1,0,0]
    v_pk_fma_f32 v[180:181], v[178:179], v[170:171], v[186:187] op_sel:[1,1,0] op_sel_hi:[1,0,1] neg_lo:[1,0,0]
    v_cvt_pk_bf16_f32 v153, v148, -v149
    v_cvt_pk_bf16_f32 v197, v192, -v193
    ds_write2st64_b32 v236, v153, v197 offset0:28 offset1:92
    v_pk_mul_f32 v[138:139], v[128:129], v[120:121] op_sel:[0,0] op_sel_hi:[0,1]
    v_pk_mul_f32 v[182:183], v[172:173], v[164:165] op_sel:[0,0] op_sel_hi:[0,1]
    v_cvt_pk_bf16_f32 v150, v134, v135
    v_cvt_pk_bf16_f32 v194, v178, v179
    v_pk_fma_f32 v[146:147], v[128:129], v[120:121], v[138:139] op_sel:[1,1,0] op_sel_hi:[1,0,1] neg_lo:[1,0,0]
    v_pk_fma_f32 v[190:191], v[172:173], v[164:165], v[182:183] op_sel:[1,1,0] op_sel_hi:[1,0,1] neg_lo:[1,0,0]
    v_cvt_pk_bf16_f32 v152, v146, -v147
    v_cvt_pk_bf16_f32 v196, v190, -v191
    ds_write2st64_b32 v228, v150, v194 offset0:4 offset1:68
    ds_write2st64_b32 v237, v152, v196 offset0:29 offset1:93
    v_pk_mul_f32 v[140:141], v[128:129], v[122:123] op_sel:[0,0] op_sel_hi:[0,1]
    v_pk_mul_f32 v[184:185], v[172:173], v[166:167] op_sel:[0,0] op_sel_hi:[0,1]
    v_pk_fma_f32 v[148:149], v[128:129], v[122:123], v[140:141] op_sel:[1,1,0] op_sel_hi:[1,0,1] neg_lo:[1,0,0]
    v_pk_fma_f32 v[192:193], v[172:173], v[166:167], v[184:185] op_sel:[1,1,0] op_sel_hi:[1,0,1] neg_lo:[1,0,0]
    v_pk_mul_f32 v[142:143], v[136:137], v[126:127] op_sel:[0,0] op_sel_hi:[0,1]
    v_pk_mul_f32 v[186:187], v[180:181], v[170:171] op_sel:[0,0] op_sel_hi:[0,1]
    v_cvt_pk_bf16_f32 v153, v148, -v149
    v_cvt_pk_bf16_f32 v197, v192, -v193
    ds_write2st64_b32 v238, v153, v197 offset0:30 offset1:94
    v_pk_mul_f32 v[138:139], v[128:129], v[124:125] op_sel:[0,0] op_sel_hi:[0,1]
    v_pk_mul_f32 v[182:183], v[172:173], v[168:169] op_sel:[0,0] op_sel_hi:[0,1]
    v_pk_fma_f32 v[134:135], v[136:137], v[126:127], v[142:143] op_sel:[1,1,0] op_sel_hi:[1,0,1] neg_lo:[1,0,0]
    v_pk_fma_f32 v[178:179], v[180:181], v[170:171], v[186:187] op_sel:[1,1,0] op_sel_hi:[1,0,1] neg_lo:[1,0,0]
    v_pk_fma_f32 v[146:147], v[128:129], v[124:125], v[138:139] op_sel:[1,1,0] op_sel_hi:[1,0,1] neg_lo:[1,0,0]
    v_pk_fma_f32 v[190:191], v[172:173], v[168:169], v[182:183] op_sel:[1,1,0] op_sel_hi:[1,0,1] neg_lo:[1,0,0]
    v_cvt_pk_bf16_f32 v152, v146, -v147
    v_cvt_pk_bf16_f32 v196, v190, -v191
    v_cvt_pk_bf16_f32 v151, v136, v137
    v_cvt_pk_bf16_f32 v195, v180, v181
    ds_write2st64_b32 v239, v152, v196 offset0:31 offset1:95
    v_pk_mul_f32 v[144:145], v[130:131], v[128:129] op_sel:[0,0] op_sel_hi:[0,1]
    v_pk_mul_f32 v[188:189], v[174:175], v[172:173] op_sel:[0,0] op_sel_hi:[0,1]
    v_pk_fma_f32 v[132:133], v[130:131], v[128:129], v[144:145] op_sel:[1,1,0] op_sel_hi:[1,0,1] neg_lo:[1,0,0]
    v_pk_fma_f32 v[176:177], v[174:175], v[172:173], v[188:189] op_sel:[1,1,0] op_sel_hi:[1,0,1] neg_lo:[1,0,0]
    ds_write2st64_b32 v229, v151, v195 offset0:5 offset1:69
    v_cvt_pk_bf16_f32 v153, v130, -v131
    v_cvt_pk_bf16_f32 v197, v174, -v175
    ds_write2st64_b32 v224, v153, v197 offset0:32 offset1:96
    v_pk_mul_f32 v[142:143], v[134:135], v[126:127] op_sel:[0,0] op_sel_hi:[0,1]
    v_pk_mul_f32 v[186:187], v[178:179], v[170:171] op_sel:[0,0] op_sel_hi:[0,1]
    v_pk_mul_f32 v[140:141], v[130:131], v[114:115] op_sel:[0,0] op_sel_hi:[0,1]
    v_pk_mul_f32 v[184:185], v[174:175], v[158:159] op_sel:[0,0] op_sel_hi:[0,1]
    v_pk_fma_f32 v[148:149], v[130:131], v[114:115], v[140:141] op_sel:[1,1,0] op_sel_hi:[1,0,1] neg_lo:[1,0,0]
    v_pk_fma_f32 v[192:193], v[174:175], v[158:159], v[184:185] op_sel:[1,1,0] op_sel_hi:[1,0,1] neg_lo:[1,0,0]
    v_cvt_pk_bf16_f32 v152, v148, -v149
    v_cvt_pk_bf16_f32 v196, v192, -v193
    v_pk_fma_f32 v[136:137], v[134:135], v[126:127], v[142:143] op_sel:[1,1,0] op_sel_hi:[1,0,1] neg_lo:[1,0,0]
    v_pk_fma_f32 v[180:181], v[178:179], v[170:171], v[186:187] op_sel:[1,1,0] op_sel_hi:[1,0,1] neg_lo:[1,0,0]
    ds_write2st64_b32 v225, v152, v196 offset0:33 offset1:97
    v_pk_mul_f32 v[138:139], v[130:131], v[118:119] op_sel:[0,0] op_sel_hi:[0,1]
    v_pk_mul_f32 v[182:183], v[174:175], v[162:163] op_sel:[0,0] op_sel_hi:[0,1]
    v_cvt_pk_bf16_f32 v150, v134, v135
    v_cvt_pk_bf16_f32 v194, v178, v179
    v_pk_fma_f32 v[146:147], v[130:131], v[118:119], v[138:139] op_sel:[1,1,0] op_sel_hi:[1,0,1] neg_lo:[1,0,0]
    v_pk_fma_f32 v[190:191], v[174:175], v[162:163], v[182:183] op_sel:[1,1,0] op_sel_hi:[1,0,1] neg_lo:[1,0,0]
    v_cvt_pk_bf16_f32 v153, v146, -v147
    v_cvt_pk_bf16_f32 v197, v190, -v191
    ds_write2st64_b32 v226, v153, v197 offset0:34 offset1:98
    ds_write2st64_b32 v230, v150, v194 offset0:6 offset1:70
    v_pk_mul_f32 v[140:141], v[130:131], v[122:123] op_sel:[0,0] op_sel_hi:[0,1]
    v_pk_mul_f32 v[184:185], v[174:175], v[166:167] op_sel:[0,0] op_sel_hi:[0,1]
    v_pk_fma_f32 v[148:149], v[130:131], v[122:123], v[140:141] op_sel:[1,1,0] op_sel_hi:[1,0,1] neg_lo:[1,0,0]
    v_pk_fma_f32 v[192:193], v[174:175], v[166:167], v[184:185] op_sel:[1,1,0] op_sel_hi:[1,0,1] neg_lo:[1,0,0]
    v_pk_mul_f32 v[142:143], v[136:137], v[126:127] op_sel:[0,0] op_sel_hi:[0,1]
    v_pk_mul_f32 v[186:187], v[180:181], v[170:171] op_sel:[0,0] op_sel_hi:[0,1]
    v_cvt_pk_bf16_f32 v152, v148, -v149
    v_cvt_pk_bf16_f32 v196, v192, -v193
    ds_write2st64_b32 v227, v152, v196 offset0:35 offset1:99
    v_pk_mul_f32 v[144:145], v[132:133], v[128:129] op_sel:[0,0] op_sel_hi:[0,1]
    v_pk_mul_f32 v[188:189], v[176:177], v[172:173] op_sel:[0,0] op_sel_hi:[0,1]
    v_pk_fma_f32 v[134:135], v[136:137], v[126:127], v[142:143] op_sel:[1,1,0] op_sel_hi:[1,0,1] neg_lo:[1,0,0]
    v_pk_fma_f32 v[178:179], v[180:181], v[170:171], v[186:187] op_sel:[1,1,0] op_sel_hi:[1,0,1] neg_lo:[1,0,0]
    v_pk_fma_f32 v[130:131], v[132:133], v[128:129], v[144:145] op_sel:[1,1,0] op_sel_hi:[1,0,1] neg_lo:[1,0,0]
    v_pk_fma_f32 v[174:175], v[176:177], v[172:173], v[188:189] op_sel:[1,1,0] op_sel_hi:[1,0,1] neg_lo:[1,0,0]
    v_cvt_pk_bf16_f32 v153, v132, -v133
    v_cvt_pk_bf16_f32 v197, v176, -v177
    v_cvt_pk_bf16_f32 v151, v136, v137
    v_cvt_pk_bf16_f32 v195, v180, v181
    ds_write2st64_b32 v228, v153, v197 offset0:36 offset1:100
    v_pk_mul_f32 v[138:139], v[132:133], v[114:115] op_sel:[0,0] op_sel_hi:[0,1]
    v_pk_mul_f32 v[182:183], v[176:177], v[158:159] op_sel:[0,0] op_sel_hi:[0,1]
    v_pk_fma_f32 v[146:147], v[132:133], v[114:115], v[138:139] op_sel:[1,1,0] op_sel_hi:[1,0,1] neg_lo:[1,0,0]
    v_pk_fma_f32 v[190:191], v[176:177], v[158:159], v[182:183] op_sel:[1,1,0] op_sel_hi:[1,0,1] neg_lo:[1,0,0]
    ds_write2st64_b32 v231, v151, v195 offset0:7 offset1:71
    v_cvt_pk_bf16_f32 v152, v146, -v147
    v_cvt_pk_bf16_f32 v196, v190, -v191
    ds_write2st64_b32 v229, v152, v196 offset0:37 offset1:101
    v_pk_mul_f32 v[140:141], v[132:133], v[118:119] op_sel:[0,0] op_sel_hi:[0,1]
    v_pk_mul_f32 v[184:185], v[176:177], v[162:163] op_sel:[0,0] op_sel_hi:[0,1]
    v_pk_mul_f32 v[142:143], v[134:135], v[126:127] op_sel:[0,0] op_sel_hi:[0,1]
    v_pk_mul_f32 v[186:187], v[178:179], v[170:171] op_sel:[0,0] op_sel_hi:[0,1]
    v_pk_fma_f32 v[148:149], v[132:133], v[118:119], v[140:141] op_sel:[1,1,0] op_sel_hi:[1,0,1] neg_lo:[1,0,0]
    v_pk_fma_f32 v[192:193], v[176:177], v[162:163], v[184:185] op_sel:[1,1,0] op_sel_hi:[1,0,1] neg_lo:[1,0,0]
    v_cvt_pk_bf16_f32 v153, v148, -v149
    v_cvt_pk_bf16_f32 v197, v192, -v193
    v_pk_fma_f32 v[136:137], v[134:135], v[126:127], v[142:143] op_sel:[1,1,0] op_sel_hi:[1,0,1] neg_lo:[1,0,0]
    v_pk_fma_f32 v[180:181], v[178:179], v[170:171], v[186:187] op_sel:[1,1,0] op_sel_hi:[1,0,1] neg_lo:[1,0,0]
    ds_write2st64_b32 v230, v153, v197 offset0:38 offset1:102
    v_pk_mul_f32 v[138:139], v[132:133], v[122:123] op_sel:[0,0] op_sel_hi:[0,1]
    v_pk_mul_f32 v[182:183], v[176:177], v[166:167] op_sel:[0,0] op_sel_hi:[0,1]
    v_pk_fma_f32 v[146:147], v[132:133], v[122:123], v[138:139] op_sel:[1,1,0] op_sel_hi:[1,0,1] neg_lo:[1,0,0]
    v_pk_fma_f32 v[190:191], v[176:177], v[166:167], v[182:183] op_sel:[1,1,0] op_sel_hi:[1,0,1] neg_lo:[1,0,0]
    v_cvt_pk_bf16_f32 v150, v134, v135
    v_cvt_pk_bf16_f32 v194, v178, v179
    v_cvt_pk_bf16_f32 v152, v146, -v147
    v_cvt_pk_bf16_f32 v196, v190, -v191
    ds_write2st64_b32 v231, v152, v196 offset0:39 offset1:103
    ds_write2st64_b32 v232, v150, v194 offset0:8 offset1:72
    v_pk_mul_f32 v[144:145], v[130:131], v[128:129] op_sel:[0,0] op_sel_hi:[0,1]
    v_pk_mul_f32 v[188:189], v[174:175], v[172:173] op_sel:[0,0] op_sel_hi:[0,1]
    v_pk_fma_f32 v[132:133], v[130:131], v[128:129], v[144:145] op_sel:[1,1,0] op_sel_hi:[1,0,1] neg_lo:[1,0,0]
    v_pk_fma_f32 v[176:177], v[174:175], v[172:173], v[188:189] op_sel:[1,1,0] op_sel_hi:[1,0,1] neg_lo:[1,0,0]
    v_cvt_pk_bf16_f32 v153, v130, -v131
    v_cvt_pk_bf16_f32 v197, v174, -v175
    v_pk_mul_f32 v[142:143], v[136:137], v[126:127] op_sel:[0,0] op_sel_hi:[0,1]
    v_pk_mul_f32 v[186:187], v[180:181], v[170:171] op_sel:[0,0] op_sel_hi:[0,1]
    ds_write2st64_b32 v232, v153, v197 offset0:40 offset1:104
    v_pk_mul_f32 v[140:141], v[130:131], v[118:119] op_sel:[0,0] op_sel_hi:[0,1]
    v_pk_mul_f32 v[184:185], v[174:175], v[162:163] op_sel:[0,0] op_sel_hi:[0,1]
    v_pk_fma_f32 v[134:135], v[136:137], v[126:127], v[142:143] op_sel:[1,1,0] op_sel_hi:[1,0,1] neg_lo:[1,0,0]
    v_pk_fma_f32 v[178:179], v[180:181], v[170:171], v[186:187] op_sel:[1,1,0] op_sel_hi:[1,0,1] neg_lo:[1,0,0]
    v_pk_fma_f32 v[148:149], v[130:131], v[118:119], v[140:141] op_sel:[1,1,0] op_sel_hi:[1,0,1] neg_lo:[1,0,0]
    v_pk_fma_f32 v[192:193], v[174:175], v[162:163], v[184:185] op_sel:[1,1,0] op_sel_hi:[1,0,1] neg_lo:[1,0,0]
    v_cvt_pk_bf16_f32 v152, v148, -v149
    v_cvt_pk_bf16_f32 v196, v192, -v193
    ds_write2st64_b32 v233, v152, v196 offset0:41 offset1:105
    v_cvt_pk_bf16_f32 v151, v136, v137
    v_cvt_pk_bf16_f32 v195, v180, v181
    v_pk_mul_f32 v[144:145], v[132:133], v[128:129] op_sel:[0,0] op_sel_hi:[0,1]
    v_pk_mul_f32 v[188:189], v[176:177], v[172:173] op_sel:[0,0] op_sel_hi:[0,1]
    v_pk_fma_f32 v[130:131], v[132:133], v[128:129], v[144:145] op_sel:[1,1,0] op_sel_hi:[1,0,1] neg_lo:[1,0,0]
    v_pk_fma_f32 v[174:175], v[176:177], v[172:173], v[188:189] op_sel:[1,1,0] op_sel_hi:[1,0,1] neg_lo:[1,0,0]
    ds_write2st64_b32 v233, v151, v195 offset0:9 offset1:73
    v_cvt_pk_bf16_f32 v153, v132, -v133
    v_cvt_pk_bf16_f32 v197, v176, -v177
    ds_write2st64_b32 v234, v153, v197 offset0:42 offset1:106
    v_pk_mul_f32 v[138:139], v[132:133], v[118:119] op_sel:[0,0] op_sel_hi:[0,1]
    v_pk_mul_f32 v[182:183], v[176:177], v[162:163] op_sel:[0,0] op_sel_hi:[0,1]
    v_pk_mul_f32 v[142:143], v[134:135], v[126:127] op_sel:[0,0] op_sel_hi:[0,1]
    v_pk_mul_f32 v[186:187], v[178:179], v[170:171] op_sel:[0,0] op_sel_hi:[0,1]
    v_pk_fma_f32 v[146:147], v[132:133], v[118:119], v[138:139] op_sel:[1,1,0] op_sel_hi:[1,0,1] neg_lo:[1,0,0]
    v_pk_fma_f32 v[190:191], v[176:177], v[162:163], v[182:183] op_sel:[1,1,0] op_sel_hi:[1,0,1] neg_lo:[1,0,0]
    v_cvt_pk_bf16_f32 v152, v146, -v147
    v_cvt_pk_bf16_f32 v196, v190, -v191
    ds_write2st64_b32 v235, v152, v196 offset0:43 offset1:107
    v_pk_fma_f32 v[136:137], v[134:135], v[126:127], v[142:143] op_sel:[1,1,0] op_sel_hi:[1,0,1] neg_lo:[1,0,0]
    v_pk_fma_f32 v[180:181], v[178:179], v[170:171], v[186:187] op_sel:[1,1,0] op_sel_hi:[1,0,1] neg_lo:[1,0,0]
    v_pk_mul_f32 v[144:145], v[130:131], v[128:129] op_sel:[0,0] op_sel_hi:[0,1]
    v_pk_mul_f32 v[188:189], v[174:175], v[172:173] op_sel:[0,0] op_sel_hi:[0,1]
    v_pk_fma_f32 v[132:133], v[130:131], v[128:129], v[144:145] op_sel:[1,1,0] op_sel_hi:[1,0,1] neg_lo:[1,0,0]
    v_pk_fma_f32 v[176:177], v[174:175], v[172:173], v[188:189] op_sel:[1,1,0] op_sel_hi:[1,0,1] neg_lo:[1,0,0]
    v_cvt_pk_bf16_f32 v150, v134, v135
    v_cvt_pk_bf16_f32 v194, v178, v179
    v_cvt_pk_bf16_f32 v153, v130, -v131
    v_cvt_pk_bf16_f32 v197, v174, -v175
    ds_write2st64_b32 v236, v153, v197 offset0:44 offset1:108
    v_pk_mul_f32 v[140:141], v[130:131], v[118:119] op_sel:[0,0] op_sel_hi:[0,1]
    v_pk_mul_f32 v[184:185], v[174:175], v[162:163] op_sel:[0,0] op_sel_hi:[0,1]
    ds_write2st64_b32 v234, v150, v194 offset0:10 offset1:74
    v_pk_fma_f32 v[148:149], v[130:131], v[118:119], v[140:141] op_sel:[1,1,0] op_sel_hi:[1,0,1] neg_lo:[1,0,0]
    v_pk_fma_f32 v[192:193], v[174:175], v[162:163], v[184:185] op_sel:[1,1,0] op_sel_hi:[1,0,1] neg_lo:[1,0,0]
    v_cvt_pk_bf16_f32 v152, v148, -v149
    v_cvt_pk_bf16_f32 v196, v192, -v193
    v_pk_mul_f32 v[142:143], v[136:137], v[126:127] op_sel:[0,0] op_sel_hi:[0,1]
    v_pk_mul_f32 v[186:187], v[180:181], v[170:171] op_sel:[0,0] op_sel_hi:[0,1]
    ds_write2st64_b32 v237, v152, v196 offset0:45 offset1:109
    v_pk_mul_f32 v[144:145], v[132:133], v[128:129] op_sel:[0,0] op_sel_hi:[0,1]
    v_pk_mul_f32 v[188:189], v[176:177], v[172:173] op_sel:[0,0] op_sel_hi:[0,1]
    v_pk_fma_f32 v[130:131], v[132:133], v[128:129], v[144:145] op_sel:[1,1,0] op_sel_hi:[1,0,1] neg_lo:[1,0,0]
    v_pk_fma_f32 v[174:175], v[176:177], v[172:173], v[188:189] op_sel:[1,1,0] op_sel_hi:[1,0,1] neg_lo:[1,0,0]
    v_pk_fma_f32 v[134:135], v[136:137], v[126:127], v[142:143] op_sel:[1,1,0] op_sel_hi:[1,0,1] neg_lo:[1,0,0]
    v_pk_fma_f32 v[178:179], v[180:181], v[170:171], v[186:187] op_sel:[1,1,0] op_sel_hi:[1,0,1] neg_lo:[1,0,0]
    v_cvt_pk_bf16_f32 v153, v132, -v133
    v_cvt_pk_bf16_f32 v197, v176, -v177
    ds_write2st64_b32 v238, v153, v197 offset0:46 offset1:110
    v_cvt_pk_bf16_f32 v151, v136, v137
    v_cvt_pk_bf16_f32 v195, v180, v181
    v_pk_mul_f32 v[138:139], v[132:133], v[118:119] op_sel:[0,0] op_sel_hi:[0,1]
    v_pk_mul_f32 v[182:183], v[176:177], v[162:163] op_sel:[0,0] op_sel_hi:[0,1]
    v_pk_fma_f32 v[146:147], v[132:133], v[118:119], v[138:139] op_sel:[1,1,0] op_sel_hi:[1,0,1] neg_lo:[1,0,0]
    v_pk_fma_f32 v[190:191], v[176:177], v[162:163], v[182:183] op_sel:[1,1,0] op_sel_hi:[1,0,1] neg_lo:[1,0,0]
    v_cvt_pk_bf16_f32 v152, v146, -v147
    v_cvt_pk_bf16_f32 v196, v190, -v191
    ds_write2st64_b32 v235, v151, v195 offset0:11 offset1:75
    ds_write2st64_b32 v239, v152, v196 offset0:47 offset1:111
    v_pk_mul_f32 v[144:145], v[130:131], v[128:129] op_sel:[0,0] op_sel_hi:[0,1]
    v_pk_mul_f32 v[188:189], v[174:175], v[172:173] op_sel:[0,0] op_sel_hi:[0,1]
    v_pk_mul_f32 v[142:143], v[134:135], v[126:127] op_sel:[0,0] op_sel_hi:[0,1]
    v_pk_mul_f32 v[186:187], v[178:179], v[170:171] op_sel:[0,0] op_sel_hi:[0,1]
    v_pk_fma_f32 v[132:133], v[130:131], v[128:129], v[144:145] op_sel:[1,1,0] op_sel_hi:[1,0,1] neg_lo:[1,0,0]
    v_pk_fma_f32 v[176:177], v[174:175], v[172:173], v[188:189] op_sel:[1,1,0] op_sel_hi:[1,0,1] neg_lo:[1,0,0]
    v_cvt_pk_bf16_f32 v153, v130, -v131
    v_cvt_pk_bf16_f32 v197, v174, -v175
    ds_write2st64_b32 v224, v153, v197 offset0:48 offset1:112
    v_pk_fma_f32 v[136:137], v[134:135], v[126:127], v[142:143] op_sel:[1,1,0] op_sel_hi:[1,0,1] neg_lo:[1,0,0]
    v_pk_fma_f32 v[180:181], v[178:179], v[170:171], v[186:187] op_sel:[1,1,0] op_sel_hi:[1,0,1] neg_lo:[1,0,0]
    v_pk_mul_f32 v[144:145], v[132:133], v[128:129] op_sel:[0,0] op_sel_hi:[0,1]
    v_pk_mul_f32 v[188:189], v[176:177], v[172:173] op_sel:[0,0] op_sel_hi:[0,1]
    v_pk_fma_f32 v[130:131], v[132:133], v[128:129], v[144:145] op_sel:[1,1,0] op_sel_hi:[1,0,1] neg_lo:[1,0,0]
    v_pk_fma_f32 v[174:175], v[176:177], v[172:173], v[188:189] op_sel:[1,1,0] op_sel_hi:[1,0,1] neg_lo:[1,0,0]
    v_cvt_pk_bf16_f32 v150, v134, v135
    v_cvt_pk_bf16_f32 v194, v178, v179
    v_cvt_pk_bf16_f32 v152, v132, -v133
    v_cvt_pk_bf16_f32 v196, v176, -v177
    ds_write2st64_b32 v225, v152, v196 offset0:49 offset1:113
    v_pk_mul_f32 v[144:145], v[130:131], v[128:129] op_sel:[0,0] op_sel_hi:[0,1]
    v_pk_mul_f32 v[188:189], v[174:175], v[172:173] op_sel:[0,0] op_sel_hi:[0,1]
    ds_write2st64_b32 v236, v150, v194 offset0:12 offset1:76
    v_pk_fma_f32 v[132:133], v[130:131], v[128:129], v[144:145] op_sel:[1,1,0] op_sel_hi:[1,0,1] neg_lo:[1,0,0]
    v_pk_fma_f32 v[176:177], v[174:175], v[172:173], v[188:189] op_sel:[1,1,0] op_sel_hi:[1,0,1] neg_lo:[1,0,0]
    v_cvt_pk_bf16_f32 v153, v130, -v131
    v_cvt_pk_bf16_f32 v197, v174, -v175
    ds_write2st64_b32 v226, v153, v197 offset0:50 offset1:114
    v_pk_mul_f32 v[142:143], v[136:137], v[126:127] op_sel:[0,0] op_sel_hi:[0,1]
    v_pk_mul_f32 v[186:187], v[180:181], v[170:171] op_sel:[0,0] op_sel_hi:[0,1]
    v_pk_mul_f32 v[144:145], v[132:133], v[128:129] op_sel:[0,0] op_sel_hi:[0,1]
    v_pk_mul_f32 v[188:189], v[176:177], v[172:173] op_sel:[0,0] op_sel_hi:[0,1]
    v_pk_fma_f32 v[130:131], v[132:133], v[128:129], v[144:145] op_sel:[1,1,0] op_sel_hi:[1,0,1] neg_lo:[1,0,0]
    v_pk_fma_f32 v[174:175], v[176:177], v[172:173], v[188:189] op_sel:[1,1,0] op_sel_hi:[1,0,1] neg_lo:[1,0,0]
    v_pk_fma_f32 v[134:135], v[136:137], v[126:127], v[142:143] op_sel:[1,1,0] op_sel_hi:[1,0,1] neg_lo:[1,0,0]
    v_pk_fma_f32 v[178:179], v[180:181], v[170:171], v[186:187] op_sel:[1,1,0] op_sel_hi:[1,0,1] neg_lo:[1,0,0]
    v_cvt_pk_bf16_f32 v152, v132, -v133
    v_cvt_pk_bf16_f32 v196, v176, -v177
    ds_write2st64_b32 v227, v152, v196 offset0:51 offset1:115
    v_pk_mul_f32 v[144:145], v[130:131], v[128:129] op_sel:[0,0] op_sel_hi:[0,1]
    v_pk_mul_f32 v[188:189], v[174:175], v[172:173] op_sel:[0,0] op_sel_hi:[0,1]
    v_cvt_pk_bf16_f32 v151, v136, v137
    v_cvt_pk_bf16_f32 v195, v180, v181
    v_pk_fma_f32 v[132:133], v[130:131], v[128:129], v[144:145] op_sel:[1,1,0] op_sel_hi:[1,0,1] neg_lo:[1,0,0]
    v_pk_fma_f32 v[176:177], v[174:175], v[172:173], v[188:189] op_sel:[1,1,0] op_sel_hi:[1,0,1] neg_lo:[1,0,0]
    v_cvt_pk_bf16_f32 v153, v130, -v131
    v_cvt_pk_bf16_f32 v197, v174, -v175
    ds_write2st64_b32 v237, v151, v195 offset0:13 offset1:77
    ds_write2st64_b32 v228, v153, v197 offset0:52 offset1:116
    v_pk_mul_f32 v[144:145], v[132:133], v[128:129] op_sel:[0,0] op_sel_hi:[0,1]
    v_pk_mul_f32 v[188:189], v[176:177], v[172:173] op_sel:[0,0] op_sel_hi:[0,1]
    v_pk_fma_f32 v[130:131], v[132:133], v[128:129], v[144:145] op_sel:[1,1,0] op_sel_hi:[1,0,1] neg_lo:[1,0,0]
    v_pk_fma_f32 v[174:175], v[176:177], v[172:173], v[188:189] op_sel:[1,1,0] op_sel_hi:[1,0,1] neg_lo:[1,0,0]
    v_pk_mul_f32 v[142:143], v[134:135], v[126:127] op_sel:[0,0] op_sel_hi:[0,1]
    v_pk_mul_f32 v[186:187], v[178:179], v[170:171] op_sel:[0,0] op_sel_hi:[0,1]
    v_cvt_pk_bf16_f32 v152, v132, -v133
    v_cvt_pk_bf16_f32 v196, v176, -v177
    ds_write2st64_b32 v229, v152, v196 offset0:53 offset1:117
    v_pk_fma_f32 v[136:137], v[134:135], v[126:127], v[142:143] op_sel:[1,1,0] op_sel_hi:[1,0,1] neg_lo:[1,0,0]
    v_pk_fma_f32 v[180:181], v[178:179], v[170:171], v[186:187] op_sel:[1,1,0] op_sel_hi:[1,0,1] neg_lo:[1,0,0]
    v_pk_mul_f32 v[144:145], v[130:131], v[128:129] op_sel:[0,0] op_sel_hi:[0,1]
    v_pk_mul_f32 v[188:189], v[174:175], v[172:173] op_sel:[0,0] op_sel_hi:[0,1]
    v_pk_fma_f32 v[132:133], v[130:131], v[128:129], v[144:145] op_sel:[1,1,0] op_sel_hi:[1,0,1] neg_lo:[1,0,0]
    v_pk_fma_f32 v[176:177], v[174:175], v[172:173], v[188:189] op_sel:[1,1,0] op_sel_hi:[1,0,1] neg_lo:[1,0,0]
    v_cvt_pk_bf16_f32 v153, v130, -v131
    v_cvt_pk_bf16_f32 v197, v174, -v175
    v_cvt_pk_bf16_f32 v150, v134, v135
    v_cvt_pk_bf16_f32 v194, v178, v179
    ds_write2st64_b32 v230, v153, v197 offset0:54 offset1:118
    v_pk_mul_f32 v[144:145], v[132:133], v[128:129] op_sel:[0,0] op_sel_hi:[0,1]
    v_pk_mul_f32 v[188:189], v[176:177], v[172:173] op_sel:[0,0] op_sel_hi:[0,1]
    ds_write2st64_b32 v238, v150, v194 offset0:14 offset1:78
    v_pk_fma_f32 v[130:131], v[132:133], v[128:129], v[144:145] op_sel:[1,1,0] op_sel_hi:[1,0,1] neg_lo:[1,0,0]
    v_pk_fma_f32 v[174:175], v[176:177], v[172:173], v[188:189] op_sel:[1,1,0] op_sel_hi:[1,0,1] neg_lo:[1,0,0]
    v_cvt_pk_bf16_f32 v152, v132, -v133
    v_cvt_pk_bf16_f32 v196, v176, -v177
    ds_write2st64_b32 v231, v152, v196 offset0:55 offset1:119
    v_cvt_pk_bf16_f32 v151, v136, v137
    v_cvt_pk_bf16_f32 v195, v180, v181
    v_cvt_pk_bf16_f32 v153, v130, -v131
    v_cvt_pk_bf16_f32 v197, v174, -v175
    ds_write2st64_b32 v232, v153, v197 offset0:56 offset1:120
    ds_write2st64_b32 v239, v151, v195 offset0:15 offset1:79
    ds_read_b128 v[112:115], v240 offset:0
    ds_read_b128 v[116:119], v240 offset:4096
    ds_read_b128 v[120:123], v240 offset:8192
    ds_read_b128 v[124:127], v240 offset:12288
    ds_read_b128 v[128:131], v241 offset:0
    ds_read_b128 v[132:135], v241 offset:4096
    ds_read_b128 v[136:139], v241 offset:8192
    ds_read_b128 v[140:143], v241 offset:12288
    ds_read_b128 v[144:147], v242 offset:0
    ds_read_b128 v[148:151], v242 offset:4096
    ds_read_b128 v[152:155], v242 offset:8192
    ds_read_b128 v[156:159], v242 offset:12288
    s_cmp_ge_u32 s2, 128
    s_cbranch_scc1 L_noxfs_17
    s_nop 0
    ds_read_b64 v[10:11], v82 offset:0
    ds_read_b64 v[12:13], v82 offset:8
    ds_read_b64 v[14:15], v82 offset:1088
    ds_read_b64 v[16:17], v82 offset:1096
    ds_read_b64 v[18:19], v82 offset:2176
    ds_read_b64 v[20:21], v82 offset:2184
    ds_read_b64 v[22:23], v82 offset:3264
    ds_read_b64 v[24:25], v82 offset:3272
    ds_read_b64 v[26:27], v82 offset:4352
    ds_read_b64 v[28:29], v82 offset:4360
    v_lshlrev_b32_e64 v2, 4, v1
    s_add_u32 s3, s62, 4096
    s_waitcnt lgkmcnt(8)
    buffer_store_dwordx4 v[10:13], v2, s[8:11], s62 offen offset:0 sc1
    s_waitcnt lgkmcnt(6)
    buffer_store_dwordx4 v[14:17], v2, s[8:11], s62 offen offset:1024 sc1
    s_waitcnt lgkmcnt(4)
    buffer_store_dwordx4 v[18:21], v2, s[8:11], s62 offen offset:2048 sc1
    s_waitcnt lgkmcnt(2)
    buffer_store_dwordx4 v[22:25], v2, s[8:11], s62 offen offset:3072 sc1
    s_waitcnt lgkmcnt(0)
    buffer_store_dwordx4 v[26:29], v2, s[8:11], s3 offen sc1
L_noxfs_17:
    s_waitcnt lgkmcnt(8)
    v_mfma_f32_16x16x32_bf16 v[60:63], v[116:119], v[112:115], 0
    v_mfma_f32_16x16x32_bf16 v[64:67], v[120:123], v[112:115], 0
    v_mfma_f32_16x16x32_bf16 v[68:71], v[124:127], v[112:115], 0
    ds_read_b128 v[160:163], v243 offset:0
    ds_read_b128 v[164:167], v243 offset:4096
    ds_read_b128 v[168:171], v243 offset:8192
    ds_read_b128 v[172:175], v243 offset:12288
    s_waitcnt lgkmcnt(8)
    v_mfma_f32_16x16x32_bf16 v[60:63], v[132:135], v[128:131], v[60:63]
    v_mfma_f32_16x16x32_bf16 v[64:67], v[136:139], v[128:131], v[64:67]
    v_mfma_f32_16x16x32_bf16 v[68:71], v[140:143], v[128:131], v[68:71]
    ds_read_b128 v[176:179], v240 offset:16384
    ds_read_b128 v[180:183], v240 offset:20480
    ds_read_b128 v[184:187], v240 offset:24576
    ds_read_b128 v[188:191], v240 offset:28672
    s_waitcnt lgkmcnt(8)
    v_mfma_f32_16x16x32_bf16 v[60:63], v[148:151], v[144:147], v[60:63]
    v_mfma_f32_16x16x32_bf16 v[64:67], v[152:155], v[144:147], v[64:67]
    v_mfma_f32_16x16x32_bf16 v[68:71], v[156:159], v[144:147], v[68:71]
    ds_read_b128 v[192:195], v241 offset:16384
    ds_read_b128 v[196:199], v241 offset:20480
    ds_read_b128 v[200:203], v241 offset:24576
    ds_read_b128 v[204:207], v241 offset:28672
    s_waitcnt lgkmcnt(8)
    v_mfma_f32_16x16x32_bf16 v[60:63], v[164:167], v[160:163], v[60:63]
    v_mfma_f32_16x16x32_bf16 v[64:67], v[168:171], v[160:163], v[64:67]
    v_mfma_f32_16x16x32_bf16 v[68:71], v[172:175], v[160:163], v[68:71]
    ds_read_b128 v[208:211], v242 offset:16384
    ds_read_b128 v[212:215], v242 offset:20480
    ds_read_b128 v[216:219], v242 offset:24576
    ds_read_b128 v[220:223], v242 offset:28672
    s_waitcnt lgkmcnt(8)
    v_mfma_f32_16x16x32_bf16 v[60:63], v[180:183], v[176:179], v[60:63]
    v_mfma_f32_16x16x32_bf16 v[64:67], v[184:187], v[176:179], v[64:67]
    v_mfma_f32_16x16x32_bf16 v[68:71], v[188:191], v[176:179], v[68:71]
    ds_read_b128 v[224:227], v243 offset:16384
    ds_read_b128 v[228:231], v243 offset:20480
    ds_read_b128 v[232:235], v243 offset:24576
    ds_read_b128 v[236:239], v243 offset:28672
    s_waitcnt lgkmcnt(8)
    v_mfma_f32_16x16x32_bf16 v[60:63], v[196:199], v[192:195], v[60:63]
    v_mfma_f32_16x16x32_bf16 v[64:67], v[200:203], v[192:195], v[64:67]
    v_mfma_f32_16x16x32_bf16 v[68:71], v[204:207], v[192:195], v[68:71]
    s_waitcnt lgkmcnt(4)
    v_mfma_f32_16x16x32_bf16 v[60:63], v[212:215], v[208:211], v[60:63]
    v_mfma_f32_16x16x32_bf16 v[64:67], v[216:219], v[208:211], v[64:67]
    v_mfma_f32_16x16x32_bf16 v[68:71], v[220:223], v[208:211], v[68:71]
    s_waitcnt lgkmcnt(0)
    v_mfma_f32_16x16x32_bf16 v[60:63], v[228:231], v[224:227], v[60:63]
    v_mfma_f32_16x16x32_bf16 v[64:67], v[232:235], v[224:227], v[64:67]
    v_mfma_f32_16x16x32_bf16 v[68:71], v[236:239], v[224:227], v[68:71]
    s_barrier
    s_cmp_eq_u32 s4, 0
    s_cbranch_scc0 L_w0_18
    v_lshlrev_b32_e64 v222, 7, v1
    v_add_u32 v222, 5373952, v222
    v_mov_b32_e64 v223, 16
    s_mov_b32 s96, 15
    v_writelane_b32 v223, s96, 8
    s_mov_b32 s96, 15
    v_writelane_b32 v223, s96, 9
    s_mov_b32 s96, 15
    v_writelane_b32 v223, s96, 10
    s_mov_b32 s96, 15
    v_writelane_b32 v223, s96, 11
    s_mov_b32 s96, 15
    v_writelane_b32 v223, s96, 12
    s_mov_b32 s96, 15
    v_writelane_b32 v223, s96, 13
    s_mov_b32 s96, 15
    v_writelane_b32 v223, s96, 14
    s_mov_b32 s96, 15
    v_writelane_b32 v223, s96, 15
    s_mov_b64 s[36:37], exec
    s_mov_b64 exec, 0xffff
    buffer_load_dword v253, v222, s[8:11], 0 offen sc1
    s_mov_b64 exec, s[36:37]
L_w0_18:
    v_cvt_pk_bf16_f32 v20, v60, v61
    v_cvt_pk_bf16_f32 v21, v62, v63
    v_cvt_pk_bf16_f32 v22, v64, v65
    v_cvt_pk_bf16_f32 v23, v66, v67
    v_cvt_pk_bf16_f32 v24, v68, v68
    v_cvt_pk_bf16_f32 v25, v69, v69
    v_cvt_pk_bf16_f32 v26, v70, v70
    v_cvt_pk_bf16_f32 v27, v71, v71
    ds_write_b64 v244, v[20:21]
    ds_write_b32 v245, v22
    ds_write_b32 v246, v23
    ds_write_b16 v247, v24 offset:0
    ds_write_b16 v247, v25 offset:32
    ds_write_b16 v247, v26 offset:64
    ds_write_b16 v247, v27 offset:96
    ds_read_b64 v[30:31], v250
    ds_read_b64 v[32:33], v250 offset:8
    ds_read2_b32 v[34:35], v251 offset0:0 offset1:1
    ds_read2_b32 v[36:37], v252 offset0:0 offset1:1
    ds_read2_b32 v[38:39], v252 offset0:32 offset1:33
    v_mov_b32 v44, 0
    v_mov_b32 v45, 0
    v_mov_b32 v46, 0
    v_mov_b32 v47, 0
    s_mov_b64 s[36:37], exec
    s_mov_b64 exec, 0xff
    ds_write_b128 v248, v[44:47]
    s_mov_b64 exec, s[36:37]
    s_mov_b32 s7, 0x5040302
    s_mov_b32 s6, 0x1000100
    s_mov_b32 s5, 0x3020302
    v_cmp_gt_u32 vcc, 32, v1
    s_waitcnt lgkmcnt(1)
    v_perm_b32 v76, v30, v30, v94
    v_perm_b32 v77, v31, v30, v95
    v_perm_b32 v78, v32, v31, v96
    v_perm_b32 v79, v32, v31, s7
    v_cndmask_b32_e64 v79, v79, v33, vcc
    v_perm_b32 v80, v34, v34, s6
    v_mov_b32_e64 v81, v34
    v_perm_b32 v82, v34, v34, s5
    v_perm_b32 v83, v35, v35, s6
    v_perm_b32 v84, v36, v36, v97
    v_perm_b32 v86, v37, v36, v98
    v_perm_b32 v87, v37, v36, v99
    v_mov_b32_e64 v85, v84
    v_perm_b32 v88, v38, v38, v97
    v_perm_b32 v90, v39, v38, v98
    v_perm_b32 v91, v39, v38, v99
    v_mov_b32_e64 v89, v88
    ds_write_b128 v249, v[76:79] offset:0
    ds_write_b128 v249, v[80:83] offset:1024
    ds_write_b128 v249, v[84:87] offset:2048
    ds_write_b128 v249, v[88:91] offset:3072
    v_readlane_b32 s44, v79, 63
    v_readlane_b32 s45, v78, 63
    v_readlane_b32 s46, v83, 63
    v_readlane_b32 s47, v82, 63
    v_readlane_b32 s48, v87, 63
    v_readlane_b32 s49, v86, 63
    v_mov_b32 v92, 0
    v_mov_b32 v108, 0
    v_mov_b32 v96, s44
    v_mov_b32 v109, s45
    v_mov_b32 v100, s46
    v_mov_b32 v110, s47
    v_mov_b32 v104, s48
    v_mov_b32 v111, s49
    v_mov_b32_dpp v92, v79 wave_shr:1 row_mask:0xf bank_mask:0xf
    v_mov_b32_dpp v108, v78 wave_shr:1 row_mask:0xf bank_mask:0xf
    v_mov_b32_dpp v96, v83 wave_shr:1 row_mask:0xf bank_mask:0xf
    v_mov_b32_dpp v109, v82 wave_shr:1 row_mask:0xf bank_mask:0xf
    v_mov_b32_dpp v100, v87 wave_shr:1 row_mask:0xf bank_mask:0xf
    v_mov_b32_dpp v110, v86 wave_shr:1 row_mask:0xf bank_mask:0xf
    v_mov_b32_dpp v104, v91 wave_shr:1 row_mask:0xf bank_mask:0xf
    v_mov_b32_dpp v111, v90 wave_shr:1 row_mask:0xf bank_mask:0xf
    v_mov_b32 v93, v76
    v_mov_b32 v94, v77
    v_mov_b32_e64 v95, v78
    v_alignbit_b32 v112, v76, v92, 16
    v_alignbit_b32 v113, v77, v76, 16
    v_alignbit_b32 v114, v78, v77, 16
    v_alignbit_b32 v115, v79, v78, 16
    ds_write_b128 v249, v[92:95] offset:8320
    v_alignbit_b32 v128, v92, v108, 16
    v_mov_b32 v129, v112
    v_mov_b32 v130, v113
    v_mov_b32_e64 v131, v114
    ds_write_b128 v249, v[112:115] offset:4160
    ds_write_b128 v249, v[128:131] offset:12480
    v_mov_b32 v97, v80
    v_mov_b32 v98, v81
    v_mov_b32_e64 v99, v82
    v_alignbit_b32 v116, v80, v96, 16
    v_alignbit_b32 v117, v81, v80, 16
    v_alignbit_b32 v118, v82, v81, 16
    v_alignbit_b32 v119, v83, v82, 16
    ds_write_b128 v249, v[96:99] offset:9344
    v_alignbit_b32 v132, v96, v109, 16
    v_mov_b32 v133, v116
    v_mov_b32 v134, v117
    v_mov_b32_e64 v135, v118
    ds_write_b128 v249, v[116:119] offset:5184
    ds_write_b128 v249, v[132:135] offset:13504
    v_mov_b32 v101, v84
    v_mov_b32 v102, v85
    v_mov_b32_e64 v103, v86
    v_alignbit_b32 v120, v84, v100, 16
    v_alignbit_b32 v121, v85, v84, 16
    v_alignbit_b32 v122, v86, v85, 16
    v_alignbit_b32 v123, v87, v86, 16
    ds_write_b128 v249, v[100:103] offset:10368
    v_alignbit_b32 v136, v100, v110, 16
    v_mov_b32 v137, v120
    v_mov_b32 v138, v121
    v_mov_b32_e64 v139, v122
    ds_write_b128 v249, v[120:123] offset:6208
    ds_write_b128 v249, v[136:139] offset:14528
    v_mov_b32 v105, v88
    v_mov_b32 v106, v89
    v_mov_b32_e64 v107, v90
    v_alignbit_b32 v124, v88, v104, 16
    v_alignbit_b32 v125, v89, v88, 16
    v_alignbit_b32 v126, v90, v89, 16
    v_alignbit_b32 v127, v91, v90, 16
    ds_write_b128 v249, v[104:107] offset:11392
    v_alignbit_b32 v140, v104, v111, 16
    v_mov_b32 v141, v124
    v_mov_b32 v142, v125
    v_mov_b32_e64 v143, v126
    ds_write_b128 v249, v[124:127] offset:7232
    ds_write_b128 v249, v[140:143] offset:15552
    s_waitcnt vmcnt(0)
    s_barrier
    s_cmp_ge_u32 s2, 128
    s_cbranch_scc1 L_noxfa_19
    s_and_b32 s35, s2, 7
    s_add_u32 s35, s35, 40
    s_cmp_eq_u32 s4, 0
    s_cbranch_scc0 L_w0_20
    s_lshl_b32 s96, s35, 7
    s_add_u32 s96, s96, 5373952
    v_mov_b32 v2, 1
    v_mov_b32 v3, 0
    s_mov_b64 s[36:37], exec
    s_mov_b64 exec, 1
    buffer_atomic_add v2, v3, s[8:11], s96 offen sc1
    s_mov_b64 exec, s[36:37]
L_w0_20:
L_noxfa_19:
    s_cmp_eq_u32 s4, 0
    s_cbranch_scc0 L_w0_21
    s_mov_b64 s[36:37], exec
    s_mov_b64 exec, 0xffff
    v_cmp_lt_u32 vcc, v253, v223
    s_mov_b64 exec, s[36:37]
    s_cmp_eq_u64 vcc, 0
    s_cselect_b32 s98, 1, 0
    s_cmp_eq_u32 s98, 1
    s_cbranch_scc1 L_asok_22
    s_mov_b64 s[36:37], exec
    s_mov_b64 exec, 0xffff
    s_mov_b32 s97, 0
L_poll_23:
    buffer_load_dword v253, v222, s[8:11], 0 offen sc1
    s_waitcnt vmcnt(0)
    v_cmp_lt_u32 vcc, v253, v223
    s_nop 0
    s_cbranch_vccz L_polld_24
    s_add_u32 s97, s97, 1
    s_cmp_lt_u32 s97, 262144
    s_cbranch_scc1 L_poll_23
L_polld_24:
    s_mov_b64 exec, s[36:37]
L_asok_22:
L_w0_21:
    s_barrier
    s_mov_b32 s16, s76
    s_mov_b32 s17, s77
    s_mov_b32 s18, 0x500
    s_mov_b32 s19, 0x00020000
    v_lshrrev_b32_e64 v5, 3, v0
    v_mul_u32_u24 v6, 20480, v5
    v_and_b32_e64 v7, 7, v0
    v_lshl_add_u32 v6, v7, 4, v6
    s_lshl_b32 s5, s40, 7
    v_bfe_u32 v2, v0, 1, 2
    s_lshl_b32 s6, s40, 4
    s_add_u32 s6, s6, 5242880
    v_lshlrev_b32_e64 v3, 2, v2
    buffer_load_dword v10, v3, s[8:11], s6 offen sc1
    buffer_load_dword v11, v3, s[8:11], s6 offen offset:2560 sc1
    s_add_u32 s7, s6, 15360
    buffer_load_dword v14, v3, s[8:11], s7 offen sc1
    buffer_load_dword v15, v3, s[8:11], s7 offen offset:2560 sc1
    s_lshl_b32 s3, s4, 2
    v_mov_b32 v4, s3
    s_add_u32 s6, s6, 5120
    s_add_u32 s7, s7, 5120
    buffer_load_dword v12, v4, s[8:11], s6 offen sc1
    buffer_load_dword v16, v4, s[8:11], s7 offen sc1
    s_lshl_b32 s7, s41, 1
    v_mov_b32 v4, 0
    buffer_load_ushort v13, v4, s[16:19], s7 offen
    buffer_load_dwordx4 v[20:23], v6, s[8:11], s5 offen sc1
    s_add_u32 s5, s5, 655360
    buffer_load_dwordx4 v[24:27], v6, s[8:11], s5 offen sc1
    s_add_u32 s5, s5, 655360
    buffer_load_dwordx4 v[28:31], v6, s[8:11], s5 offen sc1
    s_add_u32 s5, s5, 655360
    buffer_load_dwordx4 v[32:35], v6, s[8:11], s5 offen sc1
    s_getpc_b64 s[98:99]
L_pcx1:
    s_sub_u32 s98, s98, (L_pcx1-adaLN_cond__ssm_conv_s4d__glu_gated_geglu__prompt_kernel)
    s_subb_u32 s99, s99, 0
    s_add_u32 s28, s98, (L_convep-adaLN_cond__ssm_conv_s4d__glu_gated_geglu__prompt_kernel)
    s_addc_u32 s29, s99, 0
    s_mov_b32 s30, (L_codeend-L_convep)
    s_mov_b32 s31, 0x00020000
    v_lshlrev_b32 v224, 7, v0
    buffer_load_dword v225, v224, s[28:31], 0 offen
    v_mul_u32_u24 v8, 21216, v2
    v_lshl_add_u32 v8, v5, 5, v8
    v_and_b32_e64 v9, 1, v0
    v_lshl_add_u32 v8, v9, 4, v8
    v_add_u32 v8, 17120, v8
    v_mov_b32 v40, 0
    v_mov_b32 v41, 0
    v_mov_b32 v42, 0
    v_mov_b32 v43, 0
    v_lshlrev_b32_e64 v9, 4, v1
    v_add_u32 v9, s42, v9
    s_mov_b64 s[36:37], exec
    s_mov_b64 exec, 0x3fffffff
    ds_write_b128 v9, v[40:43] offset:16640
    s_mov_b64 exec, s[36:37]
    v_lshrrev_b32 v6, 4, v1
    v_bfe_u32 v7, v1, 2, 2
    v_and_b32_e64 v9, 3, v1
    v_mul_u32_u24 v4, 4160, v7
    v_lshl_add_u32 v4, v9, 3, v4
    v_lshlrev_b32 v7, 4, v6
    v_sub_u32 v4, v4, v7
    s_add_u32 s5, s42, 56
    v_add_u32 v4, s5, v4
    v_and_b32 v9, 15, v1
    v_lshlrev_b32 v5, 5, v9
    v_add_u32_e64 v5, v5, v7
    s_add_u32 s5, s42, 17088
    v_add_u32 v5, s5, v5
    v_mov_b32 v160, 0
    v_mov_b32 v161, 0
    v_mov_b32 v162, 0
    v_mov_b32 v163, 0
    v_mov_b32 v164, 0
    v_mov_b32 v165, 0
    v_mov_b32 v166, 0
    v_mov_b32 v167, 0
    v_mov_b32 v168, 0
    v_mov_b32 v169, 0
    v_mov_b32 v170, 0
    v_mov_b32 v171, 0
    v_mov_b32 v172, 0
    v_mov_b32 v173, 0
    v_mov_b32 v174, 0
    v_mov_b32 v175, 0
    v_mov_b32 v176, 0
    v_mov_b32 v177, 0
    v_mov_b32 v178, 0
    v_mov_b32 v179, 0
    v_mov_b32 v180, 0
    v_mov_b32 v181, 0
    v_mov_b32 v182, 0
    v_mov_b32 v183, 0
    v_mov_b32 v184, 0
    v_mov_b32 v185, 0
    v_mov_b32 v186, 0
    v_mov_b32 v187, 0
    v_mov_b32 v188, 0
    v_mov_b32 v189, 0
    v_mov_b32 v190, 0
    v_mov_b32 v191, 0
    s_waitcnt vmcnt(5)
    v_add_f32_e64 v10, v10, v14
    v_cvt_pk_bf16_f32 v10, v10, v10
    v_lshlrev_b32 v10, 16, v10
    v_add_f32 v11, v11, v15
    v_cvt_pk_bf16_f32 v11, v11, v11
    v_lshlrev_b32 v11, 16, v11
    v_add_f32 v11, 1.0, v11
    v_cvt_pk_bf16_f32 v11, v11, v11
    v_lshlrev_b32 v11, 16, v11
    v_add_f32 v12, v12, v16
    v_cvt_pk_bf16_f32 v12, v12, v12
    v_lshlrev_b32 v12, 16, v12
    v_lshlrev_b32 v13, 16, v13
    s_waitcnt vmcnt(4)
    v_lshlrev_b32 v44, 16, v20
    v_and_b32 v45, 0xffff0000, v20
    v_lshlrev_b32_e64 v46, 16, v21
    v_and_b32 v47, 0xffff0000, v21
    v_lshlrev_b32_e64 v48, 16, v22
    v_and_b32 v49, 0xffff0000, v22
    v_lshlrev_b32_e64 v50, 16, v23
    v_and_b32 v51, 0xffff0000, v23
    v_pk_fma_f32 v[44:45], v[44:45], v[10:11], v[10:11] op_sel:[0,1,0] op_sel_hi:[1,1,0]
    v_pk_fma_f32 v[46:47], v[46:47], v[10:11], v[10:11] op_sel:[0,1,0] op_sel_hi:[1,1,0]
    v_pk_fma_f32 v[48:49], v[48:49], v[10:11], v[10:11] op_sel:[0,1,0] op_sel_hi:[1,1,0]
    v_pk_fma_f32 v[50:51], v[50:51], v[10:11], v[10:11] op_sel:[0,1,0] op_sel_hi:[1,1,0]
    v_cvt_pk_bf16_f32 v20, v44, v45
    v_cvt_pk_bf16_f32 v21, v46, v47
    v_cvt_pk_bf16_f32 v22, v48, v49
    v_cvt_pk_bf16_f32 v23, v50, v51
    ds_write_b128 v8, v[20:23] offset:0
    s_waitcnt vmcnt(3)
    v_lshlrev_b32 v44, 16, v24
    v_and_b32 v45, 0xffff0000, v24
    v_lshlrev_b32_e64 v46, 16, v25
    v_and_b32 v47, 0xffff0000, v25
    v_lshlrev_b32_e64 v48, 16, v26
    v_and_b32 v49, 0xffff0000, v26
    v_lshlrev_b32_e64 v50, 16, v27
    v_and_b32 v51, 0xffff0000, v27
    v_pk_fma_f32 v[44:45], v[44:45], v[10:11], v[10:11] op_sel:[0,1,0] op_sel_hi:[1,1,0]
    v_pk_fma_f32 v[46:47], v[46:47], v[10:11], v[10:11] op_sel:[0,1,0] op_sel_hi:[1,1,0]
    v_pk_fma_f32 v[48:49], v[48:49], v[10:11], v[10:11] op_sel:[0,1,0] op_sel_hi:[1,1,0]
    v_pk_fma_f32 v[50:51], v[50:51], v[10:11], v[10:11] op_sel:[0,1,0] op_sel_hi:[1,1,0]
    v_cvt_pk_bf16_f32 v24, v44, v45
    v_cvt_pk_bf16_f32 v25, v46, v47
    v_cvt_pk_bf16_f32 v26, v48, v49
    v_cvt_pk_bf16_f32 v27, v50, v51
    ds_write_b128 v8, v[24:27] offset:1024
    s_waitcnt vmcnt(2)
    v_lshlrev_b32 v44, 16, v28
    v_and_b32 v45, 0xffff0000, v28
    v_lshlrev_b32_e64 v46, 16, v29
    v_and_b32 v47, 0xffff0000, v29
    v_lshlrev_b32_e64 v48, 16, v30
    v_and_b32 v49, 0xffff0000, v30
    v_lshlrev_b32_e64 v50, 16, v31
    v_and_b32 v51, 0xffff0000, v31
    v_pk_fma_f32 v[44:45], v[44:45], v[10:11], v[10:11] op_sel:[0,1,0] op_sel_hi:[1,1,0]
    v_pk_fma_f32 v[46:47], v[46:47], v[10:11], v[10:11] op_sel:[0,1,0] op_sel_hi:[1,1,0]
    v_pk_fma_f32 v[48:49], v[48:49], v[10:11], v[10:11] op_sel:[0,1,0] op_sel_hi:[1,1,0]
    v_pk_fma_f32 v[50:51], v[50:51], v[10:11], v[10:11] op_sel:[0,1,0] op_sel_hi:[1,1,0]
    v_cvt_pk_bf16_f32 v28, v44, v45
    v_cvt_pk_bf16_f32 v29, v46, v47
    v_cvt_pk_bf16_f32 v30, v48, v49
    v_cvt_pk_bf16_f32 v31, v50, v51
    ds_write_b128 v8, v[28:31] offset:2048
    s_waitcnt vmcnt(1)
    v_lshlrev_b32 v44, 16, v32
    v_and_b32 v45, 0xffff0000, v32
    v_lshlrev_b32_e64 v46, 16, v33
    v_and_b32 v47, 0xffff0000, v33
    v_lshlrev_b32_e64 v48, 16, v34
    v_and_b32 v49, 0xffff0000, v34
    v_lshlrev_b32_e64 v50, 16, v35
    v_and_b32 v51, 0xffff0000, v35
    v_pk_fma_f32 v[44:45], v[44:45], v[10:11], v[10:11] op_sel:[0,1,0] op_sel_hi:[1,1,0]
    v_pk_fma_f32 v[46:47], v[46:47], v[10:11], v[10:11] op_sel:[0,1,0] op_sel_hi:[1,1,0]
    v_pk_fma_f32 v[48:49], v[48:49], v[10:11], v[10:11] op_sel:[0,1,0] op_sel_hi:[1,1,0]
    v_pk_fma_f32 v[50:51], v[50:51], v[10:11], v[10:11] op_sel:[0,1,0] op_sel_hi:[1,1,0]
    v_cvt_pk_bf16_f32 v32, v44, v45
    v_cvt_pk_bf16_f32 v33, v46, v47
    v_cvt_pk_bf16_f32 v34, v48, v49
    v_cvt_pk_bf16_f32 v35, v50, v51
    ds_write_b128 v8, v[32:35] offset:3072
    s_waitcnt lgkmcnt(0)
    s_barrier
    ds_read_b64_tr_b16 v[20:21], v4 offset:8
    ds_read_b64_tr_b16 v[22:23], v4 offset:0
    ds_read_b128 v[52:55], v5 offset:0
    ds_read_b64_tr_b16 v[24:25], v4 offset:520
    ds_read_b64_tr_b16 v[26:27], v4 offset:512
    ds_read_b128 v[56:59], v5 offset:512
    ds_read_b64_tr_b16 v[28:29], v4 offset:1032
    ds_read_b64_tr_b16 v[30:31], v4 offset:1024
    ds_read_b128 v[60:63], v5 offset:1024
    ds_read_b64_tr_b16 v[32:33], v4 offset:1544
    ds_read_b64_tr_b16 v[34:35], v4 offset:1536
    ds_read_b128 v[64:67], v5 offset:1536
    ds_read_b64_tr_b16 v[36:37], v4 offset:2056
    ds_read_b64_tr_b16 v[38:39], v4 offset:2048
    ds_read_b128 v[68:71], v5 offset:2048
    ds_read_b64_tr_b16 v[40:41], v4 offset:2568
    ds_read_b64_tr_b16 v[42:43], v4 offset:2560
    ds_read_b128 v[72:75], v5 offset:2560
    ds_read_b64_tr_b16 v[44:45], v4 offset:3080
    ds_read_b64_tr_b16 v[46:47], v4 offset:3072
    ds_read_b128 v[76:79], v5 offset:3072
    ds_read_b64_tr_b16 v[48:49], v4 offset:3592
    ds_read_b64_tr_b16 v[50:51], v4 offset:3584
    ds_read_b128 v[80:83], v5 offset:3584
    s_and_b32 s5, s2, 7
    s_lshr_b32 s6, s2, 3
    s_and_b32 s44, s5, 1
    s_lshl_b32 s44, s44, 3
    s_and_b32 s7, s6, 7
    s_add_u32 s44, s44, s7
    s_lshr_b32 s54, s5, 1
    s_lshl_b32 s54, s54, 3
    s_add_u32 s54, s54, s7
    s_and_b32 s55, s5, 1
    s_lshl_b32 s55, s55, 2
    s_lshr_b32 s5, s5, 1
    s_lshr_b32 s6, s6, 3
    s_add_u32 s55, s55, s6
    s_mul_i32 s46, s5, 27
    s_mul_i32 s7, s6, 7
    s_add_u32 s46, s46, s7
    s_cmp_eq_u32 s6, 3
    s_cselect_b32 s47, 6, 7
    s_lshl_b32 s48, s44, 2
    s_add_u32 s48, s48, s4
    v_lshlrev_b32 v219, 4, v1
    v_lshrrev_b32_e64 v220, 4, v0
    v_mul_u32_u24 v220, 40960, v220
    v_and_b32_e64 v223, 15, v1
    v_lshl_add_u32 v220, v223, 3, v220
    v_add_u32 v221, 20480, v220
    v_lshlrev_b32_e64 v216, 7, v1
    v_add_u32 v216, 5379072, v216
    v_mov_b32 v217, 16
    v_lshlrev_b32 v226, 7, v1
    v_add_u32 v226, 5377024, v226
    v_mov_b32 v227, 5
    s_mov_b32 s96, 7
    v_writelane_b32 v227, s96, 0
    s_mov_b32 s96, 7
    v_writelane_b32 v227, s96, 1
    s_mov_b32 s96, 7
    v_writelane_b32 v227, s96, 2
    s_mov_b32 s96, 7
    v_writelane_b32 v227, s96, 3
    s_mov_b32 s96, 7
    v_writelane_b32 v227, s96, 4
    s_mov_b32 s96, 7
    v_writelane_b32 v227, s96, 5
    s_mov_b32 s96, 6
    v_writelane_b32 v227, s96, 6
    s_mov_b32 s96, 6
    v_writelane_b32 v227, s96, 7
    v_add_u32 v4, 64, v4
    v_subrev_u32 v5, 64, v5
    s_waitcnt lgkmcnt(0)
    v_mfma_f32_16x16x32_bf16 v[188:191], v[20:23], v[80:83], v[188:191]
    ds_read_b64_tr_b16 v[84:85], v4 offset:8
    v_mfma_f32_16x16x32_bf16 v[184:187], v[20:23], v[76:79], v[184:187]
    ds_read_b64_tr_b16 v[86:87], v4 offset:0
    v_mfma_f32_16x16x32_bf16 v[180:183], v[20:23], v[72:75], v[180:183]
    ds_read_b128 v[116:119], v5 offset:0
    v_mfma_f32_16x16x32_bf16 v[188:191], v[24:27], v[76:79], v[188:191]
    ds_read_b64_tr_b16 v[88:89], v4 offset:520
    v_mfma_f32_16x16x32_bf16 v[184:187], v[24:27], v[72:75], v[184:187]
    ds_read_b64_tr_b16 v[90:91], v4 offset:512
    v_mfma_f32_16x16x32_bf16 v[176:179], v[20:23], v[68:71], v[176:179]
    ds_read_b128 v[120:123], v5 offset:512
    v_mfma_f32_16x16x32_bf16 v[188:191], v[28:31], v[72:75], v[188:191]
    ds_read_b64_tr_b16 v[92:93], v4 offset:1032
    v_mfma_f32_16x16x32_bf16 v[180:183], v[24:27], v[68:71], v[180:183]
    ds_read_b64_tr_b16 v[94:95], v4 offset:1024
    v_mfma_f32_16x16x32_bf16 v[184:187], v[28:31], v[68:71], v[184:187]
    ds_read_b128 v[124:127], v5 offset:1024
    v_mfma_f32_16x16x32_bf16 v[188:191], v[32:35], v[68:71], v[188:191]
    ds_read_b64_tr_b16 v[96:97], v4 offset:1544
    v_mfma_f32_16x16x32_bf16 v[172:175], v[20:23], v[64:67], v[172:175]
    ds_read_b64_tr_b16 v[98:99], v4 offset:1536
    v_mfma_f32_16x16x32_bf16 v[176:179], v[24:27], v[64:67], v[176:179]
    ds_read_b128 v[128:131], v5 offset:1536
    v_mfma_f32_16x16x32_bf16 v[180:183], v[28:31], v[64:67], v[180:183]
    ds_read_b64_tr_b16 v[100:101], v4 offset:2056
    v_mfma_f32_16x16x32_bf16 v[184:187], v[32:35], v[64:67], v[184:187]
    ds_read_b64_tr_b16 v[102:103], v4 offset:2048
    v_mfma_f32_16x16x32_bf16 v[188:191], v[36:39], v[64:67], v[188:191]
    ds_read_b128 v[132:135], v5 offset:2048
    v_mfma_f32_16x16x32_bf16 v[168:171], v[20:23], v[60:63], v[168:171]
    ds_read_b64_tr_b16 v[104:105], v4 offset:2568
    v_mfma_f32_16x16x32_bf16 v[172:175], v[24:27], v[60:63], v[172:175]
    ds_read_b64_tr_b16 v[106:107], v4 offset:2560
    v_mfma_f32_16x16x32_bf16 v[176:179], v[28:31], v[60:63], v[176:179]
    ds_read_b128 v[136:139], v5 offset:2560
    v_mfma_f32_16x16x32_bf16 v[180:183], v[32:35], v[60:63], v[180:183]
    ds_read_b64_tr_b16 v[108:109], v4 offset:3080
    v_mfma_f32_16x16x32_bf16 v[184:187], v[36:39], v[60:63], v[184:187]
    ds_read_b64_tr_b16 v[110:111], v4 offset:3072
    v_mfma_f32_16x16x32_bf16 v[188:191], v[40:43], v[60:63], v[188:191]
    ds_read_b128 v[140:143], v5 offset:3072
    v_mfma_f32_16x16x32_bf16 v[164:167], v[20:23], v[56:59], v[164:167]
    ds_read_b64_tr_b16 v[112:113], v4 offset:3592
    v_mfma_f32_16x16x32_bf16 v[168:171], v[24:27], v[56:59], v[168:171]
    ds_read_b64_tr_b16 v[114:115], v4 offset:3584
    v_mfma_f32_16x16x32_bf16 v[172:175], v[28:31], v[56:59], v[172:175]
    ds_read_b128 v[144:147], v5 offset:3584
    v_mfma_f32_16x16x32_bf16 v[176:179], v[32:35], v[56:59], v[176:179]
    v_mfma_f32_16x16x32_bf16 v[180:183], v[36:39], v[56:59], v[180:183]
    v_mfma_f32_16x16x32_bf16 v[184:187], v[40:43], v[56:59], v[184:187]
    v_mfma_f32_16x16x32_bf16 v[188:191], v[44:47], v[56:59], v[188:191]
    v_mfma_f32_16x16x32_bf16 v[160:163], v[20:23], v[52:55], v[160:163]
    v_mfma_f32_16x16x32_bf16 v[164:167], v[24:27], v[52:55], v[164:167]
    v_mfma_f32_16x16x32_bf16 v[168:171], v[28:31], v[52:55], v[168:171]
    v_mfma_f32_16x16x32_bf16 v[172:175], v[32:35], v[52:55], v[172:175]
    v_mfma_f32_16x16x32_bf16 v[176:179], v[36:39], v[52:55], v[176:179]
    v_mfma_f32_16x16x32_bf16 v[180:183], v[40:43], v[52:55], v[180:183]
    v_mfma_f32_16x16x32_bf16 v[184:187], v[44:47], v[52:55], v[184:187]
    v_mfma_f32_16x16x32_bf16 v[188:191], v[48:51], v[52:55], v[188:191]
    v_add_u32_e64 v4, 64, v4
    v_subrev_u32 v5, 64, v5
    s_waitcnt lgkmcnt(0)
    v_mfma_f32_16x16x32_bf16 v[188:191], v[84:87], v[144:147], v[188:191]
    ds_read_b64_tr_b16 v[20:21], v4 offset:8
    v_mfma_f32_16x16x32_bf16 v[184:187], v[84:87], v[140:143], v[184:187]
    ds_read_b64_tr_b16 v[22:23], v4 offset:0
    v_mfma_f32_16x16x32_bf16 v[180:183], v[84:87], v[136:139], v[180:183]
    ds_read_b128 v[52:55], v5 offset:0
    v_mfma_f32_16x16x32_bf16 v[188:191], v[88:91], v[140:143], v[188:191]
    ds_read_b64_tr_b16 v[24:25], v4 offset:520
    v_mfma_f32_16x16x32_bf16 v[184:187], v[88:91], v[136:139], v[184:187]
    ds_read_b64_tr_b16 v[26:27], v4 offset:512
    v_mfma_f32_16x16x32_bf16 v[176:179], v[84:87], v[132:135], v[176:179]
    ds_read_b128 v[56:59], v5 offset:512
    v_mfma_f32_16x16x32_bf16 v[188:191], v[92:95], v[136:139], v[188:191]
    ds_read_b64_tr_b16 v[28:29], v4 offset:1032
    v_mfma_f32_16x16x32_bf16 v[180:183], v[88:91], v[132:135], v[180:183]
    ds_read_b64_tr_b16 v[30:31], v4 offset:1024
    v_mfma_f32_16x16x32_bf16 v[184:187], v[92:95], v[132:135], v[184:187]
    ds_read_b128 v[60:63], v5 offset:1024
    v_mfma_f32_16x16x32_bf16 v[188:191], v[96:99], v[132:135], v[188:191]
    ds_read_b64_tr_b16 v[32:33], v4 offset:1544
    v_mfma_f32_16x16x32_bf16 v[172:175], v[84:87], v[128:131], v[172:175]
    ds_read_b64_tr_b16 v[34:35], v4 offset:1536
    v_mfma_f32_16x16x32_bf16 v[176:179], v[88:91], v[128:131], v[176:179]
    ds_read_b128 v[64:67], v5 offset:1536
    v_mfma_f32_16x16x32_bf16 v[180:183], v[92:95], v[128:131], v[180:183]
    ds_read_b64_tr_b16 v[36:37], v4 offset:2056
    v_mfma_f32_16x16x32_bf16 v[184:187], v[96:99], v[128:131], v[184:187]
    ds_read_b64_tr_b16 v[38:39], v4 offset:2048
    v_mfma_f32_16x16x32_bf16 v[188:191], v[100:103], v[128:131], v[188:191]
    ds_read_b128 v[68:71], v5 offset:2048
    v_mfma_f32_16x16x32_bf16 v[168:171], v[84:87], v[124:127], v[168:171]
    ds_read_b64_tr_b16 v[40:41], v4 offset:2568
    v_mfma_f32_16x16x32_bf16 v[172:175], v[88:91], v[124:127], v[172:175]
    ds_read_b64_tr_b16 v[42:43], v4 offset:2560
    v_mfma_f32_16x16x32_bf16 v[176:179], v[92:95], v[124:127], v[176:179]
    ds_read_b128 v[72:75], v5 offset:2560
    v_mfma_f32_16x16x32_bf16 v[180:183], v[96:99], v[124:127], v[180:183]
    ds_read_b64_tr_b16 v[44:45], v4 offset:3080
    v_mfma_f32_16x16x32_bf16 v[184:187], v[100:103], v[124:127], v[184:187]
    ds_read_b64_tr_b16 v[46:47], v4 offset:3072
    v_mfma_f32_16x16x32_bf16 v[188:191], v[104:107], v[124:127], v[188:191]
    ds_read_b128 v[76:79], v5 offset:3072
    v_mfma_f32_16x16x32_bf16 v[164:167], v[84:87], v[120:123], v[164:167]
    ds_read_b64_tr_b16 v[48:49], v4 offset:3592
    v_mfma_f32_16x16x32_bf16 v[168:171], v[88:91], v[120:123], v[168:171]
    ds_read_b64_tr_b16 v[50:51], v4 offset:3584
    v_mfma_f32_16x16x32_bf16 v[172:175], v[92:95], v[120:123], v[172:175]
    ds_read_b128 v[80:83], v5 offset:3584
    v_mfma_f32_16x16x32_bf16 v[176:179], v[96:99], v[120:123], v[176:179]
    v_mfma_f32_16x16x32_bf16 v[180:183], v[100:103], v[120:123], v[180:183]
    v_mfma_f32_16x16x32_bf16 v[184:187], v[104:107], v[120:123], v[184:187]
    v_mfma_f32_16x16x32_bf16 v[188:191], v[108:111], v[120:123], v[188:191]
    v_mfma_f32_16x16x32_bf16 v[160:163], v[84:87], v[116:119], v[160:163]
    v_mfma_f32_16x16x32_bf16 v[164:167], v[88:91], v[116:119], v[164:167]
    v_mfma_f32_16x16x32_bf16 v[168:171], v[92:95], v[116:119], v[168:171]
    v_mfma_f32_16x16x32_bf16 v[172:175], v[96:99], v[116:119], v[172:175]
    v_mfma_f32_16x16x32_bf16 v[176:179], v[100:103], v[116:119], v[176:179]
    v_mfma_f32_16x16x32_bf16 v[180:183], v[104:107], v[116:119], v[180:183]
    v_mfma_f32_16x16x32_bf16 v[184:187], v[108:111], v[116:119], v[184:187]
    v_mfma_f32_16x16x32_bf16 v[188:191], v[112:115], v[116:119], v[188:191]
    v_add_u32_e64 v4, 64, v4
    v_subrev_u32 v5, 64, v5
    s_waitcnt lgkmcnt(0)
    v_mfma_f32_16x16x32_bf16 v[188:191], v[20:23], v[80:83], v[188:191]
    ds_read_b64_tr_b16 v[84:85], v4 offset:8
    v_mfma_f32_16x16x32_bf16 v[184:187], v[20:23], v[76:79], v[184:187]
    ds_read_b64_tr_b16 v[86:87], v4 offset:0
    v_mfma_f32_16x16x32_bf16 v[180:183], v[20:23], v[72:75], v[180:183]
    ds_read_b128 v[116:119], v5 offset:0
    v_mfma_f32_16x16x32_bf16 v[188:191], v[24:27], v[76:79], v[188:191]
    ds_read_b64_tr_b16 v[88:89], v4 offset:520
    v_mfma_f32_16x16x32_bf16 v[184:187], v[24:27], v[72:75], v[184:187]
    ds_read_b64_tr_b16 v[90:91], v4 offset:512
    v_mfma_f32_16x16x32_bf16 v[176:179], v[20:23], v[68:71], v[176:179]
    ds_read_b128 v[120:123], v5 offset:512
    v_mfma_f32_16x16x32_bf16 v[188:191], v[28:31], v[72:75], v[188:191]
    ds_read_b64_tr_b16 v[92:93], v4 offset:1032
    v_mfma_f32_16x16x32_bf16 v[180:183], v[24:27], v[68:71], v[180:183]
    ds_read_b64_tr_b16 v[94:95], v4 offset:1024
    v_mfma_f32_16x16x32_bf16 v[184:187], v[28:31], v[68:71], v[184:187]
    ds_read_b128 v[124:127], v5 offset:1024
    v_mfma_f32_16x16x32_bf16 v[188:191], v[32:35], v[68:71], v[188:191]
    ds_read_b64_tr_b16 v[96:97], v4 offset:1544
    v_mfma_f32_16x16x32_bf16 v[172:175], v[20:23], v[64:67], v[172:175]
    ds_read_b64_tr_b16 v[98:99], v4 offset:1536
    v_mfma_f32_16x16x32_bf16 v[176:179], v[24:27], v[64:67], v[176:179]
    ds_read_b128 v[128:131], v5 offset:1536
    v_mfma_f32_16x16x32_bf16 v[180:183], v[28:31], v[64:67], v[180:183]
    ds_read_b64_tr_b16 v[100:101], v4 offset:2056
    v_mfma_f32_16x16x32_bf16 v[184:187], v[32:35], v[64:67], v[184:187]
    ds_read_b64_tr_b16 v[102:103], v4 offset:2048
    v_mfma_f32_16x16x32_bf16 v[188:191], v[36:39], v[64:67], v[188:191]
    ds_read_b128 v[132:135], v5 offset:2048
    v_mfma_f32_16x16x32_bf16 v[168:171], v[20:23], v[60:63], v[168:171]
    ds_read_b64_tr_b16 v[104:105], v4 offset:2568
    v_mfma_f32_16x16x32_bf16 v[172:175], v[24:27], v[60:63], v[172:175]
    ds_read_b64_tr_b16 v[106:107], v4 offset:2560
    v_mfma_f32_16x16x32_bf16 v[176:179], v[28:31], v[60:63], v[176:179]
    ds_read_b128 v[136:139], v5 offset:2560
    v_mfma_f32_16x16x32_bf16 v[180:183], v[32:35], v[60:63], v[180:183]
    ds_read_b64_tr_b16 v[108:109], v4 offset:3080
    v_mfma_f32_16x16x32_bf16 v[184:187], v[36:39], v[60:63], v[184:187]
    ds_read_b64_tr_b16 v[110:111], v4 offset:3072
    v_mfma_f32_16x16x32_bf16 v[188:191], v[40:43], v[60:63], v[188:191]
    ds_read_b128 v[140:143], v5 offset:3072
    v_mfma_f32_16x16x32_bf16 v[164:167], v[20:23], v[56:59], v[164:167]
    ds_read_b64_tr_b16 v[112:113], v4 offset:3592
    v_mfma_f32_16x16x32_bf16 v[168:171], v[24:27], v[56:59], v[168:171]
    ds_read_b64_tr_b16 v[114:115], v4 offset:3584
    v_mfma_f32_16x16x32_bf16 v[172:175], v[28:31], v[56:59], v[172:175]
    ds_read_b128 v[144:147], v5 offset:3584
    v_mfma_f32_16x16x32_bf16 v[176:179], v[32:35], v[56:59], v[176:179]
    v_mfma_f32_16x16x32_bf16 v[180:183], v[36:39], v[56:59], v[180:183]
    v_mfma_f32_16x16x32_bf16 v[184:187], v[40:43], v[56:59], v[184:187]
    v_mfma_f32_16x16x32_bf16 v[188:191], v[44:47], v[56:59], v[188:191]
    v_mfma_f32_16x16x32_bf16 v[160:163], v[20:23], v[52:55], v[160:163]
    v_mfma_f32_16x16x32_bf16 v[164:167], v[24:27], v[52:55], v[164:167]
    v_mfma_f32_16x16x32_bf16 v[168:171], v[28:31], v[52:55], v[168:171]
    v_mfma_f32_16x16x32_bf16 v[172:175], v[32:35], v[52:55], v[172:175]
    v_mfma_f32_16x16x32_bf16 v[176:179], v[36:39], v[52:55], v[176:179]
    v_mfma_f32_16x16x32_bf16 v[180:183], v[40:43], v[52:55], v[180:183]
    v_mfma_f32_16x16x32_bf16 v[184:187], v[44:47], v[52:55], v[184:187]
    v_mfma_f32_16x16x32_bf16 v[188:191], v[48:51], v[52:55], v[188:191]
    v_add_u32_e64 v4, 64, v4
    v_subrev_u32 v5, 64, v5
    s_mov_b64 s[36:37], exec
    s_mov_b64 exec, 0xff
    buffer_load_dword v218, v216, s[8:11], 0 offen sc1
    s_mov_b64 exec, s[36:37]
    s_waitcnt lgkmcnt(0)
    v_mfma_f32_16x16x32_bf16 v[188:191], v[84:87], v[144:147], v[188:191]
    ds_read_b64_tr_b16 v[20:21], v4 offset:8
    v_mfma_f32_16x16x32_bf16 v[184:187], v[84:87], v[140:143], v[184:187]
    ds_read_b64_tr_b16 v[22:23], v4 offset:0
    v_mfma_f32_16x16x32_bf16 v[180:183], v[84:87], v[136:139], v[180:183]
    ds_read_b128 v[52:55], v5 offset:0
    v_mfma_f32_16x16x32_bf16 v[188:191], v[88:91], v[140:143], v[188:191]
    ds_read_b64_tr_b16 v[24:25], v4 offset:520
    v_mfma_f32_16x16x32_bf16 v[184:187], v[88:91], v[136:139], v[184:187]
    ds_read_b64_tr_b16 v[26:27], v4 offset:512
    v_mfma_f32_16x16x32_bf16 v[176:179], v[84:87], v[132:135], v[176:179]
    ds_read_b128 v[56:59], v5 offset:512
    v_mfma_f32_16x16x32_bf16 v[188:191], v[92:95], v[136:139], v[188:191]
    ds_read_b64_tr_b16 v[28:29], v4 offset:1032
    v_mfma_f32_16x16x32_bf16 v[180:183], v[88:91], v[132:135], v[180:183]
    ds_read_b64_tr_b16 v[30:31], v4 offset:1024
    v_mfma_f32_16x16x32_bf16 v[184:187], v[92:95], v[132:135], v[184:187]
    ds_read_b128 v[60:63], v5 offset:1024
    v_mfma_f32_16x16x32_bf16 v[188:191], v[96:99], v[132:135], v[188:191]
    ds_read_b64_tr_b16 v[32:33], v4 offset:1544
    v_mfma_f32_16x16x32_bf16 v[172:175], v[84:87], v[128:131], v[172:175]
    ds_read_b64_tr_b16 v[34:35], v4 offset:1536
    v_mfma_f32_16x16x32_bf16 v[176:179], v[88:91], v[128:131], v[176:179]
    ds_read_b128 v[64:67], v5 offset:1536
    v_mfma_f32_16x16x32_bf16 v[180:183], v[92:95], v[128:131], v[180:183]
    ds_read_b64_tr_b16 v[36:37], v4 offset:2056
    v_mfma_f32_16x16x32_bf16 v[184:187], v[96:99], v[128:131], v[184:187]
    ds_read_b64_tr_b16 v[38:39], v4 offset:2048
    v_mfma_f32_16x16x32_bf16 v[188:191], v[100:103], v[128:131], v[188:191]
    ds_read_b128 v[68:71], v5 offset:2048
    v_mfma_f32_16x16x32_bf16 v[168:171], v[84:87], v[124:127], v[168:171]
    ds_read_b64_tr_b16 v[40:41], v4 offset:2568
    v_mfma_f32_16x16x32_bf16 v[172:175], v[88:91], v[124:127], v[172:175]
    ds_read_b64_tr_b16 v[42:43], v4 offset:2560
    v_mfma_f32_16x16x32_bf16 v[176:179], v[92:95], v[124:127], v[176:179]
    ds_read_b128 v[72:75], v5 offset:2560
    v_mfma_f32_16x16x32_bf16 v[180:183], v[96:99], v[124:127], v[180:183]
    ds_read_b64_tr_b16 v[44:45], v4 offset:3080
    v_mfma_f32_16x16x32_bf16 v[184:187], v[100:103], v[124:127], v[184:187]
    ds_read_b64_tr_b16 v[46:47], v4 offset:3072
    v_mfma_f32_16x16x32_bf16 v[188:191], v[104:107], v[124:127], v[188:191]
    ds_read_b128 v[76:79], v5 offset:3072
    v_mfma_f32_16x16x32_bf16 v[164:167], v[84:87], v[120:123], v[164:167]
    ds_read_b64_tr_b16 v[48:49], v4 offset:3592
    v_mfma_f32_16x16x32_bf16 v[168:171], v[88:91], v[120:123], v[168:171]
    ds_read_b64_tr_b16 v[50:51], v4 offset:3584
    v_mfma_f32_16x16x32_bf16 v[172:175], v[92:95], v[120:123], v[172:175]
    ds_read_b128 v[80:83], v5 offset:3584
    v_mfma_f32_16x16x32_bf16 v[176:179], v[96:99], v[120:123], v[176:179]
    v_mfma_f32_16x16x32_bf16 v[180:183], v[100:103], v[120:123], v[180:183]
    v_mfma_f32_16x16x32_bf16 v[184:187], v[104:107], v[120:123], v[184:187]
    v_mfma_f32_16x16x32_bf16 v[188:191], v[108:111], v[120:123], v[188:191]
    v_mfma_f32_16x16x32_bf16 v[160:163], v[84:87], v[116:119], v[160:163]
    v_mfma_f32_16x16x32_bf16 v[164:167], v[88:91], v[116:119], v[164:167]
    v_mfma_f32_16x16x32_bf16 v[168:171], v[92:95], v[116:119], v[168:171]
    v_mfma_f32_16x16x32_bf16 v[172:175], v[96:99], v[116:119], v[172:175]
    v_mfma_f32_16x16x32_bf16 v[176:179], v[100:103], v[116:119], v[176:179]
    v_mfma_f32_16x16x32_bf16 v[180:183], v[104:107], v[116:119], v[180:183]
    v_mfma_f32_16x16x32_bf16 v[184:187], v[108:111], v[116:119], v[184:187]
    v_mfma_f32_16x16x32_bf16 v[188:191], v[112:115], v[116:119], v[188:191]
    v_add_u32_e64 v4, 64, v4
    v_subrev_u32 v5, 64, v5
    s_waitcnt lgkmcnt(0)
    v_mfma_f32_16x16x32_bf16 v[188:191], v[20:23], v[80:83], v[188:191]
    ds_read_b64_tr_b16 v[84:85], v4 offset:8
    v_mfma_f32_16x16x32_bf16 v[184:187], v[20:23], v[76:79], v[184:187]
    ds_read_b64_tr_b16 v[86:87], v4 offset:0
    v_mfma_f32_16x16x32_bf16 v[180:183], v[20:23], v[72:75], v[180:183]
    ds_read_b128 v[116:119], v5 offset:0
    v_mfma_f32_16x16x32_bf16 v[188:191], v[24:27], v[76:79], v[188:191]
    ds_read_b64_tr_b16 v[88:89], v4 offset:520
    v_mfma_f32_16x16x32_bf16 v[184:187], v[24:27], v[72:75], v[184:187]
    ds_read_b64_tr_b16 v[90:91], v4 offset:512
    v_mfma_f32_16x16x32_bf16 v[176:179], v[20:23], v[68:71], v[176:179]
    ds_read_b128 v[120:123], v5 offset:512
    v_mfma_f32_16x16x32_bf16 v[188:191], v[28:31], v[72:75], v[188:191]
    ds_read_b64_tr_b16 v[92:93], v4 offset:1032
    v_mfma_f32_16x16x32_bf16 v[180:183], v[24:27], v[68:71], v[180:183]
    ds_read_b64_tr_b16 v[94:95], v4 offset:1024
    v_mfma_f32_16x16x32_bf16 v[184:187], v[28:31], v[68:71], v[184:187]
    ds_read_b128 v[124:127], v5 offset:1024
    v_mfma_f32_16x16x32_bf16 v[188:191], v[32:35], v[68:71], v[188:191]
    ds_read_b64_tr_b16 v[96:97], v4 offset:1544
    v_mfma_f32_16x16x32_bf16 v[172:175], v[20:23], v[64:67], v[172:175]
    ds_read_b64_tr_b16 v[98:99], v4 offset:1536
    v_mfma_f32_16x16x32_bf16 v[176:179], v[24:27], v[64:67], v[176:179]
    ds_read_b128 v[128:131], v5 offset:1536
    v_mfma_f32_16x16x32_bf16 v[180:183], v[28:31], v[64:67], v[180:183]
    ds_read_b64_tr_b16 v[100:101], v4 offset:2056
    v_mfma_f32_16x16x32_bf16 v[184:187], v[32:35], v[64:67], v[184:187]
    ds_read_b64_tr_b16 v[102:103], v4 offset:2048
    v_mfma_f32_16x16x32_bf16 v[188:191], v[36:39], v[64:67], v[188:191]
    ds_read_b128 v[132:135], v5 offset:2048
    v_mfma_f32_16x16x32_bf16 v[168:171], v[20:23], v[60:63], v[168:171]
    ds_read_b64_tr_b16 v[104:105], v4 offset:2568
    v_mfma_f32_16x16x32_bf16 v[172:175], v[24:27], v[60:63], v[172:175]
    ds_read_b64_tr_b16 v[106:107], v4 offset:2560
    v_mfma_f32_16x16x32_bf16 v[176:179], v[28:31], v[60:63], v[176:179]
    ds_read_b128 v[136:139], v5 offset:2560
    v_mfma_f32_16x16x32_bf16 v[180:183], v[32:35], v[60:63], v[180:183]
    ds_read_b64_tr_b16 v[108:109], v4 offset:3080
    v_mfma_f32_16x16x32_bf16 v[184:187], v[36:39], v[60:63], v[184:187]
    ds_read_b64_tr_b16 v[110:111], v4 offset:3072
    v_mfma_f32_16x16x32_bf16 v[188:191], v[40:43], v[60:63], v[188:191]
    ds_read_b128 v[140:143], v5 offset:3072
    v_mfma_f32_16x16x32_bf16 v[164:167], v[20:23], v[56:59], v[164:167]
    ds_read_b64_tr_b16 v[112:113], v4 offset:3592
    v_mfma_f32_16x16x32_bf16 v[168:171], v[24:27], v[56:59], v[168:171]
    ds_read_b64_tr_b16 v[114:115], v4 offset:3584
    v_mfma_f32_16x16x32_bf16 v[172:175], v[28:31], v[56:59], v[172:175]
    ds_read_b128 v[144:147], v5 offset:3584
    v_mfma_f32_16x16x32_bf16 v[176:179], v[32:35], v[56:59], v[176:179]
    v_mfma_f32_16x16x32_bf16 v[180:183], v[36:39], v[56:59], v[180:183]
    v_mfma_f32_16x16x32_bf16 v[184:187], v[40:43], v[56:59], v[184:187]
    v_mfma_f32_16x16x32_bf16 v[188:191], v[44:47], v[56:59], v[188:191]
    v_mfma_f32_16x16x32_bf16 v[160:163], v[20:23], v[52:55], v[160:163]
    v_mfma_f32_16x16x32_bf16 v[164:167], v[24:27], v[52:55], v[164:167]
    v_mfma_f32_16x16x32_bf16 v[168:171], v[28:31], v[52:55], v[168:171]
    v_mfma_f32_16x16x32_bf16 v[172:175], v[32:35], v[52:55], v[172:175]
    v_mfma_f32_16x16x32_bf16 v[176:179], v[36:39], v[52:55], v[176:179]
    v_mfma_f32_16x16x32_bf16 v[180:183], v[40:43], v[52:55], v[180:183]
    v_mfma_f32_16x16x32_bf16 v[184:187], v[44:47], v[52:55], v[184:187]
    v_mfma_f32_16x16x32_bf16 v[188:191], v[48:51], v[52:55], v[188:191]
    v_add_u32 v4, 64, v4
    v_subrev_u32 v5, 64, v5
    s_waitcnt vmcnt(0)
    s_mov_b64 s[36:37], exec
    s_mov_b64 exec, 0xff
    v_cmp_lt_u32 vcc, v218, v217
    s_mov_b64 exec, s[36:37]
    s_cmp_eq_u64 vcc, 0
    s_cselect_b32 s33, 1, 0
    s_mov_b32 s20, s8
    s_mov_b32 s21, s9
    s_cmp_eq_u32 s33, 1
    s_cselect_b32 s22, 0x2000000, 0
    s_mov_b32 s23, 0x00020000
    s_waitcnt lgkmcnt(0)
    v_mfma_f32_16x16x32_bf16 v[188:191], v[84:87], v[144:147], v[188:191]
    ds_read_b64_tr_b16 v[20:21], v4 offset:8
    v_mfma_f32_16x16x32_bf16 v[184:187], v[84:87], v[140:143], v[184:187]
    ds_read_b64_tr_b16 v[22:23], v4 offset:0
    v_mfma_f32_16x16x32_bf16 v[180:183], v[84:87], v[136:139], v[180:183]
    ds_read_b128 v[52:55], v5 offset:0
    v_mfma_f32_16x16x32_bf16 v[188:191], v[88:91], v[140:143], v[188:191]
    ds_read_b64_tr_b16 v[24:25], v4 offset:520
    v_mfma_f32_16x16x32_bf16 v[184:187], v[88:91], v[136:139], v[184:187]
    ds_read_b64_tr_b16 v[26:27], v4 offset:512
    v_mfma_f32_16x16x32_bf16 v[176:179], v[84:87], v[132:135], v[176:179]
    ds_read_b128 v[56:59], v5 offset:512
    v_mfma_f32_16x16x32_bf16 v[188:191], v[92:95], v[136:139], v[188:191]
    ds_read_b64_tr_b16 v[28:29], v4 offset:1032
    v_mfma_f32_16x16x32_bf16 v[180:183], v[88:91], v[132:135], v[180:183]
    ds_read_b64_tr_b16 v[30:31], v4 offset:1024
    v_mfma_f32_16x16x32_bf16 v[184:187], v[92:95], v[132:135], v[184:187]
    ds_read_b128 v[60:63], v5 offset:1024
    v_mfma_f32_16x16x32_bf16 v[188:191], v[96:99], v[132:135], v[188:191]
    ds_read_b64_tr_b16 v[32:33], v4 offset:1544
    v_mfma_f32_16x16x32_bf16 v[172:175], v[84:87], v[128:131], v[172:175]
    ds_read_b64_tr_b16 v[34:35], v4 offset:1536
    v_mfma_f32_16x16x32_bf16 v[176:179], v[88:91], v[128:131], v[176:179]
    ds_read_b128 v[64:67], v5 offset:1536
    v_mfma_f32_16x16x32_bf16 v[180:183], v[92:95], v[128:131], v[180:183]
    ds_read_b64_tr_b16 v[36:37], v4 offset:2056
    v_mfma_f32_16x16x32_bf16 v[184:187], v[96:99], v[128:131], v[184:187]
    ds_read_b64_tr_b16 v[38:39], v4 offset:2048
    v_mfma_f32_16x16x32_bf16 v[188:191], v[100:103], v[128:131], v[188:191]
    ds_read_b128 v[68:71], v5 offset:2048
    v_mfma_f32_16x16x32_bf16 v[168:171], v[84:87], v[124:127], v[168:171]
    ds_read_b64_tr_b16 v[40:41], v4 offset:2568
    v_mfma_f32_16x16x32_bf16 v[172:175], v[88:91], v[124:127], v[172:175]
    ds_read_b64_tr_b16 v[42:43], v4 offset:2560
    v_mfma_f32_16x16x32_bf16 v[176:179], v[92:95], v[124:127], v[176:179]
    ds_read_b128 v[72:75], v5 offset:2560
    v_mfma_f32_16x16x32_bf16 v[180:183], v[96:99], v[124:127], v[180:183]
    ds_read_b64_tr_b16 v[44:45], v4 offset:3080
    v_mfma_f32_16x16x32_bf16 v[184:187], v[100:103], v[124:127], v[184:187]
    ds_read_b64_tr_b16 v[46:47], v4 offset:3072
    v_mfma_f32_16x16x32_bf16 v[188:191], v[104:107], v[124:127], v[188:191]
    ds_read_b128 v[76:79], v5 offset:3072
    v_mfma_f32_16x16x32_bf16 v[164:167], v[84:87], v[120:123], v[164:167]
    ds_read_b64_tr_b16 v[48:49], v4 offset:3592
    v_mfma_f32_16x16x32_bf16 v[168:171], v[88:91], v[120:123], v[168:171]
    ds_read_b64_tr_b16 v[50:51], v4 offset:3584
    v_mfma_f32_16x16x32_bf16 v[172:175], v[92:95], v[120:123], v[172:175]
    ds_read_b128 v[80:83], v5 offset:3584
    v_mfma_f32_16x16x32_bf16 v[176:179], v[96:99], v[120:123], v[176:179]
    s_lshl_b32 s3, s40, 7
    s_nop 0
    s_add_u32 s3, s3, 20185088
    buffer_load_dwordx2 v[200:201], v220, s[20:23], s3 offen sc1
    buffer_load_dwordx2 v[202:203], v221, s[20:23], s3 offen sc1
    v_mfma_f32_16x16x32_bf16 v[180:183], v[100:103], v[120:123], v[180:183]
    v_mfma_f32_16x16x32_bf16 v[184:187], v[104:107], v[120:123], v[184:187]
    v_mfma_f32_16x16x32_bf16 v[188:191], v[108:111], v[120:123], v[188:191]
    s_add_u32 s3, s3, 655360
    buffer_load_dwordx2 v[204:205], v220, s[20:23], s3 offen sc1
    buffer_load_dwordx2 v[206:207], v221, s[20:23], s3 offen sc1
    v_mfma_f32_16x16x32_bf16 v[160:163], v[84:87], v[116:119], v[160:163]
    v_mfma_f32_16x16x32_bf16 v[164:167], v[88:91], v[116:119], v[164:167]
    v_mfma_f32_16x16x32_bf16 v[168:171], v[92:95], v[116:119], v[168:171]
    s_add_u32 s3, s3, 655360
    buffer_load_dwordx2 v[208:209], v220, s[20:23], s3 offen sc1
    buffer_load_dwordx2 v[210:211], v221, s[20:23], s3 offen sc1
    v_mfma_f32_16x16x32_bf16 v[172:175], v[96:99], v[116:119], v[172:175]
    v_mfma_f32_16x16x32_bf16 v[176:179], v[100:103], v[116:119], v[176:179]
    v_mfma_f32_16x16x32_bf16 v[180:183], v[104:107], v[116:119], v[180:183]
    s_add_u32 s3, s3, 655360
    buffer_load_dwordx2 v[212:213], v220, s[20:23], s3 offen sc1
    buffer_load_dwordx2 v[214:215], v221, s[20:23], s3 offen sc1
    v_mfma_f32_16x16x32_bf16 v[184:187], v[108:111], v[116:119], v[184:187]
    v_mfma_f32_16x16x32_bf16 v[188:191], v[112:115], v[116:119], v[188:191]
    v_add_u32_e64 v4, 64, v4
    v_subrev_u32 v5, 64, v5
    s_waitcnt lgkmcnt(0)
    v_mfma_f32_16x16x32_bf16 v[188:191], v[20:23], v[80:83], v[188:191]
    ds_read_b64_tr_b16 v[84:85], v4 offset:8
    v_mfma_f32_16x16x32_bf16 v[184:187], v[20:23], v[76:79], v[184:187]
    ds_read_b64_tr_b16 v[86:87], v4 offset:0
    v_mfma_f32_16x16x32_bf16 v[180:183], v[20:23], v[72:75], v[180:183]
    ds_read_b128 v[116:119], v5 offset:0
    v_mfma_f32_16x16x32_bf16 v[188:191], v[24:27], v[76:79], v[188:191]
    ds_read_b64_tr_b16 v[88:89], v4 offset:520
    v_mfma_f32_16x16x32_bf16 v[184:187], v[24:27], v[72:75], v[184:187]
    ds_read_b64_tr_b16 v[90:91], v4 offset:512
    v_mfma_f32_16x16x32_bf16 v[176:179], v[20:23], v[68:71], v[176:179]
    ds_read_b128 v[120:123], v5 offset:512
    v_mfma_f32_16x16x32_bf16 v[188:191], v[28:31], v[72:75], v[188:191]
    ds_read_b64_tr_b16 v[92:93], v4 offset:1032
    v_mfma_f32_16x16x32_bf16 v[180:183], v[24:27], v[68:71], v[180:183]
    ds_read_b64_tr_b16 v[94:95], v4 offset:1024
    v_mfma_f32_16x16x32_bf16 v[184:187], v[28:31], v[68:71], v[184:187]
    ds_read_b128 v[124:127], v5 offset:1024
    v_mfma_f32_16x16x32_bf16 v[188:191], v[32:35], v[68:71], v[188:191]
    ds_read_b64_tr_b16 v[96:97], v4 offset:1544
    v_mfma_f32_16x16x32_bf16 v[172:175], v[20:23], v[64:67], v[172:175]
    ds_read_b64_tr_b16 v[98:99], v4 offset:1536
    v_mfma_f32_16x16x32_bf16 v[176:179], v[24:27], v[64:67], v[176:179]
    ds_read_b128 v[128:131], v5 offset:1536
    v_mfma_f32_16x16x32_bf16 v[180:183], v[28:31], v[64:67], v[180:183]
    ds_read_b64_tr_b16 v[100:101], v4 offset:2056
    v_mfma_f32_16x16x32_bf16 v[184:187], v[32:35], v[64:67], v[184:187]
    ds_read_b64_tr_b16 v[102:103], v4 offset:2048
    v_mfma_f32_16x16x32_bf16 v[188:191], v[36:39], v[64:67], v[188:191]
    ds_read_b128 v[132:135], v5 offset:2048
    v_mfma_f32_16x16x32_bf16 v[168:171], v[20:23], v[60:63], v[168:171]
    ds_read_b64_tr_b16 v[104:105], v4 offset:2568
    v_mfma_f32_16x16x32_bf16 v[172:175], v[24:27], v[60:63], v[172:175]
    ds_read_b64_tr_b16 v[106:107], v4 offset:2560
    v_mfma_f32_16x16x32_bf16 v[176:179], v[28:31], v[60:63], v[176:179]
    ds_read_b128 v[136:139], v5 offset:2560
    v_mfma_f32_16x16x32_bf16 v[180:183], v[32:35], v[60:63], v[180:183]
    ds_read_b64_tr_b16 v[108:109], v4 offset:3080
    v_mfma_f32_16x16x32_bf16 v[184:187], v[36:39], v[60:63], v[184:187]
    ds_read_b64_tr_b16 v[110:111], v4 offset:3072
    v_mfma_f32_16x16x32_bf16 v[188:191], v[40:43], v[60:63], v[188:191]
    ds_read_b128 v[140:143], v5 offset:3072
    v_mfma_f32_16x16x32_bf16 v[164:167], v[20:23], v[56:59], v[164:167]
    ds_read_b64_tr_b16 v[112:113], v4 offset:3592
    v_mfma_f32_16x16x32_bf16 v[168:171], v[24:27], v[56:59], v[168:171]
    ds_read_b64_tr_b16 v[114:115], v4 offset:3584
    v_mfma_f32_16x16x32_bf16 v[172:175], v[28:31], v[56:59], v[172:175]
    ds_read_b128 v[144:147], v5 offset:3584
    v_mfma_f32_16x16x32_bf16 v[176:179], v[32:35], v[56:59], v[176:179]
    v_mfma_f32_16x16x32_bf16 v[180:183], v[36:39], v[56:59], v[180:183]
    v_mfma_f32_16x16x32_bf16 v[184:187], v[40:43], v[56:59], v[184:187]
    v_mfma_f32_16x16x32_bf16 v[188:191], v[44:47], v[56:59], v[188:191]
    v_mfma_f32_16x16x32_bf16 v[160:163], v[20:23], v[52:55], v[160:163]
    v_mfma_f32_16x16x32_bf16 v[164:167], v[24:27], v[52:55], v[164:167]
    v_mfma_f32_16x16x32_bf16 v[168:171], v[28:31], v[52:55], v[168:171]
    v_mfma_f32_16x16x32_bf16 v[172:175], v[32:35], v[52:55], v[172:175]
    v_mfma_f32_16x16x32_bf16 v[176:179], v[36:39], v[52:55], v[176:179]
    v_mfma_f32_16x16x32_bf16 v[180:183], v[40:43], v[52:55], v[180:183]
    v_mfma_f32_16x16x32_bf16 v[184:187], v[44:47], v[52:55], v[184:187]
    v_mfma_f32_16x16x32_bf16 v[188:191], v[48:51], v[52:55], v[188:191]
    v_add_u32_e64 v4, 64, v4
    v_subrev_u32 v5, 64, v5
    s_waitcnt lgkmcnt(0)
    v_mfma_f32_16x16x32_bf16 v[188:191], v[84:87], v[144:147], v[188:191]
    v_mfma_f32_16x16x32_bf16 v[184:187], v[84:87], v[140:143], v[184:187]
    v_mfma_f32_16x16x32_bf16 v[180:183], v[84:87], v[136:139], v[180:183]
    v_mfma_f32_16x16x32_bf16 v[188:191], v[88:91], v[140:143], v[188:191]
    v_mfma_f32_16x16x32_bf16 v[184:187], v[88:91], v[136:139], v[184:187]
    v_mfma_f32_16x16x32_bf16 v[176:179], v[84:87], v[132:135], v[176:179]
    v_mfma_f32_16x16x32_bf16 v[188:191], v[92:95], v[136:139], v[188:191]
    v_mfma_f32_16x16x32_bf16 v[180:183], v[88:91], v[132:135], v[180:183]
    v_mfma_f32_16x16x32_bf16 v[184:187], v[92:95], v[132:135], v[184:187]
    v_mfma_f32_16x16x32_bf16 v[188:191], v[96:99], v[132:135], v[188:191]
    v_mfma_f32_16x16x32_bf16 v[172:175], v[84:87], v[128:131], v[172:175]
    v_mfma_f32_16x16x32_bf16 v[176:179], v[88:91], v[128:131], v[176:179]
    v_mfma_f32_16x16x32_bf16 v[180:183], v[92:95], v[128:131], v[180:183]
    v_mfma_f32_16x16x32_bf16 v[184:187], v[96:99], v[128:131], v[184:187]
    v_mfma_f32_16x16x32_bf16 v[188:191], v[100:103], v[128:131], v[188:191]
    v_mfma_f32_16x16x32_bf16 v[168:171], v[84:87], v[124:127], v[168:171]
    v_mfma_f32_16x16x32_bf16 v[172:175], v[88:91], v[124:127], v[172:175]
    v_mfma_f32_16x16x32_bf16 v[176:179], v[92:95], v[124:127], v[176:179]
    v_mfma_f32_16x16x32_bf16 v[180:183], v[96:99], v[124:127], v[180:183]
    v_mfma_f32_16x16x32_bf16 v[184:187], v[100:103], v[124:127], v[184:187]
    v_mfma_f32_16x16x32_bf16 v[188:191], v[104:107], v[124:127], v[188:191]
    v_mfma_f32_16x16x32_bf16 v[164:167], v[84:87], v[120:123], v[164:167]
    v_mfma_f32_16x16x32_bf16 v[168:171], v[88:91], v[120:123], v[168:171]
    v_mfma_f32_16x16x32_bf16 v[172:175], v[92:95], v[120:123], v[172:175]
    v_mfma_f32_16x16x32_bf16 v[176:179], v[96:99], v[120:123], v[176:179]
    v_mfma_f32_16x16x32_bf16 v[180:183], v[100:103], v[120:123], v[180:183]
    v_mfma_f32_16x16x32_bf16 v[184:187], v[104:107], v[120:123], v[184:187]
    v_mfma_f32_16x16x32_bf16 v[188:191], v[108:111], v[120:123], v[188:191]
    v_mfma_f32_16x16x32_bf16 v[160:163], v[84:87], v[116:119], v[160:163]
    v_mfma_f32_16x16x32_bf16 v[164:167], v[88:91], v[116:119], v[164:167]
    v_mfma_f32_16x16x32_bf16 v[168:171], v[92:95], v[116:119], v[168:171]
    v_mfma_f32_16x16x32_bf16 v[172:175], v[96:99], v[116:119], v[172:175]
    v_mfma_f32_16x16x32_bf16 v[176:179], v[100:103], v[116:119], v[176:179]
    v_mfma_f32_16x16x32_bf16 v[180:183], v[104:107], v[116:119], v[180:183]
    v_mfma_f32_16x16x32_bf16 v[184:187], v[108:111], v[116:119], v[184:187]
    v_mfma_f32_16x16x32_bf16 v[188:191], v[112:115], v[116:119], v[188:191]
L_convep:
    v_and_b32 v6, 15, v1
    v_lshrrev_b32 v7, 4, v1
    v_lshlrev_b32_e64 v6, 5, v6
    v_lshl_add_u32 v6, v7, 3, v6
    s_add_u32 s5, s42, 17120
    v_add_u32_e64 v6, s5, v6
    ds_read_b64 v[20:21], v6 offset:0
    ds_read_b64 v[22:23], v6 offset:512
    ds_read_b64 v[24:25], v6 offset:1024
    ds_read_b64 v[26:27], v6 offset:1536
    ds_read_b64 v[28:29], v6 offset:2048
    ds_read_b64 v[30:31], v6 offset:2560
    ds_read_b64 v[32:33], v6 offset:3072
    ds_read_b64 v[34:35], v6 offset:3584
    s_waitcnt lgkmcnt(7)
    v_lshlrev_b32 v44, 16, v20
    v_and_b32 v45, 0xffff0000, v20
    v_lshlrev_b32_e64 v46, 16, v21
    v_and_b32 v47, 0xffff0000, v21
    v_pk_fma_f32 v[44:45], v[44:45], v[12:13], v[160:161] op_sel:[0,1,0] op_sel_hi:[1,1,1]
    v_pk_fma_f32 v[46:47], v[46:47], v[12:13], v[162:163] op_sel:[0,1,0] op_sel_hi:[1,1,1]
    v_pk_mul_f32 v[44:45], v[44:45], v[12:13] op_sel_hi:[1,0]
    v_pk_mul_f32 v[46:47], v[46:47], v[12:13] op_sel_hi:[1,0]
    v_cvt_pk_bf16_f32 v20, v44, v45
    v_cvt_pk_bf16_f32 v21, v46, v47
    ds_write_b64 v6, v[20:21] offset:0
    s_waitcnt lgkmcnt(7)
    v_lshlrev_b32 v44, 16, v22
    v_and_b32 v45, 0xffff0000, v22
    v_lshlrev_b32_e64 v46, 16, v23
    v_and_b32 v47, 0xffff0000, v23
    v_pk_fma_f32 v[44:45], v[44:45], v[12:13], v[164:165] op_sel:[0,1,0] op_sel_hi:[1,1,1]
    v_pk_fma_f32 v[46:47], v[46:47], v[12:13], v[166:167] op_sel:[0,1,0] op_sel_hi:[1,1,1]
    v_pk_mul_f32 v[44:45], v[44:45], v[12:13] op_sel_hi:[1,0]
    v_pk_mul_f32 v[46:47], v[46:47], v[12:13] op_sel_hi:[1,0]
    v_cvt_pk_bf16_f32 v22, v44, v45
    v_cvt_pk_bf16_f32 v23, v46, v47
    ds_write_b64 v6, v[22:23] offset:512
    s_waitcnt lgkmcnt(7)
    v_lshlrev_b32 v44, 16, v24
    v_and_b32 v45, 0xffff0000, v24
    v_lshlrev_b32_e64 v46, 16, v25
    v_and_b32 v47, 0xffff0000, v25
    v_pk_fma_f32 v[44:45], v[44:45], v[12:13], v[168:169] op_sel:[0,1,0] op_sel_hi:[1,1,1]
    v_pk_fma_f32 v[46:47], v[46:47], v[12:13], v[170:171] op_sel:[0,1,0] op_sel_hi:[1,1,1]
    v_pk_mul_f32 v[44:45], v[44:45], v[12:13] op_sel_hi:[1,0]
    v_pk_mul_f32 v[46:47], v[46:47], v[12:13] op_sel_hi:[1,0]
    v_cvt_pk_bf16_f32 v24, v44, v45
    v_cvt_pk_bf16_f32 v25, v46, v47
    ds_write_b64 v6, v[24:25] offset:1024
    s_waitcnt lgkmcnt(7)
    v_lshlrev_b32 v44, 16, v26
    v_and_b32 v45, 0xffff0000, v26
    v_lshlrev_b32_e64 v46, 16, v27
    v_and_b32 v47, 0xffff0000, v27
    v_pk_fma_f32 v[44:45], v[44:45], v[12:13], v[172:173] op_sel:[0,1,0] op_sel_hi:[1,1,1]
    v_pk_fma_f32 v[46:47], v[46:47], v[12:13], v[174:175] op_sel:[0,1,0] op_sel_hi:[1,1,1]
    v_pk_mul_f32 v[44:45], v[44:45], v[12:13] op_sel_hi:[1,0]
    v_pk_mul_f32 v[46:47], v[46:47], v[12:13] op_sel_hi:[1,0]
    v_cvt_pk_bf16_f32 v26, v44, v45
    v_cvt_pk_bf16_f32 v27, v46, v47
    ds_write_b64 v6, v[26:27] offset:1536
    s_waitcnt lgkmcnt(7)
    v_lshlrev_b32 v44, 16, v28
    v_and_b32 v45, 0xffff0000, v28
    v_lshlrev_b32_e64 v46, 16, v29
    v_and_b32 v47, 0xffff0000, v29
    v_pk_fma_f32 v[44:45], v[44:45], v[12:13], v[176:177] op_sel:[0,1,0] op_sel_hi:[1,1,1]
    v_pk_fma_f32 v[46:47], v[46:47], v[12:13], v[178:179] op_sel:[0,1,0] op_sel_hi:[1,1,1]
    v_pk_mul_f32 v[44:45], v[44:45], v[12:13] op_sel_hi:[1,0]
    v_pk_mul_f32 v[46:47], v[46:47], v[12:13] op_sel_hi:[1,0]
    v_cvt_pk_bf16_f32 v28, v44, v45
    v_cvt_pk_bf16_f32 v29, v46, v47
    ds_write_b64 v6, v[28:29] offset:2048
    s_waitcnt lgkmcnt(7)
    v_lshlrev_b32 v44, 16, v30
    v_and_b32 v45, 0xffff0000, v30
    v_lshlrev_b32_e64 v46, 16, v31
    v_and_b32 v47, 0xffff0000, v31
    v_pk_fma_f32 v[44:45], v[44:45], v[12:13], v[180:181] op_sel:[0,1,0] op_sel_hi:[1,1,1]
    v_pk_fma_f32 v[46:47], v[46:47], v[12:13], v[182:183] op_sel:[0,1,0] op_sel_hi:[1,1,1]
    v_pk_mul_f32 v[44:45], v[44:45], v[12:13] op_sel_hi:[1,0]
    v_pk_mul_f32 v[46:47], v[46:47], v[12:13] op_sel_hi:[1,0]
    v_cvt_pk_bf16_f32 v30, v44, v45
    v_cvt_pk_bf16_f32 v31, v46, v47
    ds_write_b64 v6, v[30:31] offset:2560
    s_waitcnt lgkmcnt(7)
    v_lshlrev_b32 v44, 16, v32
    v_and_b32 v45, 0xffff0000, v32
    v_lshlrev_b32_e64 v46, 16, v33
    v_and_b32 v47, 0xffff0000, v33
    v_pk_fma_f32 v[44:45], v[44:45], v[12:13], v[184:185] op_sel:[0,1,0] op_sel_hi:[1,1,1]
    v_pk_fma_f32 v[46:47], v[46:47], v[12:13], v[186:187] op_sel:[0,1,0] op_sel_hi:[1,1,1]
    v_pk_mul_f32 v[44:45], v[44:45], v[12:13] op_sel_hi:[1,0]
    v_pk_mul_f32 v[46:47], v[46:47], v[12:13] op_sel_hi:[1,0]
    v_cvt_pk_bf16_f32 v32, v44, v45
    v_cvt_pk_bf16_f32 v33, v46, v47
    ds_write_b64 v6, v[32:33] offset:3072
    s_waitcnt lgkmcnt(7)
    v_lshlrev_b32 v44, 16, v34
    v_and_b32 v45, 0xffff0000, v34
    v_lshlrev_b32_e64 v46, 16, v35
    v_and_b32 v47, 0xffff0000, v35
    v_pk_fma_f32 v[44:45], v[44:45], v[12:13], v[188:189] op_sel:[0,1,0] op_sel_hi:[1,1,1]
    v_pk_fma_f32 v[46:47], v[46:47], v[12:13], v[190:191] op_sel:[0,1,0] op_sel_hi:[1,1,1]
    v_pk_mul_f32 v[44:45], v[44:45], v[12:13] op_sel_hi:[1,0]
    v_pk_mul_f32 v[46:47], v[46:47], v[12:13] op_sel_hi:[1,0]
    v_cvt_pk_bf16_f32 v34, v44, v45
    v_cvt_pk_bf16_f32 v35, v46, v47
    ds_write_b64 v6, v[34:35] offset:3584
    v_lshrrev_b32_e64 v6, 4, v0
    v_bfe_u32 v7, v1, 2, 2
    v_and_b32_e64 v9, 3, v1
    v_mul_u32_u24 v8, 21216, v7
    v_lshl_add_u32 v8, v6, 6, v8
    v_lshl_add_u32 v8, v9, 3, v8
    v_add_u32 v8, 17120, v8
    v_mul_u32_u24 v6, 40960, v6
    v_and_b32 v9, 15, v1
    v_lshl_add_u32 v6, v9, 4, v6
    s_lshl_b32 s5, s40, 8
    s_add_u32 s5, s5, 2621440
    s_waitcnt lgkmcnt(0)
    s_barrier
    ds_read_b64_tr_b16 v[20:21], v8 offset:0
    ds_read_b64_tr_b16 v[22:23], v8 offset:32
    ds_read_b64_tr_b16 v[24:25], v8 offset:1024
    ds_read_b64_tr_b16 v[26:27], v8 offset:1056
    ds_read_b64_tr_b16 v[28:29], v8 offset:2048
    ds_read_b64_tr_b16 v[30:31], v8 offset:2080
    ds_read_b64_tr_b16 v[32:33], v8 offset:3072
    ds_read_b64_tr_b16 v[34:35], v8 offset:3104
    s_cmp_eq_u32 s33, 1
    s_cbranch_scc1 L_xfok_25
    v_lshlrev_b32_e64 v222, 7, v1
    v_add_u32 v222, 5379072, v222
    v_mov_b32 v223, 16
    s_mov_b64 s[36:37], exec
    s_mov_b64 exec, 0xff
    s_mov_b32 s97, 0
L_poll_26:
    buffer_load_dword v224, v222, s[8:11], 0 offen sc1
    s_waitcnt vmcnt(0)
    v_cmp_lt_u32_e64 vcc, v224, v223
    s_nop 0
    s_cbranch_vccz L_polld_27
    s_add_u32 s97, s97, 1
    s_cmp_lt_u32 s97, 262144
    s_cbranch_scc1 L_poll_26
L_polld_27:
    s_mov_b64 exec, s[36:37]
    s_lshl_b32 s3, s40, 7
    s_add_u32 s3, s3, 20185088
    buffer_load_dwordx2 v[200:201], v220, s[8:11], s3 offen sc1
    buffer_load_dwordx2 v[202:203], v221, s[8:11], s3 offen sc1
    s_add_u32 s3, s3, 655360
    buffer_load_dwordx2 v[204:205], v220, s[8:11], s3 offen sc1
    buffer_load_dwordx2 v[206:207], v221, s[8:11], s3 offen sc1
    s_add_u32 s3, s3, 655360
    buffer_load_dwordx2 v[208:209], v220, s[8:11], s3 offen sc1
    buffer_load_dwordx2 v[210:211], v221, s[8:11], s3 offen sc1
    s_add_u32 s3, s3, 655360
    buffer_load_dwordx2 v[212:213], v220, s[8:11], s3 offen sc1
    buffer_load_dwordx2 v[214:215], v221, s[8:11], s3 offen sc1
L_xfok_25:
    s_waitcnt vmcnt(0)
    s_waitcnt lgkmcnt(6)
    v_lshlrev_b32_e64 v44, 16, v20
    v_and_b32 v45, 0xffff0000, v20
    v_lshlrev_b32_e64 v46, 16, v200
    v_and_b32 v47, 0xffff0000, v200
    v_pk_add_f32 v[44:45], v[44:45], v[46:47]
    v_cvt_pk_bf16_f32 v52, v44, v45
    v_lshlrev_b32_e64 v44, 16, v21
    v_and_b32 v45, 0xffff0000, v21
    v_lshlrev_b32_e64 v46, 16, v201
    v_and_b32 v47, 0xffff0000, v201
    v_pk_add_f32 v[44:45], v[44:45], v[46:47]
    v_cvt_pk_bf16_f32 v53, v44, v45
    v_lshlrev_b32_e64 v44, 16, v22
    v_and_b32 v45, 0xffff0000, v22
    v_lshlrev_b32_e64 v46, 16, v202
    v_and_b32 v47, 0xffff0000, v202
    v_pk_add_f32 v[44:45], v[44:45], v[46:47]
    v_cvt_pk_bf16_f32 v54, v44, v45
    v_lshlrev_b32_e64 v44, 16, v23
    v_and_b32 v45, 0xffff0000, v23
    v_lshlrev_b32_e64 v46, 16, v203
    v_and_b32 v47, 0xffff0000, v203
    v_pk_add_f32 v[44:45], v[44:45], v[46:47]
    v_cvt_pk_bf16_f32 v55, v44, v45
    buffer_store_dwordx4 v[52:55], v6, s[8:11], s5 offen sc1
    s_add_u32 s5, s5, 655360
    s_waitcnt lgkmcnt(4)
    v_lshlrev_b32 v44, 16, v24
    v_and_b32 v45, 0xffff0000, v24
    v_lshlrev_b32_e64 v46, 16, v204
    v_and_b32 v47, 0xffff0000, v204
    v_pk_add_f32 v[44:45], v[44:45], v[46:47]
    v_cvt_pk_bf16_f32 v56, v44, v45
    v_lshlrev_b32_e64 v44, 16, v25
    v_and_b32 v45, 0xffff0000, v25
    v_lshlrev_b32_e64 v46, 16, v205
    v_and_b32 v47, 0xffff0000, v205
    v_pk_add_f32 v[44:45], v[44:45], v[46:47]
    v_cvt_pk_bf16_f32 v57, v44, v45
    v_lshlrev_b32_e64 v44, 16, v26
    v_and_b32 v45, 0xffff0000, v26
    v_lshlrev_b32_e64 v46, 16, v206
    v_and_b32 v47, 0xffff0000, v206
    v_pk_add_f32 v[44:45], v[44:45], v[46:47]
    v_cvt_pk_bf16_f32 v58, v44, v45
    v_lshlrev_b32_e64 v44, 16, v27
    v_and_b32 v45, 0xffff0000, v27
    v_lshlrev_b32_e64 v46, 16, v207
    v_and_b32 v47, 0xffff0000, v207
    v_pk_add_f32 v[44:45], v[44:45], v[46:47]
    v_cvt_pk_bf16_f32 v59, v44, v45
    buffer_store_dwordx4 v[56:59], v6, s[8:11], s5 offen sc1
    s_add_u32 s5, s5, 655360
    s_waitcnt lgkmcnt(2)
    v_lshlrev_b32 v44, 16, v28
    v_and_b32 v45, 0xffff0000, v28
    v_lshlrev_b32_e64 v46, 16, v208
    v_and_b32 v47, 0xffff0000, v208
    v_pk_add_f32 v[44:45], v[44:45], v[46:47]
    v_cvt_pk_bf16_f32 v60, v44, v45
    v_lshlrev_b32_e64 v44, 16, v29
    v_and_b32 v45, 0xffff0000, v29
    v_lshlrev_b32_e64 v46, 16, v209
    v_and_b32 v47, 0xffff0000, v209
    v_pk_add_f32 v[44:45], v[44:45], v[46:47]
    v_cvt_pk_bf16_f32 v61, v44, v45
    v_lshlrev_b32_e64 v44, 16, v30
    v_and_b32 v45, 0xffff0000, v30
    v_lshlrev_b32_e64 v46, 16, v210
    v_and_b32 v47, 0xffff0000, v210
    v_pk_add_f32 v[44:45], v[44:45], v[46:47]
    v_cvt_pk_bf16_f32 v62, v44, v45
    v_lshlrev_b32_e64 v44, 16, v31
    v_and_b32 v45, 0xffff0000, v31
    v_lshlrev_b32_e64 v46, 16, v211
    v_and_b32 v47, 0xffff0000, v211
    v_pk_add_f32 v[44:45], v[44:45], v[46:47]
    v_cvt_pk_bf16_f32 v63, v44, v45
    buffer_store_dwordx4 v[60:63], v6, s[8:11], s5 offen sc1
    s_add_u32 s5, s5, 655360
    s_waitcnt lgkmcnt(0)
    v_lshlrev_b32 v44, 16, v32
    v_and_b32 v45, 0xffff0000, v32
    v_lshlrev_b32_e64 v46, 16, v212
    v_and_b32 v47, 0xffff0000, v212
    v_pk_add_f32 v[44:45], v[44:45], v[46:47]
    v_cvt_pk_bf16_f32 v64, v44, v45
    v_lshlrev_b32_e64 v44, 16, v33
    v_and_b32 v45, 0xffff0000, v33
    v_lshlrev_b32_e64 v46, 16, v213
    v_and_b32 v47, 0xffff0000, v213
    v_pk_add_f32 v[44:45], v[44:45], v[46:47]
    v_cvt_pk_bf16_f32 v65, v44, v45
    v_lshlrev_b32_e64 v44, 16, v34
    v_and_b32 v45, 0xffff0000, v34
    v_lshlrev_b32_e64 v46, 16, v214
    v_and_b32 v47, 0xffff0000, v214
    v_pk_add_f32 v[44:45], v[44:45], v[46:47]
    v_cvt_pk_bf16_f32 v66, v44, v45
    v_lshlrev_b32_e64 v44, 16, v35
    v_and_b32 v45, 0xffff0000, v35
    v_lshlrev_b32_e64 v46, 16, v215
    v_and_b32 v47, 0xffff0000, v215
    v_pk_add_f32 v[44:45], v[44:45], v[46:47]
    v_cvt_pk_bf16_f32 v67, v44, v45
    buffer_store_dwordx4 v[64:67], v6, s[8:11], s5 offen sc1
    s_mov_b64 s[36:37], exec
    s_mov_b64 exec, 0xffff
    buffer_load_dword v228, v226, s[8:11], 0 offen sc1
    s_mov_b64 exec, s[36:37]
L_convend:
    s_and_b32 s35, s2, 7
    s_add_u32 s35, s35, 16
    s_waitcnt vmcnt(0)
    s_barrier
    s_cmp_eq_u32 s4, 0
    s_cbranch_scc0 L_w0_28
    s_lshl_b32 s96, s35, 7
    s_add_u32 s96, s96, 5373952
    v_mov_b32 v2, 1
    v_mov_b32_e64 v3, 0
    s_mov_b64 s[36:37], exec
    s_mov_b64 exec, 1
    buffer_atomic_add v2, v3, s[8:11], s96 offen sc1
    s_mov_b64 exec, s[36:37]
L_w0_28:
    s_mov_b64 s[36:37], exec
    s_mov_b64 exec, 0xffff
    v_cmp_lt_u32_e64 vcc, v228, v227
    s_mov_b64 exec, s[36:37]
    s_cmp_eq_u64 vcc, 0
    s_cselect_b32 s34, 1, 0
    s_cmp_eq_u32 s34, 1
    s_cbranch_scc1 L_wpok_29
    s_mov_b64 s[36:37], exec
    s_mov_b64 exec, 0xffff
    s_mov_b32 s97, 0
L_poll_30:
    buffer_load_dword v228, v226, s[8:11], 0 offen sc1
    s_waitcnt vmcnt(0)
    v_cmp_lt_u32 vcc, v228, v227
    s_nop 0
    s_cbranch_vccz L_polld_31
    s_add_u32 s97, s97, 1
    s_cmp_lt_u32 s97, 262144
    s_cbranch_scc1 L_poll_30
L_polld_31:
    s_mov_b64 exec, s[36:37]
L_wpok_29:
    v_lshlrev_b32_e64 v6, 4, v1
    s_mov_b32 s12, s8
    s_mov_b32 s13, s9
    s_mov_b32 s14, 0x2000000
    s_mov_b32 s15, 0x00020000
    s_mul_i32 s53, s4, 10240
    s_mul_i32 s51, s46, 41984
    s_add_u32 s51, s51, s53
    s_add_u32 s51, s51, 6291456
    s_add_u32 m0, s53, 84992
    s_mov_b32 s5, s51
    buffer_load_dwordx4 v6, s[12:15], s5 offen offset:0 sc1 lds
    buffer_load_dwordx4 v6, s[12:15], s5 offen offset:1024 sc1 lds
    buffer_load_dwordx4 v6, s[12:15], s5 offen offset:2048 sc1 lds
    buffer_load_dwordx4 v6, s[12:15], s5 offen offset:3072 sc1 lds
    s_add_u32 m0, m0, 4096
    s_add_u32 s5, s5, 4096
    buffer_load_dwordx4 v6, s[12:15], s5 offen offset:0 sc1 lds
    buffer_load_dwordx4 v6, s[12:15], s5 offen offset:1024 sc1 lds
    buffer_load_dwordx4 v6, s[12:15], s5 offen offset:2048 sc1 lds
    buffer_load_dwordx4 v6, s[12:15], s5 offen offset:3072 sc1 lds
    s_add_u32 m0, m0, 4096
    s_add_u32 s5, s5, 4096
    buffer_load_dwordx4 v6, s[12:15], s5 offen offset:0 sc1 lds
    buffer_load_dwordx4 v6, s[12:15], s5 offen offset:1024 sc1 lds
    buffer_load_dwordx4 v6, s[12:15], s5 offen offset:2048 sc1 lds
    s_add_u32 s51, s51, 41984
    v_lshlrev_b32_e64 v6, 4, v1
    s_add_u32 m0, s53, 0
    s_mov_b32 s5, s51
    buffer_load_dwordx4 v6, s[12:15], s5 offen offset:0 sc1 lds
    buffer_load_dwordx4 v6, s[12:15], s5 offen offset:1024 sc1 lds
    buffer_load_dwordx4 v6, s[12:15], s5 offen offset:2048 sc1 lds
    buffer_load_dwordx4 v6, s[12:15], s5 offen offset:3072 sc1 lds
    s_add_u32 m0, m0, 4096
    s_add_u32 s5, s5, 4096
    buffer_load_dwordx4 v6, s[12:15], s5 offen offset:0 sc1 lds
    buffer_load_dwordx4 v6, s[12:15], s5 offen offset:1024 sc1 lds
    buffer_load_dwordx4 v6, s[12:15], s5 offen offset:2048 sc1 lds
    buffer_load_dwordx4 v6, s[12:15], s5 offen offset:3072 sc1 lds
    s_add_u32 m0, m0, 4096
    s_add_u32 s5, s5, 4096
    buffer_load_dwordx4 v6, s[12:15], s5 offen offset:0 sc1 lds
    buffer_load_dwordx4 v6, s[12:15], s5 offen offset:1024 sc1 lds
    buffer_load_dwordx4 v6, s[12:15], s5 offen offset:2048 sc1 lds
    s_add_u32 s51, s51, 41984
    s_mov_b32 s3, 0x7040100
    s_cmp_eq_u32 s4, 1
    s_cselect_b32 s3, 0x1512110e, s3
    s_cmp_eq_u32 s4, 2
    s_cselect_b32 s3, 0x221f1c1b, s3
    s_cmp_eq_u32 s4, 3
    s_cselect_b32 s3, 0x302d2c29, s3
    s_bfe_u32 s64, s3, 0x80000
    s_lshl_b32 s64, s64, 10
    s_bfe_u32 s65, s3, 0x80008
    s_lshl_b32 s65, s65, 10
    s_bfe_u32 s66, s3, 0x80010
    s_lshl_b32 s66, s66, 10
    s_bfe_u32 s67, s3, 0x80018
    s_lshl_b32 s67, s67, 10
    s_mov_b32 s3, 0x3020b08
    s_cmp_eq_u32 s4, 1
    s_cselect_b32 s3, 0x100f1918, s3
    s_cmp_eq_u32 s4, 2
    s_cselect_b32 s3, 0x201e2623, s3
    s_cmp_eq_u32 s4, 3
    s_cselect_b32 s3, 0x2b2a3433, s3
    s_bfe_u32 s68, s3, 0x80000
    s_lshl_b32 s68, s68, 10
    s_bfe_u32 s69, s3, 0x80008
    s_lshl_b32 s69, s69, 10
    s_bfe_u32 s70, s3, 0x80010
    s_lshl_b32 s70, s70, 10
    s_bfe_u32 s71, s3, 0x80018
    s_lshl_b32 s71, s71, 10
    s_mov_b32 s3, 0xa090605
    s_cmp_eq_u32 s4, 1
    s_cselect_b32 s3, 0x17161413, s3
    s_cmp_eq_u32 s4, 2
    s_cselect_b32 s3, 0x27252421, s3
    s_cmp_eq_u32 s4, 3
    s_cselect_b32 s3, 0x32312f2e, s3
    s_bfe_u32 s72, s3, 0x80000
    s_lshl_b32 s72, s72, 10
    s_bfe_u32 s73, s3, 0x80008
    s_lshl_b32 s73, s73, 10
    s_bfe_u32 s74, s3, 0x80010
    s_lshl_b32 s74, s74, 10
    s_bfe_u32 s75, s3, 0x80018
    s_lshl_b32 s75, s75, 10
    s_mov_b32 s3, 0xd0c
    s_cmp_eq_u32 s4, 1
    s_cselect_b32 s3, 0x1d1a, s3
    s_cmp_eq_u32 s4, 2
    s_cselect_b32 s3, 0x2828, s3
    s_cmp_eq_u32 s4, 3
    s_cselect_b32 s3, 0x3535, s3
    s_bfe_u32 s76, s3, 0x80000
    s_lshl_b32 s76, s76, 10
    s_bfe_u32 s77, s3, 0x80008
    s_lshl_b32 s77, s77, 10
    s_mul_i32 s5, s55, 5
    s_add_u32 s5, s5, 0
    s_mul_i32 s5, s5, 55296
    s_add_u32 s57, s5, 10878976
    s_mul_i32 s5, s55, 5
    s_add_u32 s5, s5, 1
    s_mul_i32 s5, s5, 55296
    s_add_u32 s58, s5, 10878976
    s_mul_i32 s5, s55, 5
    s_add_u32 s5, s5, 2
    s_mul_i32 s5, s5, 55296
    s_add_u32 s59, s5, 10878976
    s_mul_i32 s5, s55, 5
    s_add_u32 s5, s5, 3
    s_mul_i32 s5, s5, 55296
    s_add_u32 s60, s5, 10878976
    s_mul_i32 s5, s55, 5
    s_add_u32 s5, s5, 4
    s_mul_i32 s5, s5, 55296
    s_add_u32 s61, s5, 10878976
    s_branch L_Bdone_4
L_prep_3:
    s_nop 0
    s_mov_b32 s12, s88
    s_mov_b32 s13, s89
    s_mov_b32 s14, 0x4b0000
    s_mov_b32 s15, 0x00020000
    s_mov_b32 s16, s86
    s_mov_b32 s17, s87
    s_mov_b32 s18, 0x500
    s_mov_b32 s19, 0x00020000
    s_sub_u32 s32, s2, 136
    s_lshr_b32 s33, s32, 1
    s_and_b32 s32, s32, 1
    s_mul_i32 s34, s32, 320
    s_mul_i32 s5, s4, 80
    s_add_u32 s34, s34, s5
    s_lshl_b32 s6, s34, 1
    s_mul_i32 s5, s34, 7680
    s_lshl_b32 s7, s33, 7
    s_add_u32 s5, s5, s7
    v_lshrrev_b32 v2, 3, v1
    v_and_b32 v3, 7, v1
    v_mul_u32_u24 v4, 7680, v2
    v_lshl_add_u32 v4, v3, 4, v4
    v_lshlrev_b32_e64 v5, 1, v2
    buffer_load_ushort v10, v5, s[16:19], s6 offen offset:0
    buffer_load_ushort v11, v5, s[16:19], s6 offen offset:16
    buffer_load_ushort v12, v5, s[16:19], s6 offen offset:32
    buffer_load_ushort v13, v5, s[16:19], s6 offen offset:48
    buffer_load_ushort v14, v5, s[16:19], s6 offen offset:64
    buffer_load_ushort v15, v5, s[16:19], s6 offen offset:80
    buffer_load_ushort v16, v5, s[16:19], s6 offen offset:96
    buffer_load_ushort v17, v5, s[16:19], s6 offen offset:112
    buffer_load_ushort v18, v5, s[16:19], s6 offen offset:128
    buffer_load_ushort v19, v5, s[16:19], s6 offen offset:144
    buffer_load_dwordx4 v[20:23], v4, s[12:15], s5 offen nt
    s_add_u32 s5, s5, 61440
    buffer_load_dwordx4 v[24:27], v4, s[12:15], s5 offen nt
    s_add_u32 s5, s5, 61440
    buffer_load_dwordx4 v[28:31], v4, s[12:15], s5 offen nt
    s_add_u32 s5, s5, 61440
    buffer_load_dwordx4 v[32:35], v4, s[12:15], s5 offen nt
    s_add_u32 s5, s5, 61440
    buffer_load_dwordx4 v[36:39], v4, s[12:15], s5 offen nt
    s_add_u32 s5, s5, 61440
    buffer_load_dwordx4 v[40:43], v4, s[12:15], s5 offen nt
    s_add_u32 s5, s5, 61440
    buffer_load_dwordx4 v[44:47], v4, s[12:15], s5 offen nt
    s_add_u32 s5, s5, 61440
    buffer_load_dwordx4 v[48:51], v4, s[12:15], s5 offen nt
    s_add_u32 s5, s5, 61440
    buffer_load_dwordx4 v[52:55], v4, s[12:15], s5 offen nt
    s_add_u32 s5, s5, 61440
    buffer_load_dwordx4 v[56:59], v4, s[12:15], s5 offen nt
    s_cmp_ge_u32 s2, 214
    s_cbranch_scc1 L_wd_32
    s_sub_u32 s45, s2, 160
    s_and_b32 s44, s45, 1
    s_lshr_b32 s45, s45, 1
    s_cmp_eq_u32 s44, 0
    s_cselect_b32 s12, s80, s82
    s_cselect_b32 s13, s81, s83
    s_mov_b32 s14, 0x21c000
    s_mov_b32 s15, 0x00020000
    v_lshrrev_b32_e64 v2, 3, v1
    v_mul_u32_u24 v2, 3456, v2
    v_bfe_u32 v3, v1, 4, 1
    v_lshlrev_b32 v3, 2, v3
    v_and_b32 v4, 7, v1
    v_xor_b32_e64 v3, v3, v4
    v_lshl_add_u32 v2, v3, 4, v2
    s_mul_i32 s5, s4, 552960
    s_lshl_b32 s6, s45, 7
    s_add_u32 s5, s5, s6
    s_mul_i32 s6, s4, 20480
    s_add_u32 s6, s6, 8192
    s_add_u32 m0, s6, 0
    s_nop 0
    buffer_load_dwordx4 v2, s[12:15], s5 offen nt lds
    s_add_u32 s5, s5, 27648
    s_add_u32 m0, s6, 1024
    s_nop 0
    buffer_load_dwordx4 v2, s[12:15], s5 offen nt lds
    s_add_u32 s5, s5, 27648
    s_add_u32 m0, s6, 2048
    s_nop 0
    buffer_load_dwordx4 v2, s[12:15], s5 offen nt lds
    s_add_u32 s5, s5, 27648
    s_add_u32 m0, s6, 3072
    s_nop 0
    buffer_load_dwordx4 v2, s[12:15], s5 offen nt lds
    s_add_u32 s5, s5, 27648
    s_add_u32 m0, s6, 4096
    s_nop 0
    buffer_load_dwordx4 v2, s[12:15], s5 offen nt lds
    s_add_u32 s5, s5, 27648
    s_add_u32 m0, s6, 5120
    s_nop 0
    buffer_load_dwordx4 v2, s[12:15], s5 offen nt lds
    s_waitcnt vmcnt(16)
    v_lshlrev_b32_e64 v10, 16, v10
    v_mul_f32 v70, 0xbfb8aa3b, v10
    v_exp_f32 v70, v70
    s_nop 0
    v_add_f32 v70, 1.0, v70
    v_rcp_f32 v70, v70
    s_nop 0
    v_mul_f32 v10, v10, v70
    v_cvt_pk_bf16_f32 v10, v10, v10
    v_lshlrev_b32 v10, 16, v10
    v_lshlrev_b32 v11, 16, v11
    v_mul_f32 v70, 0xbfb8aa3b, v11
    v_exp_f32 v70, v70
    s_nop 0
    v_add_f32 v70, 1.0, v70
    v_rcp_f32 v70, v70
    s_nop 0
    v_mul_f32 v11, v11, v70
    v_cvt_pk_bf16_f32 v11, v11, v11
    v_lshlrev_b32 v11, 16, v11
    v_lshlrev_b32 v12, 16, v12
    v_mul_f32 v70, 0xbfb8aa3b, v12
    v_exp_f32 v70, v70
    s_nop 0
    v_add_f32 v70, 1.0, v70
    v_rcp_f32 v70, v70
    s_nop 0
    v_mul_f32 v12, v12, v70
    v_cvt_pk_bf16_f32 v12, v12, v12
    v_lshlrev_b32 v12, 16, v12
    v_lshlrev_b32 v13, 16, v13
    v_mul_f32 v70, 0xbfb8aa3b, v13
    v_exp_f32 v70, v70
    s_nop 0
    v_add_f32 v70, 1.0, v70
    v_rcp_f32 v70, v70
    s_nop 0
    v_mul_f32 v13, v13, v70
    v_cvt_pk_bf16_f32 v13, v13, v13
    v_lshlrev_b32 v13, 16, v13
    v_lshlrev_b32 v14, 16, v14
    v_mul_f32 v70, 0xbfb8aa3b, v14
    v_exp_f32 v70, v70
    s_nop 0
    v_add_f32 v70, 1.0, v70
    v_rcp_f32 v70, v70
    s_nop 0
    v_mul_f32 v14, v14, v70
    v_cvt_pk_bf16_f32 v14, v14, v14
    v_lshlrev_b32 v14, 16, v14
    v_lshlrev_b32 v15, 16, v15
    v_mul_f32 v70, 0xbfb8aa3b, v15
    v_exp_f32 v70, v70
    s_nop 0
    v_add_f32 v70, 1.0, v70
    v_rcp_f32 v70, v70
    s_nop 0
    v_mul_f32 v15, v15, v70
    v_cvt_pk_bf16_f32 v15, v15, v15
    v_lshlrev_b32 v15, 16, v15
    v_lshlrev_b32 v16, 16, v16
    v_mul_f32 v70, 0xbfb8aa3b, v16
    v_exp_f32 v70, v70
    s_nop 0
    v_add_f32 v70, 1.0, v70
    v_rcp_f32 v70, v70
    s_nop 0
    v_mul_f32 v16, v16, v70
    v_cvt_pk_bf16_f32 v16, v16, v16
    v_lshlrev_b32 v16, 16, v16
    v_lshlrev_b32 v17, 16, v17
    v_mul_f32 v70, 0xbfb8aa3b, v17
    v_exp_f32 v70, v70
    s_nop 0
    v_add_f32 v70, 1.0, v70
    v_rcp_f32 v70, v70
    s_nop 0
    v_mul_f32 v17, v17, v70
    v_cvt_pk_bf16_f32 v17, v17, v17
    v_lshlrev_b32 v17, 16, v17
    v_lshlrev_b32 v18, 16, v18
    v_mul_f32 v70, 0xbfb8aa3b, v18
    v_exp_f32 v70, v70
    s_nop 0
    v_add_f32 v70, 1.0, v70
    v_rcp_f32 v70, v70
    s_nop 0
    v_mul_f32 v18, v18, v70
    v_cvt_pk_bf16_f32 v18, v18, v18
    v_lshlrev_b32 v18, 16, v18
    v_lshlrev_b32 v19, 16, v19
    v_mul_f32 v70, 0xbfb8aa3b, v19
    v_exp_f32 v70, v70
    s_nop 0
    v_add_f32 v70, 1.0, v70
    v_rcp_f32 v70, v70
    s_nop 0
    v_mul_f32 v19, v19, v70
    v_cvt_pk_bf16_f32 v19, v19, v19
    v_lshlrev_b32 v19, 16, v19
    s_waitcnt vmcnt(15)
    v_lshlrev_b32_e64 v70, 16, v20
    v_and_b32 v71, 0xffff0000, v20
    v_pk_mul_f32 v[60:61], v[70:71], v[10:11] op_sel_hi:[1,0]
    v_lshlrev_b32_e64 v70, 16, v21
    v_and_b32 v71, 0xffff0000, v21
    v_pk_mul_f32 v[62:63], v[70:71], v[10:11] op_sel_hi:[1,0]
    v_lshlrev_b32_e64 v70, 16, v22
    v_and_b32 v71, 0xffff0000, v22
    v_pk_mul_f32 v[64:65], v[70:71], v[10:11] op_sel_hi:[1,0]
    v_lshlrev_b32_e64 v70, 16, v23
    v_and_b32 v71, 0xffff0000, v23
    v_pk_mul_f32 v[66:67], v[70:71], v[10:11] op_sel_hi:[1,0]
    s_waitcnt vmcnt(14)
    v_lshlrev_b32 v70, 16, v24
    v_and_b32 v71, 0xffff0000, v24
    v_pk_fma_f32 v[60:61], v[70:71], v[10:11], v[60:61] op_sel:[0,1,0] op_sel_hi:[1,1,1]
    v_lshlrev_b32_e64 v70, 16, v25
    v_and_b32 v71, 0xffff0000, v25
    v_pk_fma_f32 v[62:63], v[70:71], v[10:11], v[62:63] op_sel:[0,1,0] op_sel_hi:[1,1,1]
    v_lshlrev_b32_e64 v70, 16, v26
    v_and_b32 v71, 0xffff0000, v26
    v_pk_fma_f32 v[64:65], v[70:71], v[10:11], v[64:65] op_sel:[0,1,0] op_sel_hi:[1,1,1]
    v_lshlrev_b32_e64 v70, 16, v27
    v_and_b32 v71, 0xffff0000, v27
    v_pk_fma_f32 v[66:67], v[70:71], v[10:11], v[66:67] op_sel:[0,1,0] op_sel_hi:[1,1,1]
    s_waitcnt vmcnt(13)
    v_lshlrev_b32 v70, 16, v28
    v_and_b32 v71, 0xffff0000, v28
    v_pk_fma_f32 v[60:61], v[70:71], v[12:13], v[60:61] op_sel_hi:[1,0,1]
    v_lshlrev_b32_e64 v70, 16, v29
    v_and_b32 v71, 0xffff0000, v29
    v_pk_fma_f32 v[62:63], v[70:71], v[12:13], v[62:63] op_sel_hi:[1,0,1]
    v_lshlrev_b32_e64 v70, 16, v30
    v_and_b32 v71, 0xffff0000, v30
    v_pk_fma_f32 v[64:65], v[70:71], v[12:13], v[64:65] op_sel_hi:[1,0,1]
    v_lshlrev_b32_e64 v70, 16, v31
    v_and_b32 v71, 0xffff0000, v31
    v_pk_fma_f32 v[66:67], v[70:71], v[12:13], v[66:67] op_sel_hi:[1,0,1]
    s_waitcnt vmcnt(12)
    v_lshlrev_b32 v70, 16, v32
    v_and_b32 v71, 0xffff0000, v32
    v_pk_fma_f32 v[60:61], v[70:71], v[12:13], v[60:61] op_sel:[0,1,0] op_sel_hi:[1,1,1]
    v_lshlrev_b32_e64 v70, 16, v33
    v_and_b32 v71, 0xffff0000, v33
    v_pk_fma_f32 v[62:63], v[70:71], v[12:13], v[62:63] op_sel:[0,1,0] op_sel_hi:[1,1,1]
    v_lshlrev_b32_e64 v70, 16, v34
    v_and_b32 v71, 0xffff0000, v34
    v_pk_fma_f32 v[64:65], v[70:71], v[12:13], v[64:65] op_sel:[0,1,0] op_sel_hi:[1,1,1]
    v_lshlrev_b32_e64 v70, 16, v35
    v_and_b32 v71, 0xffff0000, v35
    v_pk_fma_f32 v[66:67], v[70:71], v[12:13], v[66:67] op_sel:[0,1,0] op_sel_hi:[1,1,1]
    s_waitcnt vmcnt(11)
    v_lshlrev_b32 v70, 16, v36
    v_and_b32 v71, 0xffff0000, v36
    v_pk_fma_f32 v[60:61], v[70:71], v[14:15], v[60:61] op_sel_hi:[1,0,1]
    v_lshlrev_b32_e64 v70, 16, v37
    v_and_b32 v71, 0xffff0000, v37
    v_pk_fma_f32 v[62:63], v[70:71], v[14:15], v[62:63] op_sel_hi:[1,0,1]
    v_lshlrev_b32_e64 v70, 16, v38
    v_and_b32 v71, 0xffff0000, v38
    v_pk_fma_f32 v[64:65], v[70:71], v[14:15], v[64:65] op_sel_hi:[1,0,1]
    v_lshlrev_b32_e64 v70, 16, v39
    v_and_b32 v71, 0xffff0000, v39
    v_pk_fma_f32 v[66:67], v[70:71], v[14:15], v[66:67] op_sel_hi:[1,0,1]
    s_waitcnt vmcnt(10)
    v_lshlrev_b32 v70, 16, v40
    v_and_b32 v71, 0xffff0000, v40
    v_pk_fma_f32 v[60:61], v[70:71], v[14:15], v[60:61] op_sel:[0,1,0] op_sel_hi:[1,1,1]
    v_lshlrev_b32_e64 v70, 16, v41
    v_and_b32 v71, 0xffff0000, v41
    v_pk_fma_f32 v[62:63], v[70:71], v[14:15], v[62:63] op_sel:[0,1,0] op_sel_hi:[1,1,1]
    v_lshlrev_b32_e64 v70, 16, v42
    v_and_b32 v71, 0xffff0000, v42
    v_pk_fma_f32 v[64:65], v[70:71], v[14:15], v[64:65] op_sel:[0,1,0] op_sel_hi:[1,1,1]
    v_lshlrev_b32_e64 v70, 16, v43
    v_and_b32 v71, 0xffff0000, v43
    v_pk_fma_f32 v[66:67], v[70:71], v[14:15], v[66:67] op_sel:[0,1,0] op_sel_hi:[1,1,1]
    s_waitcnt vmcnt(9)
    v_lshlrev_b32 v70, 16, v44
    v_and_b32 v71, 0xffff0000, v44
    v_pk_fma_f32 v[60:61], v[70:71], v[16:17], v[60:61] op_sel_hi:[1,0,1]
    v_lshlrev_b32_e64 v70, 16, v45
    v_and_b32 v71, 0xffff0000, v45
    v_pk_fma_f32 v[62:63], v[70:71], v[16:17], v[62:63] op_sel_hi:[1,0,1]
    v_lshlrev_b32_e64 v70, 16, v46
    v_and_b32 v71, 0xffff0000, v46
    v_pk_fma_f32 v[64:65], v[70:71], v[16:17], v[64:65] op_sel_hi:[1,0,1]
    v_lshlrev_b32_e64 v70, 16, v47
    v_and_b32 v71, 0xffff0000, v47
    v_pk_fma_f32 v[66:67], v[70:71], v[16:17], v[66:67] op_sel_hi:[1,0,1]
    s_waitcnt vmcnt(8)
    v_lshlrev_b32 v70, 16, v48
    v_and_b32 v71, 0xffff0000, v48
    v_pk_fma_f32 v[60:61], v[70:71], v[16:17], v[60:61] op_sel:[0,1,0] op_sel_hi:[1,1,1]
    v_lshlrev_b32_e64 v70, 16, v49
    v_and_b32 v71, 0xffff0000, v49
    v_pk_fma_f32 v[62:63], v[70:71], v[16:17], v[62:63] op_sel:[0,1,0] op_sel_hi:[1,1,1]
    v_lshlrev_b32_e64 v70, 16, v50
    v_and_b32 v71, 0xffff0000, v50
    v_pk_fma_f32 v[64:65], v[70:71], v[16:17], v[64:65] op_sel:[0,1,0] op_sel_hi:[1,1,1]
    v_lshlrev_b32_e64 v70, 16, v51
    v_and_b32 v71, 0xffff0000, v51
    v_pk_fma_f32 v[66:67], v[70:71], v[16:17], v[66:67] op_sel:[0,1,0] op_sel_hi:[1,1,1]
    s_waitcnt vmcnt(7)
    v_lshlrev_b32 v70, 16, v52
    v_and_b32 v71, 0xffff0000, v52
    v_pk_fma_f32 v[60:61], v[70:71], v[18:19], v[60:61] op_sel_hi:[1,0,1]
    v_lshlrev_b32_e64 v70, 16, v53
    v_and_b32 v71, 0xffff0000, v53
    v_pk_fma_f32 v[62:63], v[70:71], v[18:19], v[62:63] op_sel_hi:[1,0,1]
    v_lshlrev_b32_e64 v70, 16, v54
    v_and_b32 v71, 0xffff0000, v54
    v_pk_fma_f32 v[64:65], v[70:71], v[18:19], v[64:65] op_sel_hi:[1,0,1]
    v_lshlrev_b32_e64 v70, 16, v55
    v_and_b32 v71, 0xffff0000, v55
    v_pk_fma_f32 v[66:67], v[70:71], v[18:19], v[66:67] op_sel_hi:[1,0,1]
    s_waitcnt vmcnt(6)
    v_lshlrev_b32 v70, 16, v56
    v_and_b32 v71, 0xffff0000, v56
    v_pk_fma_f32 v[60:61], v[70:71], v[18:19], v[60:61] op_sel:[0,1,0] op_sel_hi:[1,1,1]
    v_lshlrev_b32_e64 v70, 16, v57
    v_and_b32 v71, 0xffff0000, v57
    v_pk_fma_f32 v[62:63], v[70:71], v[18:19], v[62:63] op_sel:[0,1,0] op_sel_hi:[1,1,1]
    v_lshlrev_b32_e64 v70, 16, v58
    v_and_b32 v71, 0xffff0000, v58
    v_pk_fma_f32 v[64:65], v[70:71], v[18:19], v[64:65] op_sel:[0,1,0] op_sel_hi:[1,1,1]
    v_lshlrev_b32_e64 v70, 16, v59
    v_and_b32 v71, 0xffff0000, v59
    v_pk_fma_f32 v[66:67], v[70:71], v[18:19], v[66:67] op_sel:[0,1,0] op_sel_hi:[1,1,1]
    v_add_f32_dpp v60, v60, v60 row_ror:8 row_mask:0xf bank_mask:0xf
    v_add_f32_dpp v61, v61, v61 row_ror:8 row_mask:0xf bank_mask:0xf
    v_add_f32_dpp v62, v62, v62 row_ror:8 row_mask:0xf bank_mask:0xf
    v_add_f32_dpp v63, v63, v63 row_ror:8 row_mask:0xf bank_mask:0xf
    v_add_f32_dpp v64, v64, v64 row_ror:8 row_mask:0xf bank_mask:0xf
    v_add_f32_dpp v65, v65, v65 row_ror:8 row_mask:0xf bank_mask:0xf
    v_add_f32_dpp v66, v66, v66 row_ror:8 row_mask:0xf bank_mask:0xf
    v_add_f32_dpp v67, v67, v67 row_ror:8 row_mask:0xf bank_mask:0xf
    v_mov_b32 v70, v60
    s_nop 1
    v_permlane16_swap_b32 v70, v60
    v_add_f32 v60, v60, v70
    v_mov_b32 v70, v60
    s_nop 1
    v_permlane32_swap_b32 v70, v60
    v_add_f32 v60, v60, v70
    v_mov_b32 v71, v61
    s_nop 1
    v_permlane16_swap_b32 v71, v61
    v_add_f32 v61, v61, v71
    v_mov_b32 v71, v61
    s_nop 1
    v_permlane32_swap_b32 v71, v61
    v_add_f32 v61, v61, v71
    v_mov_b32 v70, v62
    s_nop 1
    v_permlane16_swap_b32 v70, v62
    v_add_f32 v62, v62, v70
    v_mov_b32 v70, v62
    s_nop 1
    v_permlane32_swap_b32 v70, v62
    v_add_f32 v62, v62, v70
    v_mov_b32 v71, v63
    s_nop 1
    v_permlane16_swap_b32 v71, v63
    v_add_f32 v63, v63, v71
    v_mov_b32 v71, v63
    s_nop 1
    v_permlane32_swap_b32 v71, v63
    v_add_f32 v63, v63, v71
    v_mov_b32 v70, v64
    s_nop 1
    v_permlane16_swap_b32 v70, v64
    v_add_f32 v64, v64, v70
    v_mov_b32 v70, v64
    s_nop 1
    v_permlane32_swap_b32 v70, v64
    v_add_f32 v64, v64, v70
    v_mov_b32 v71, v65
    s_nop 1
    v_permlane16_swap_b32 v71, v65
    v_add_f32 v65, v65, v71
    v_mov_b32 v71, v65
    s_nop 1
    v_permlane32_swap_b32 v71, v65
    v_add_f32 v65, v65, v71
    v_mov_b32 v70, v66
    s_nop 1
    v_permlane16_swap_b32 v70, v66
    v_add_f32 v66, v66, v70
    v_mov_b32 v70, v66
    s_nop 1
    v_permlane32_swap_b32 v70, v66
    v_add_f32 v66, v66, v70
    v_mov_b32 v71, v67
    s_nop 1
    v_permlane16_swap_b32 v71, v67
    v_add_f32 v67, v67, v71
    v_mov_b32 v71, v67
    s_nop 1
    v_permlane32_swap_b32 v71, v67
    v_add_f32 v67, v67, v71
    v_and_b32 v3, 7, v1
    s_lshl_b32 s5, s4, 8
    v_lshlrev_b32_e64 v6, 5, v3
    v_add_u32 v6, s5, v6
    s_mov_b64 s[36:37], exec
    s_mov_b64 exec, 0xff
    ds_write_b128 v6, v[60:63]
    ds_write_b128 v6, v[64:67] offset:16
    s_mov_b64 exec, s[36:37]
    s_waitcnt lgkmcnt(0)
    s_barrier
    s_cmp_eq_u32 s4, 0
    s_cbranch_scc0 L_w0_35
    v_lshlrev_b32 v6, 2, v1
    ds_read_b32 v70, v6 offset:0
    ds_read_b32 v71, v6 offset:256
    ds_read_b32 v72, v6 offset:512
    ds_read_b32 v73, v6 offset:768
    s_mul_i32 s32, s32, 15360
    s_lshl_b32 s33, s33, 8
    s_add_u32 s32, s32, s33
    s_add_u32 s32, s32, 5242880
    s_waitcnt lgkmcnt(0)
    v_add_f32 v70, v70, v71
    v_add_f32_e64 v72, v72, v73
    v_add_f32 v70, v70, v72
    buffer_store_dword v70, v6, s[8:11], s32 offen sc1
L_w0_35:
    s_barrier
    s_and_b32 s35, s2, 7
    s_add_u32 s35, s35, 8
    s_cmp_eq_u32 s4, 0
    s_cbranch_scc0 L_w0_36
    s_mov_b32 s28, s92
    s_mov_b32 s29, s93
    s_mov_b32 s30, 0x100
    s_mov_b32 s31, 0x00020000
    v_mov_b32 v10, 0
    s_mov_b64 s[36:37], exec
    s_mov_b64 exec, 0x1
    s_mov_b32 s97, 0
L_poll_37:
    buffer_load_dword v11, v10, s[28:31], 0 offen sc1
    s_waitcnt vmcnt(0)
    v_cmp_eq_u32 vcc, 0, v11
    s_nop 0
    s_cbranch_vccz L_polld_38
    s_add_u32 s97, s97, 1
    s_cmp_lt_u32 s97, 262144
    s_cbranch_scc1 L_poll_37
L_polld_38:
    s_mov_b64 exec, s[36:37]
L_w0_36:
    s_waitcnt vmcnt(0)
    s_barrier
    s_cmp_eq_u32 s4, 0
    s_cbranch_scc0 L_w0_39
    s_lshl_b32 s96, s35, 7
    s_add_u32 s96, s96, 5373952
    v_mov_b32 v10, 1
    v_mov_b32 v11, 0
    s_mov_b64 s[36:37], exec
    s_mov_b64 exec, 1
    buffer_atomic_add v10, v11, s[8:11], s96 offen sc1
    s_mov_b64 exec, s[36:37]
L_w0_39:
    s_sub_u32 s45, s2, 160
    s_and_b32 s44, s45, 1
    s_lshr_b32 s45, s45, 1
    s_cmp_eq_u32 s44, 0
    s_cselect_b32 s12, s80, s82
    s_cselect_b32 s13, s81, s83
    s_mov_b32 s14, 0x21c000
    s_mov_b32 s15, 0x00020000
    v_lshrrev_b32_e64 v2, 3, v1
    v_mul_u32_u24 v2, 3456, v2
    v_bfe_u32 v3, v1, 4, 1
    v_lshlrev_b32 v3, 2, v3
    v_and_b32 v4, 7, v1
    v_xor_b32_e64 v3, v3, v4
    v_lshl_add_u32 v2, v3, 4, v2
    s_mul_i32 s5, s4, 552960
    s_lshl_b32 s6, s45, 7
    s_add_u32 s5, s5, s6
    s_mul_i32 s6, s4, 20480
    s_add_u32 s6, s6, 8192
    s_add_u32 s5, s5, 165888
    s_add_u32 m0, s6, 6144
    s_nop 0
    buffer_load_dwordx4 v2, s[12:15], s5 offen nt lds
    s_add_u32 s5, s5, 27648
    s_add_u32 m0, s6, 7168
    s_nop 0
    buffer_load_dwordx4 v2, s[12:15], s5 offen nt lds
    s_add_u32 s5, s5, 27648
    s_add_u32 m0, s6, 8192
    s_nop 0
    buffer_load_dwordx4 v2, s[12:15], s5 offen nt lds
    s_add_u32 s5, s5, 27648
    s_add_u32 m0, s6, 9216
    s_nop 0
    buffer_load_dwordx4 v2, s[12:15], s5 offen nt lds
    s_add_u32 s5, s5, 27648
    s_add_u32 m0, s6, 10240
    s_nop 0
    buffer_load_dwordx4 v2, s[12:15], s5 offen nt lds
    s_add_u32 s5, s5, 27648
    s_add_u32 m0, s6, 11264
    s_nop 0
    buffer_load_dwordx4 v2, s[12:15], s5 offen nt lds
    s_add_u32 s5, s5, 27648
    s_add_u32 m0, s6, 12288
    s_nop 0
    buffer_load_dwordx4 v2, s[12:15], s5 offen nt lds
    s_add_u32 s5, s5, 27648
    s_add_u32 m0, s6, 13312
    s_nop 0
    buffer_load_dwordx4 v2, s[12:15], s5 offen nt lds
    s_add_u32 s5, s5, 27648
    s_add_u32 m0, s6, 14336
    s_nop 0
    buffer_load_dwordx4 v2, s[12:15], s5 offen nt lds
    s_add_u32 s5, s5, 27648
    s_add_u32 m0, s6, 15360
    s_nop 0
    buffer_load_dwordx4 v2, s[12:15], s5 offen nt lds
    s_add_u32 s5, s5, 27648
    s_add_u32 m0, s6, 16384
    s_nop 0
    buffer_load_dwordx4 v2, s[12:15], s5 offen nt lds
    s_add_u32 s5, s5, 27648
    s_add_u32 m0, s6, 17408
    s_nop 0
    buffer_load_dwordx4 v2, s[12:15], s5 offen nt lds
    s_add_u32 s5, s5, 27648
    s_add_u32 m0, s6, 18432
    s_nop 0
    buffer_load_dwordx4 v2, s[12:15], s5 offen nt lds
    s_add_u32 s5, s5, 27648
    s_add_u32 m0, s6, 19456
    s_nop 0
    buffer_load_dwordx4 v2, s[12:15], s5 offen nt lds
    s_cmp_eq_u32 s4, 0
    s_cbranch_scc0 L_w0_40
    v_mov_b32 v10, 5373952
    v_mov_b32 v11, 0
    v_lshlrev_b32 v12, 7, v1
    v_add_u32 v10, 5374976, v12
    v_mov_b32 v11, 15
    s_mov_b64 s[36:37], exec
    s_mov_b64 exec, 0xff
    s_mov_b32 s97, 0
L_poll_41:
    buffer_load_dword v12, v10, s[8:11], 0 offen sc1
    s_waitcnt vmcnt(0)
    v_cmp_lt_u32 vcc, v12, v11
    s_nop 0
    s_cbranch_vccz L_polld_42
    s_add_u32 s97, s97, 1
    s_cmp_lt_u32 s97, 262144
    s_cbranch_scc1 L_poll_41
L_polld_42:
    s_mov_b64 exec, s[36:37]
L_w0_40:
    s_barrier
    v_lshlrev_b32 v5, 2, v0
    s_mov_b32 s5, 5250560
    buffer_load_dword v10, v5, s[8:11], s5 offen sc1
    buffer_load_dword v16, v5, s[8:11], s5 offen offset:2560 sc1
    s_mov_b32 s5, 5265920
    buffer_load_dword v11, v5, s[8:11], s5 offen sc1
    buffer_load_dword v17, v5, s[8:11], s5 offen offset:2560 sc1
    s_mov_b32 s5, 5251584
    buffer_load_dword v12, v5, s[8:11], s5 offen sc1
    buffer_load_dword v18, v5, s[8:11], s5 offen offset:2560 sc1
    s_mov_b32 s5, 5266944
    buffer_load_dword v13, v5, s[8:11], s5 offen sc1
    buffer_load_dword v19, v5, s[8:11], s5 offen offset:2560 sc1
    s_mov_b32 s5, 5252608
    buffer_load_dword v14, v5, s[8:11], s5 offen sc1
    buffer_load_dword v20, v5, s[8:11], s5 offen offset:2560 sc1
    s_mov_b32 s5, 5267968
    buffer_load_dword v15, v5, s[8:11], s5 offen sc1
    buffer_load_dword v21, v5, s[8:11], s5 offen offset:2560 sc1
    s_cmp_eq_u32 s2, 160
    s_cbranch_scc0 L_gbskip_43
    s_nop 0
    s_mov_b32 s5, 5255680
    buffer_load_dword v22, v5, s[8:11], s5 offen sc1
    s_mov_b32 s5, 5271040
    buffer_load_dword v23, v5, s[8:11], s5 offen sc1
    s_mov_b32 s5, 5256704
    buffer_load_dword v24, v5, s[8:11], s5 offen sc1
    s_mov_b32 s5, 5272064
    buffer_load_dword v25, v5, s[8:11], s5 offen sc1
    s_mov_b32 s5, 5257728
    buffer_load_dword v26, v5, s[8:11], s5 offen sc1
    s_mov_b32 s5, 5273088
    buffer_load_dword v27, v5, s[8:11], s5 offen sc1
    s_waitcnt vmcnt(0)
    v_add_f32 v22, v22, v23
    v_cvt_pk_bf16_f32 v22, v22, v22
    v_lshlrev_b32 v22, 16, v22
    v_add_f32 v24, v24, v25
    v_cvt_pk_bf16_f32 v24, v24, v24
    v_lshlrev_b32 v24, 16, v24
    v_add_f32 v26, v26, v27
    v_cvt_pk_bf16_f32 v26, v26, v26
    v_lshlrev_b32_e64 v26, 16, v26
    s_mov_b32 s5, 5308416
    buffer_store_dword v22, v5, s[8:11], s5 offen sc1
    buffer_store_dword v24, v5, s[8:11], s5 offen offset:1024 sc1
    s_mov_b64 s[36:37], exec
    v_cmp_gt_u32 vcc, 128, v0
    s_nop 0
    s_and_b64 exec, exec, vcc
    s_cbranch_execz L_gb2_44
    buffer_store_dword v26, v5, s[8:11], s5 offen offset:2048 sc1
L_gb2_44:
    s_mov_b64 exec, s[36:37]
L_gbskip_43:
    s_waitcnt vmcnt(0)
    v_add_f32_e64 v10, v10, v11
    v_cvt_pk_bf16_f32 v10, v10, v10
    v_lshlrev_b32 v10, 16, v10
    v_add_f32 v16, v16, v17
    v_cvt_pk_bf16_f32 v16, v16, v16
    v_lshlrev_b32 v16, 16, v16
    v_add_f32 v16, 1.0, v16
    v_cvt_pk_bf16_f32 v16, v16, v16
    v_lshlrev_b32 v16, 16, v16
    v_add_f32 v12, v12, v13
    v_cvt_pk_bf16_f32 v12, v12, v12
    v_lshlrev_b32 v12, 16, v12
    v_add_f32 v18, v18, v19
    v_cvt_pk_bf16_f32 v18, v18, v18
    v_lshlrev_b32 v18, 16, v18
    v_add_f32 v18, 1.0, v18
    v_cvt_pk_bf16_f32 v18, v18, v18
    v_lshlrev_b32 v18, 16, v18
    v_add_f32 v14, v14, v15
    v_cvt_pk_bf16_f32 v14, v14, v14
    v_lshlrev_b32 v14, 16, v14
    v_add_f32 v20, v20, v21
    v_cvt_pk_bf16_f32 v20, v20, v20
    v_lshlrev_b32 v20, 16, v20
    v_add_f32 v20, 1.0, v20
    v_cvt_pk_bf16_f32 v20, v20, v20
    v_lshlrev_b32_e64 v20, 16, v20
    ds_write_b32 v5, v10 offset:3584
    ds_write_b32 v5, v16 offset:1024
    ds_write_b32 v5, v12 offset:4608
    ds_write_b32 v5, v18 offset:2048
    s_mov_b64 s[36:37], exec
    v_cmp_gt_u32 vcc, 128, v0
    s_nop 0
    s_and_b64 exec, exec, vcc
    s_cbranch_execz L_wp_skip_45
    ds_write_b32 v5, v14 offset:5632
    ds_write_b32 v5, v20 offset:3072
L_wp_skip_45:
    s_mov_b64 exec, s[36:37]
    v_bfe_u32 v2, v1, 2, 2
    v_lshrrev_b32 v3, 4, v1
    v_and_b32 v4, 3, v1
    v_lshlrev_b32 v6, 5, v3
    v_lshl_add_u32 v6, v4, 3, v6
    v_lshrrev_b32 v7, 1, v2
    v_lshlrev_b32 v7, 6, v7
    v_xor_b32 v6, v6, v7
    v_lshl_add_u32 v6, v2, 7, v6
    s_lshl_b32 s5, s4, 10
    s_add_u32 s5, s5, 8192
    v_add_u32 v6, s5, v6
    s_lshl_b32 s5, s4, 5
    v_mov_b32_e64 v7, s5
    v_mul_u32_u24 v8, 41984, v3
    v_and_b32_e64 v9, 15, v1
    v_lshl_add_u32 v8, v9, 4, v8
    s_mul_i32 s50, s45, 167936
    s_lshl_b32 s5, s44, 8
    s_add_u32 s50, s50, s5
    s_add_u32 s50, s50, 6291456
    s_add_u32 s52, s50, 40960
    s_lshl_b32 s5, s4, 9
    s_add_u32 s50, s50, s5
    v_mov_b32 v30, 0
    v_mov_b32 v31, 0
    v_mov_b32_e64 v32, 0
    v_mov_b32 v33, 0
    s_waitcnt lgkmcnt(0)
    s_barrier
    s_mov_b32 s51, 0
    ds_read_b64_tr_b16 v[36:37], v6 offset:0
    ds_read_b64_tr_b16 v[38:39], v6 offset:512
    ds_read_b128 v[40:43], v7 offset:1024
    ds_read_b128 v[44:47], v7 offset:1040
    ds_read_b128 v[48:51], v7 offset:3584
    ds_read_b128 v[52:55], v7 offset:3600
L_wp_46:
    ds_read_b64_tr_b16 v[80:81], v6 offset:4096
    ds_read_b64_tr_b16 v[82:83], v6 offset:4608
    ds_read_b128 v[84:87], v7 offset:1152
    ds_read_b128 v[88:91], v7 offset:1168
    ds_read_b128 v[92:95], v7 offset:3712
    ds_read_b128 v[96:99], v7 offset:3728
    s_waitcnt lgkmcnt(6)
    v_lshlrev_b32 v56, 16, v36
    v_and_b32 v57, 0xffff0000, v36
    v_lshlrev_b32_e64 v58, 16, v37
    v_and_b32 v59, 0xffff0000, v37
    v_lshlrev_b32_e64 v60, 16, v38
    v_and_b32 v61, 0xffff0000, v38
    v_lshlrev_b32_e64 v62, 16, v39
    v_and_b32 v63, 0xffff0000, v39
    v_pk_mul_f32 v[64:65], v[56:57], v[40:41]
    v_pk_fma_f32 v[32:33], v[56:57], v[48:49], v[32:33]
    v_pk_mul_f32 v[66:67], v[58:59], v[42:43]
    v_pk_fma_f32 v[32:33], v[58:59], v[50:51], v[32:33]
    v_pk_mul_f32 v[68:69], v[60:61], v[44:45]
    v_pk_fma_f32 v[32:33], v[60:61], v[52:53], v[32:33]
    v_pk_mul_f32 v[70:71], v[62:63], v[46:47]
    v_pk_fma_f32 v[32:33], v[62:63], v[54:55], v[32:33]
    v_cvt_pk_bf16_f32 v72, v64, v65
    v_pk_add_f32 v[30:31], v[30:31], v[64:65]
    v_cvt_pk_bf16_f32 v73, v66, v67
    v_pk_add_f32 v[30:31], v[30:31], v[66:67]
    v_cvt_pk_bf16_f32 v74, v68, v69
    v_pk_add_f32 v[30:31], v[30:31], v[68:69]
    v_cvt_pk_bf16_f32 v75, v70, v71
    v_pk_add_f32 v[30:31], v[30:31], v[70:71]
    buffer_store_dwordx4 v[72:75], v8, s[8:11], s50 offen sc1
    s_add_u32 s50, s50, 2048
    ds_read_b64_tr_b16 v[36:37], v6 offset:8192
    ds_read_b64_tr_b16 v[38:39], v6 offset:8704
    ds_read_b128 v[40:43], v7 offset:1280
    ds_read_b128 v[44:47], v7 offset:1296
    ds_read_b128 v[48:51], v7 offset:3840
    ds_read_b128 v[52:55], v7 offset:3856
    v_add_u32 v6, 8192, v6
    v_add_u32 v7, 256, v7
    s_waitcnt lgkmcnt(6)
    v_lshlrev_b32 v56, 16, v80
    v_and_b32 v57, 0xffff0000, v80
    v_lshlrev_b32_e64 v58, 16, v81
    v_and_b32 v59, 0xffff0000, v81
    v_lshlrev_b32_e64 v60, 16, v82
    v_and_b32 v61, 0xffff0000, v82
    v_lshlrev_b32_e64 v62, 16, v83
    v_and_b32 v63, 0xffff0000, v83
    v_pk_mul_f32 v[64:65], v[56:57], v[84:85]
    v_pk_fma_f32 v[32:33], v[56:57], v[92:93], v[32:33]
    v_pk_mul_f32 v[66:67], v[58:59], v[86:87]
    v_pk_fma_f32 v[32:33], v[58:59], v[94:95], v[32:33]
    v_pk_mul_f32 v[68:69], v[60:61], v[88:89]
    v_pk_fma_f32 v[32:33], v[60:61], v[96:97], v[32:33]
    v_pk_mul_f32 v[70:71], v[62:63], v[90:91]
    v_pk_fma_f32 v[32:33], v[62:63], v[98:99], v[32:33]
    v_cvt_pk_bf16_f32 v76, v64, v65
    v_pk_add_f32 v[30:31], v[30:31], v[64:65]
    v_cvt_pk_bf16_f32 v77, v66, v67
    v_pk_add_f32 v[30:31], v[30:31], v[66:67]
    v_cvt_pk_bf16_f32 v78, v68, v69
    v_pk_add_f32 v[30:31], v[30:31], v[68:69]
    v_cvt_pk_bf16_f32 v79, v70, v71
    v_pk_add_f32 v[30:31], v[30:31], v[70:71]
    buffer_store_dwordx4 v[76:79], v8, s[8:11], s50 offen sc1
    s_add_u32 s50, s50, 2048
    s_add_u32 s51, s51, 1
    s_cmp_lt_u32 s51, 10
    s_cbranch_scc1 L_wp_46
    s_waitcnt lgkmcnt(0)
    v_add_f32 v30, v30, v31
    v_add_f32 v32, v32, v33
    v_lshlrev_b32_e64 v5, 2, v0
    ds_write_b32 v5, v30 offset:6144
    ds_write_b32 v5, v32 offset:7168
    s_waitcnt lgkmcnt(0)
    s_barrier
    s_cmp_eq_u32 s4, 0
    s_cbranch_scc0 L_w0_47
    v_lshlrev_b32_e64 v5, 2, v1
    ds_read_b32 v56, v5 offset:6144
    ds_read_b32 v60, v5 offset:7168
    ds_read_b32 v57, v5 offset:6400
    ds_read_b32 v61, v5 offset:7424
    ds_read_b32 v58, v5 offset:6656
    ds_read_b32 v62, v5 offset:7680
    ds_read_b32 v59, v5 offset:6912
    ds_read_b32 v63, v5 offset:7936
    s_waitcnt lgkmcnt(0)
    v_add_f32 v56, v56, v57
    v_add_f32 v58, v58, v59
    v_add_f32 v56, v56, v58
    v_add_f32 v60, v60, v61
    v_add_f32 v62, v62, v63
    v_add_f32_e64 v60, v60, v62
    v_cvt_pk_bf16_f32 v64, v56, v56
    v_lshlrev_b32 v64, 16, v64
    v_sub_f32 v65, v56, v64
    v_cvt_pk_bf16_f32 v66, v60, v60
    v_lshlrev_b32 v66, 16, v66
    v_sub_f32 v67, v60, v66
    v_cvt_pk_bf16_f32 v72, v64, v64
    v_cvt_pk_bf16_f32 v73, v65, v66
    v_cvt_pk_bf16_f32 v74, v66, v67
    v_mov_b32_e64 v75, 0
    buffer_store_dwordx4 v[72:75], v8, s[8:11], s52 offen sc1
    v_mov_b32 v76, 0
    v_mov_b32 v77, 0
    v_mov_b32 v78, 0
    v_mov_b32 v79, 0
    buffer_store_dwordx4 v[76:79], v8, s[8:11], s52 offen offset:512 sc1
L_w0_47:
    s_sub_u32 s35, s2, 160
    s_and_b32 s35, s35, 7
    s_add_u32 s35, s35, 24
    s_waitcnt vmcnt(0)
    s_barrier
    s_cmp_eq_u32 s4, 0
    s_cbranch_scc0 L_w0_48
    s_lshl_b32 s96, s35, 7
    s_add_u32 s96, s96, 5373952
    v_mov_b32 v2, 1
    v_mov_b32_e64 v3, 0
    s_mov_b64 s[36:37], exec
    s_mov_b64 exec, 1
    buffer_atomic_add v2, v3, s[8:11], s96 offen sc1
    s_mov_b64 exec, s[36:37]
L_w0_48:
    s_branch L_pdone_33
L_wd_32:
    s_cmp_lt_u32 s2, 216
    s_cbranch_scc1 L_idle_34
    s_waitcnt vmcnt(10)
    v_lshlrev_b32_e64 v10, 16, v10
    v_mul_f32 v70, 0xbfb8aa3b, v10
    v_exp_f32 v70, v70
    s_nop 0
    v_add_f32 v70, 1.0, v70
    v_rcp_f32 v70, v70
    s_nop 0
    v_mul_f32 v10, v10, v70
    v_cvt_pk_bf16_f32 v10, v10, v10
    v_lshlrev_b32 v10, 16, v10
    v_lshlrev_b32 v11, 16, v11
    v_mul_f32 v70, 0xbfb8aa3b, v11
    v_exp_f32 v70, v70
    s_nop 0
    v_add_f32 v70, 1.0, v70
    v_rcp_f32 v70, v70
    s_nop 0
    v_mul_f32 v11, v11, v70
    v_cvt_pk_bf16_f32 v11, v11, v11
    v_lshlrev_b32 v11, 16, v11
    v_lshlrev_b32 v12, 16, v12
    v_mul_f32 v70, 0xbfb8aa3b, v12
    v_exp_f32 v70, v70
    s_nop 0
    v_add_f32 v70, 1.0, v70
    v_rcp_f32 v70, v70
    s_nop 0
    v_mul_f32 v12, v12, v70
    v_cvt_pk_bf16_f32 v12, v12, v12
    v_lshlrev_b32 v12, 16, v12
    v_lshlrev_b32 v13, 16, v13
    v_mul_f32 v70, 0xbfb8aa3b, v13
    v_exp_f32 v70, v70
    s_nop 0
    v_add_f32 v70, 1.0, v70
    v_rcp_f32 v70, v70
    s_nop 0
    v_mul_f32 v13, v13, v70
    v_cvt_pk_bf16_f32 v13, v13, v13
    v_lshlrev_b32 v13, 16, v13
    v_lshlrev_b32 v14, 16, v14
    v_mul_f32 v70, 0xbfb8aa3b, v14
    v_exp_f32 v70, v70
    s_nop 0
    v_add_f32 v70, 1.0, v70
    v_rcp_f32 v70, v70
    s_nop 0
    v_mul_f32 v14, v14, v70
    v_cvt_pk_bf16_f32 v14, v14, v14
    v_lshlrev_b32 v14, 16, v14
    v_lshlrev_b32 v15, 16, v15
    v_mul_f32 v70, 0xbfb8aa3b, v15
    v_exp_f32 v70, v70
    s_nop 0
    v_add_f32 v70, 1.0, v70
    v_rcp_f32 v70, v70
    s_nop 0
    v_mul_f32 v15, v15, v70
    v_cvt_pk_bf16_f32 v15, v15, v15
    v_lshlrev_b32 v15, 16, v15
    v_lshlrev_b32 v16, 16, v16
    v_mul_f32 v70, 0xbfb8aa3b, v16
    v_exp_f32 v70, v70
    s_nop 0
    v_add_f32 v70, 1.0, v70
    v_rcp_f32 v70, v70
    s_nop 0
    v_mul_f32 v16, v16, v70
    v_cvt_pk_bf16_f32 v16, v16, v16
    v_lshlrev_b32 v16, 16, v16
    v_lshlrev_b32 v17, 16, v17
    v_mul_f32 v70, 0xbfb8aa3b, v17
    v_exp_f32 v70, v70
    s_nop 0
    v_add_f32 v70, 1.0, v70
    v_rcp_f32 v70, v70
    s_nop 0
    v_mul_f32 v17, v17, v70
    v_cvt_pk_bf16_f32 v17, v17, v17
    v_lshlrev_b32 v17, 16, v17
    v_lshlrev_b32 v18, 16, v18
    v_mul_f32 v70, 0xbfb8aa3b, v18
    v_exp_f32 v70, v70
    s_nop 0
    v_add_f32 v70, 1.0, v70
    v_rcp_f32 v70, v70
    s_nop 0
    v_mul_f32 v18, v18, v70
    v_cvt_pk_bf16_f32 v18, v18, v18
    v_lshlrev_b32 v18, 16, v18
    v_lshlrev_b32 v19, 16, v19
    v_mul_f32 v70, 0xbfb8aa3b, v19
    v_exp_f32 v70, v70
    s_nop 0
    v_add_f32 v70, 1.0, v70
    v_rcp_f32 v70, v70
    s_nop 0
    v_mul_f32 v19, v19, v70
    v_cvt_pk_bf16_f32 v19, v19, v19
    v_lshlrev_b32 v19, 16, v19
    s_waitcnt vmcnt(9)
    v_lshlrev_b32_e64 v70, 16, v20
    v_and_b32 v71, 0xffff0000, v20
    v_pk_mul_f32 v[60:61], v[70:71], v[10:11] op_sel_hi:[1,0]
    v_lshlrev_b32_e64 v70, 16, v21
    v_and_b32 v71, 0xffff0000, v21
    v_pk_mul_f32 v[62:63], v[70:71], v[10:11] op_sel_hi:[1,0]
    v_lshlrev_b32_e64 v70, 16, v22
    v_and_b32 v71, 0xffff0000, v22
    v_pk_mul_f32 v[64:65], v[70:71], v[10:11] op_sel_hi:[1,0]
    v_lshlrev_b32_e64 v70, 16, v23
    v_and_b32 v71, 0xffff0000, v23
    v_pk_mul_f32 v[66:67], v[70:71], v[10:11] op_sel_hi:[1,0]
    s_waitcnt vmcnt(8)
    v_lshlrev_b32 v70, 16, v24
    v_and_b32 v71, 0xffff0000, v24
    v_pk_fma_f32 v[60:61], v[70:71], v[10:11], v[60:61] op_sel:[0,1,0] op_sel_hi:[1,1,1]
    v_lshlrev_b32_e64 v70, 16, v25
    v_and_b32 v71, 0xffff0000, v25
    v_pk_fma_f32 v[62:63], v[70:71], v[10:11], v[62:63] op_sel:[0,1,0] op_sel_hi:[1,1,1]
    v_lshlrev_b32_e64 v70, 16, v26
    v_and_b32 v71, 0xffff0000, v26
    v_pk_fma_f32 v[64:65], v[70:71], v[10:11], v[64:65] op_sel:[0,1,0] op_sel_hi:[1,1,1]
    v_lshlrev_b32_e64 v70, 16, v27
    v_and_b32 v71, 0xffff0000, v27
    v_pk_fma_f32 v[66:67], v[70:71], v[10:11], v[66:67] op_sel:[0,1,0] op_sel_hi:[1,1,1]
    s_waitcnt vmcnt(7)
    v_lshlrev_b32 v70, 16, v28
    v_and_b32 v71, 0xffff0000, v28
    v_pk_fma_f32 v[60:61], v[70:71], v[12:13], v[60:61] op_sel_hi:[1,0,1]
    v_lshlrev_b32_e64 v70, 16, v29
    v_and_b32 v71, 0xffff0000, v29
    v_pk_fma_f32 v[62:63], v[70:71], v[12:13], v[62:63] op_sel_hi:[1,0,1]
    v_lshlrev_b32_e64 v70, 16, v30
    v_and_b32 v71, 0xffff0000, v30
    v_pk_fma_f32 v[64:65], v[70:71], v[12:13], v[64:65] op_sel_hi:[1,0,1]
    v_lshlrev_b32_e64 v70, 16, v31
    v_and_b32 v71, 0xffff0000, v31
    v_pk_fma_f32 v[66:67], v[70:71], v[12:13], v[66:67] op_sel_hi:[1,0,1]
    s_waitcnt vmcnt(6)
    v_lshlrev_b32 v70, 16, v32
    v_and_b32 v71, 0xffff0000, v32
    v_pk_fma_f32 v[60:61], v[70:71], v[12:13], v[60:61] op_sel:[0,1,0] op_sel_hi:[1,1,1]
    v_lshlrev_b32_e64 v70, 16, v33
    v_and_b32 v71, 0xffff0000, v33
    v_pk_fma_f32 v[62:63], v[70:71], v[12:13], v[62:63] op_sel:[0,1,0] op_sel_hi:[1,1,1]
    v_lshlrev_b32_e64 v70, 16, v34
    v_and_b32 v71, 0xffff0000, v34
    v_pk_fma_f32 v[64:65], v[70:71], v[12:13], v[64:65] op_sel:[0,1,0] op_sel_hi:[1,1,1]
    v_lshlrev_b32_e64 v70, 16, v35
    v_and_b32 v71, 0xffff0000, v35
    v_pk_fma_f32 v[66:67], v[70:71], v[12:13], v[66:67] op_sel:[0,1,0] op_sel_hi:[1,1,1]
    s_waitcnt vmcnt(5)
    v_lshlrev_b32 v70, 16, v36
    v_and_b32 v71, 0xffff0000, v36
    v_pk_fma_f32 v[60:61], v[70:71], v[14:15], v[60:61] op_sel_hi:[1,0,1]
    v_lshlrev_b32_e64 v70, 16, v37
    v_and_b32 v71, 0xffff0000, v37
    v_pk_fma_f32 v[62:63], v[70:71], v[14:15], v[62:63] op_sel_hi:[1,0,1]
    v_lshlrev_b32_e64 v70, 16, v38
    v_and_b32 v71, 0xffff0000, v38
    v_pk_fma_f32 v[64:65], v[70:71], v[14:15], v[64:65] op_sel_hi:[1,0,1]
    v_lshlrev_b32_e64 v70, 16, v39
    v_and_b32 v71, 0xffff0000, v39
    v_pk_fma_f32 v[66:67], v[70:71], v[14:15], v[66:67] op_sel_hi:[1,0,1]
    s_waitcnt vmcnt(4)
    v_lshlrev_b32 v70, 16, v40
    v_and_b32 v71, 0xffff0000, v40
    v_pk_fma_f32 v[60:61], v[70:71], v[14:15], v[60:61] op_sel:[0,1,0] op_sel_hi:[1,1,1]
    v_lshlrev_b32_e64 v70, 16, v41
    v_and_b32 v71, 0xffff0000, v41
    v_pk_fma_f32 v[62:63], v[70:71], v[14:15], v[62:63] op_sel:[0,1,0] op_sel_hi:[1,1,1]
    v_lshlrev_b32_e64 v70, 16, v42
    v_and_b32 v71, 0xffff0000, v42
    v_pk_fma_f32 v[64:65], v[70:71], v[14:15], v[64:65] op_sel:[0,1,0] op_sel_hi:[1,1,1]
    v_lshlrev_b32_e64 v70, 16, v43
    v_and_b32 v71, 0xffff0000, v43
    v_pk_fma_f32 v[66:67], v[70:71], v[14:15], v[66:67] op_sel:[0,1,0] op_sel_hi:[1,1,1]
    s_waitcnt vmcnt(3)
    v_lshlrev_b32 v70, 16, v44
    v_and_b32 v71, 0xffff0000, v44
    v_pk_fma_f32 v[60:61], v[70:71], v[16:17], v[60:61] op_sel_hi:[1,0,1]
    v_lshlrev_b32_e64 v70, 16, v45
    v_and_b32 v71, 0xffff0000, v45
    v_pk_fma_f32 v[62:63], v[70:71], v[16:17], v[62:63] op_sel_hi:[1,0,1]
    v_lshlrev_b32_e64 v70, 16, v46
    v_and_b32 v71, 0xffff0000, v46
    v_pk_fma_f32 v[64:65], v[70:71], v[16:17], v[64:65] op_sel_hi:[1,0,1]
    v_lshlrev_b32_e64 v70, 16, v47
    v_and_b32 v71, 0xffff0000, v47
    v_pk_fma_f32 v[66:67], v[70:71], v[16:17], v[66:67] op_sel_hi:[1,0,1]
    s_waitcnt vmcnt(2)
    v_lshlrev_b32 v70, 16, v48
    v_and_b32 v71, 0xffff0000, v48
    v_pk_fma_f32 v[60:61], v[70:71], v[16:17], v[60:61] op_sel:[0,1,0] op_sel_hi:[1,1,1]
    v_lshlrev_b32_e64 v70, 16, v49
    v_and_b32 v71, 0xffff0000, v49
    v_pk_fma_f32 v[62:63], v[70:71], v[16:17], v[62:63] op_sel:[0,1,0] op_sel_hi:[1,1,1]
    v_lshlrev_b32_e64 v70, 16, v50
    v_and_b32 v71, 0xffff0000, v50
    v_pk_fma_f32 v[64:65], v[70:71], v[16:17], v[64:65] op_sel:[0,1,0] op_sel_hi:[1,1,1]
    v_lshlrev_b32_e64 v70, 16, v51
    v_and_b32 v71, 0xffff0000, v51
    v_pk_fma_f32 v[66:67], v[70:71], v[16:17], v[66:67] op_sel:[0,1,0] op_sel_hi:[1,1,1]
    s_waitcnt vmcnt(1)
    v_lshlrev_b32 v70, 16, v52
    v_and_b32 v71, 0xffff0000, v52
    v_pk_fma_f32 v[60:61], v[70:71], v[18:19], v[60:61] op_sel_hi:[1,0,1]
    v_lshlrev_b32_e64 v70, 16, v53
    v_and_b32 v71, 0xffff0000, v53
    v_pk_fma_f32 v[62:63], v[70:71], v[18:19], v[62:63] op_sel_hi:[1,0,1]
    v_lshlrev_b32_e64 v70, 16, v54
    v_and_b32 v71, 0xffff0000, v54
    v_pk_fma_f32 v[64:65], v[70:71], v[18:19], v[64:65] op_sel_hi:[1,0,1]
    v_lshlrev_b32_e64 v70, 16, v55
    v_and_b32 v71, 0xffff0000, v55
    v_pk_fma_f32 v[66:67], v[70:71], v[18:19], v[66:67] op_sel_hi:[1,0,1]
    s_waitcnt vmcnt(0)
    v_lshlrev_b32 v70, 16, v56
    v_and_b32 v71, 0xffff0000, v56
    v_pk_fma_f32 v[60:61], v[70:71], v[18:19], v[60:61] op_sel:[0,1,0] op_sel_hi:[1,1,1]
    v_lshlrev_b32_e64 v70, 16, v57
    v_and_b32 v71, 0xffff0000, v57
    v_pk_fma_f32 v[62:63], v[70:71], v[18:19], v[62:63] op_sel:[0,1,0] op_sel_hi:[1,1,1]
    v_lshlrev_b32_e64 v70, 16, v58
    v_and_b32 v71, 0xffff0000, v58
    v_pk_fma_f32 v[64:65], v[70:71], v[18:19], v[64:65] op_sel:[0,1,0] op_sel_hi:[1,1,1]
    v_lshlrev_b32_e64 v70, 16, v59
    v_and_b32 v71, 0xffff0000, v59
    v_pk_fma_f32 v[66:67], v[70:71], v[18:19], v[66:67] op_sel:[0,1,0] op_sel_hi:[1,1,1]
    v_add_f32_dpp v60, v60, v60 row_ror:8 row_mask:0xf bank_mask:0xf
    v_add_f32_dpp v61, v61, v61 row_ror:8 row_mask:0xf bank_mask:0xf
    v_add_f32_dpp v62, v62, v62 row_ror:8 row_mask:0xf bank_mask:0xf
    v_add_f32_dpp v63, v63, v63 row_ror:8 row_mask:0xf bank_mask:0xf
    v_add_f32_dpp v64, v64, v64 row_ror:8 row_mask:0xf bank_mask:0xf
    v_add_f32_dpp v65, v65, v65 row_ror:8 row_mask:0xf bank_mask:0xf
    v_add_f32_dpp v66, v66, v66 row_ror:8 row_mask:0xf bank_mask:0xf
    v_add_f32_dpp v67, v67, v67 row_ror:8 row_mask:0xf bank_mask:0xf
    v_mov_b32 v70, v60
    s_nop 1
    v_permlane16_swap_b32 v70, v60
    v_add_f32 v60, v60, v70
    v_mov_b32 v70, v60
    s_nop 1
    v_permlane32_swap_b32 v70, v60
    v_add_f32 v60, v60, v70
    v_mov_b32 v71, v61
    s_nop 1
    v_permlane16_swap_b32 v71, v61
    v_add_f32 v61, v61, v71
    v_mov_b32 v71, v61
    s_nop 1
    v_permlane32_swap_b32 v71, v61
    v_add_f32 v61, v61, v71
    v_mov_b32 v70, v62
    s_nop 1
    v_permlane16_swap_b32 v70, v62
    v_add_f32 v62, v62, v70
    v_mov_b32 v70, v62
    s_nop 1
    v_permlane32_swap_b32 v70, v62
    v_add_f32 v62, v62, v70
    v_mov_b32 v71, v63
    s_nop 1
    v_permlane16_swap_b32 v71, v63
    v_add_f32 v63, v63, v71
    v_mov_b32 v71, v63
    s_nop 1
    v_permlane32_swap_b32 v71, v63
    v_add_f32 v63, v63, v71
    v_mov_b32 v70, v64
    s_nop 1
    v_permlane16_swap_b32 v70, v64
    v_add_f32 v64, v64, v70
    v_mov_b32 v70, v64
    s_nop 1
    v_permlane32_swap_b32 v70, v64
    v_add_f32 v64, v64, v70
    v_mov_b32 v71, v65
    s_nop 1
    v_permlane16_swap_b32 v71, v65
    v_add_f32 v65, v65, v71
    v_mov_b32 v71, v65
    s_nop 1
    v_permlane32_swap_b32 v71, v65
    v_add_f32 v65, v65, v71
    v_mov_b32 v70, v66
    s_nop 1
    v_permlane16_swap_b32 v70, v66
    v_add_f32 v66, v66, v70
    v_mov_b32 v70, v66
    s_nop 1
    v_permlane32_swap_b32 v70, v66
    v_add_f32 v66, v66, v70
    v_mov_b32 v71, v67
    s_nop 1
    v_permlane16_swap_b32 v71, v67
    v_add_f32 v67, v67, v71
    v_mov_b32 v71, v67
    s_nop 1
    v_permlane32_swap_b32 v71, v67
    v_add_f32 v67, v67, v71
    v_and_b32 v3, 7, v1
    s_lshl_b32 s5, s4, 8
    v_lshlrev_b32_e64 v6, 5, v3
    v_add_u32 v6, s5, v6
    s_mov_b64 s[36:37], exec
    s_mov_b64 exec, 0xff
    ds_write_b128 v6, v[60:63]
    ds_write_b128 v6, v[64:67] offset:16
    s_mov_b64 exec, s[36:37]
    s_waitcnt lgkmcnt(0)
    s_barrier
    s_cmp_eq_u32 s4, 0
    s_cbranch_scc0 L_w0_49
    v_lshlrev_b32 v6, 2, v1
    ds_read_b32 v70, v6 offset:0
    ds_read_b32 v71, v6 offset:256
    ds_read_b32 v72, v6 offset:512
    ds_read_b32 v73, v6 offset:768
    s_mul_i32 s32, s32, 15360
    s_lshl_b32 s33, s33, 8
    s_add_u32 s32, s32, s33
    s_add_u32 s32, s32, 5242880
    s_waitcnt lgkmcnt(0)
    v_add_f32 v70, v70, v71
    v_add_f32_e64 v72, v72, v73
    v_add_f32 v70, v70, v72
    buffer_store_dword v70, v6, s[8:11], s32 offen sc1
L_w0_49:
    s_barrier
    s_and_b32 s35, s2, 7
    s_add_u32 s35, s35, 8
    s_cmp_eq_u32 s4, 0
    s_cbranch_scc0 L_w0_50
    s_mov_b32 s28, s92
    s_mov_b32 s29, s93
    s_mov_b32 s30, 0x100
    s_mov_b32 s31, 0x00020000
    v_mov_b32 v10, 0
    s_mov_b64 s[36:37], exec
    s_mov_b64 exec, 0x1
    s_mov_b32 s97, 0
L_poll_51:
    buffer_load_dword v11, v10, s[28:31], 0 offen sc1
    s_waitcnt vmcnt(0)
    v_cmp_eq_u32 vcc, 0, v11
    s_nop 0
    s_cbranch_vccz L_polld_52
    s_add_u32 s97, s97, 1
    s_cmp_lt_u32 s97, 262144
    s_cbranch_scc1 L_poll_51
L_polld_52:
    s_mov_b64 exec, s[36:37]
L_w0_50:
    s_waitcnt vmcnt(0)
    s_barrier
    s_cmp_eq_u32 s4, 0
    s_cbranch_scc0 L_w0_53
    s_lshl_b32 s96, s35, 7
    s_add_u32 s96, s96, 5373952
    v_mov_b32_e64 v10, 1
    v_mov_b32 v11, 0
    s_mov_b64 s[36:37], exec
    s_mov_b64 exec, 1
    buffer_atomic_add v10, v11, s[8:11], s96 offen sc1
    s_mov_b64 exec, s[36:37]
L_w0_53:
    s_mov_b32 s12, s84
    s_mov_b32 s13, s85
    s_mov_b32 s14, 0x21c000
    s_mov_b32 s15, 0x00020000
    s_sub_u32 s45, s2, 216
    s_and_b32 s44, s45, 3
    s_lshr_b32 s45, s45, 2
    s_mul_i32 s46, s44, 14
    s_cmp_eq_u32 s44, 3
    s_cselect_b32 s5, 1, 0
    s_sub_u32 s46, s46, s5
    v_lshrrev_b32_e64 v2, 3, v1
    v_mul_u32_u24 v2, 1280, v2
    v_bfe_u32 v3, v1, 1, 2
    v_bfe_u32 v4, v1, 4, 2
    v_xor_b32 v3, v3, v4
    v_and_b32 v4, 1, v1
    v_lshl_add_u32 v3, v3, 1, v4
    v_lshl_add_u32 v2, v3, 4, v2
    s_mul_i32 s5, s46, 40960
    s_mul_i32 s6, s4, 143360
    s_add_u32 s5, s5, s6
    s_nop 0
    s_lshl_b32 s6, s45, 7
    s_add_u32 s5, s5, s6
    s_mul_i32 s6, s4, 14336
    s_add_u32 s6, s6, 8192
    s_add_u32 m0, s6, 0
    s_nop 0
    buffer_load_dwordx4 v2, s[12:15], s5 offen nt lds
    s_add_u32 s5, s5, 10240
    s_add_u32 m0, s6, 1024
    s_nop 0
    buffer_load_dwordx4 v2, s[12:15], s5 offen nt lds
    s_add_u32 s5, s5, 10240
    s_add_u32 m0, s6, 2048
    s_nop 0
    buffer_load_dwordx4 v2, s[12:15], s5 offen nt lds
    s_add_u32 s5, s5, 10240
    s_add_u32 m0, s6, 3072
    s_nop 0
    buffer_load_dwordx4 v2, s[12:15], s5 offen nt lds
    s_add_u32 s5, s5, 10240
    s_add_u32 m0, s6, 4096
    s_nop 0
    buffer_load_dwordx4 v2, s[12:15], s5 offen nt lds
    s_add_u32 s5, s5, 10240
    s_add_u32 m0, s6, 5120
    s_nop 0
    buffer_load_dwordx4 v2, s[12:15], s5 offen nt lds
    s_add_u32 s5, s5, 10240
    s_add_u32 m0, s6, 6144
    s_nop 0
    buffer_load_dwordx4 v2, s[12:15], s5 offen nt lds
    s_add_u32 s5, s5, 10240
    s_add_u32 m0, s6, 7168
    s_nop 0
    buffer_load_dwordx4 v2, s[12:15], s5 offen nt lds
    s_add_u32 s5, s5, 10240
    s_add_u32 m0, s6, 8192
    s_nop 0
    buffer_load_dwordx4 v2, s[12:15], s5 offen nt lds
    s_add_u32 s5, s5, 10240
    s_add_u32 m0, s6, 9216
    s_nop 0
    buffer_load_dwordx4 v2, s[12:15], s5 offen nt lds
    s_add_u32 s5, s5, 10240
    s_add_u32 m0, s6, 10240
    s_nop 0
    buffer_load_dwordx4 v2, s[12:15], s5 offen nt lds
    s_add_u32 s5, s5, 10240
    s_add_u32 m0, s6, 11264
    s_nop 0
    buffer_load_dwordx4 v2, s[12:15], s5 offen nt lds
    s_add_u32 s5, s5, 10240
    s_add_u32 m0, s6, 12288
    s_nop 0
    buffer_load_dwordx4 v2, s[12:15], s5 offen nt lds
    s_add_u32 s5, s5, 10240
    s_add_u32 m0, s6, 13312
    s_nop 0
    buffer_load_dwordx4 v2, s[12:15], s5 offen nt lds
    s_getpc_b64 s[98:99]
L_pcx2:
    s_sub_u32 s98, s98, (L_pcx2-adaLN_cond__ssm_conv_s4d__glu_gated_geglu__prompt_kernel)
    s_subb_u32 s99, s99, 0
    s_add_u32 s28, s98, (adaLN_cond__ssm_conv_s4d__glu_gated_geglu__prompt_kernel-adaLN_cond__ssm_conv_s4d__glu_gated_geglu__prompt_kernel)
    s_addc_u32 s29, s99, 0
    s_mov_b32 s30, (L_codeend-adaLN_cond__ssm_conv_s4d__glu_gated_geglu__prompt_kernel)
    s_mov_b32 s31, 0x00020000
    v_lshlrev_b32 v250, 7, v0
    buffer_load_dword v251, v250, s[28:31], 0 offen
    s_getpc_b64 s[98:99]
L_pcx3:
    s_sub_u32 s98, s98, (L_pcx3-adaLN_cond__ssm_conv_s4d__glu_gated_geglu__prompt_kernel)
    s_subb_u32 s99, s99, 0
    s_add_u32 s28, s98, (L_convend-adaLN_cond__ssm_conv_s4d__glu_gated_geglu__prompt_kernel)
    s_addc_u32 s29, s99, 0
    s_mov_b32 s30, (L_codeend-L_convend)
    s_mov_b32 s31, 0x00020000
    v_lshlrev_b32_e64 v250, 7, v0
    buffer_load_dword v251, v250, s[28:31], 0 offen
    v_lshrrev_b32_e64 v3, 4, v1
    v_bfe_u32 v4, v1, 2, 2
    v_lshrrev_b32 v5, 1, v3
    v_lshlrev_b32 v5, 4, v5
    v_and_b32_e64 v6, 1, v3
    v_lshl_add_u32 v5, v6, 2, v5
    v_add_u32 v5, v5, v4
    v_lshrrev_b32 v7, 1, v4
    v_lshl_add_u32 v7, v6, 1, v7
    v_xor_b32 v7, s4, v7
    v_lshlrev_b32 v7, 5, v7
    v_lshl_add_u32 v7, v5, 7, v7
    v_and_b32_e64 v6, 3, v1
    v_lshl_add_u32 v7, v6, 3, v7
    v_add_u32 v7, 8192, v7
    v_lshlrev_b32 v8, 4, v1
    s_lshl_b32 s5, s45, 2
    s_add_u32 s5, s5, s4
    s_mul_i32 s5, s5, 54
    s_add_u32 s5, s5, s46
    s_lshl_b32 s5, s5, 10
    s_add_u32 s5, s5, 10878976
    s_waitcnt vmcnt(0)
    s_barrier
    ds_read_b64_tr_b16 v[10:11], v7 offset:0
    ds_read_b64_tr_b16 v[12:13], v7 offset:1024
    ds_read_b64_tr_b16 v[14:15], v7 offset:4096
    ds_read_b64_tr_b16 v[16:17], v7 offset:5120
    ds_read_b64_tr_b16 v[18:19], v7 offset:8192
    ds_read_b64_tr_b16 v[20:21], v7 offset:9216
    ds_read_b64_tr_b16 v[22:23], v7 offset:12288
    ds_read_b64_tr_b16 v[24:25], v7 offset:13312
    s_waitcnt lgkmcnt(6)
    buffer_store_dwordx4 v[10:13], v8, s[8:11], s5 offen sc1
    s_add_u32 s5, s5, 1024
    ds_read_b64_tr_b16 v[26:27], v7 offset:16384
    ds_read_b64_tr_b16 v[28:29], v7 offset:17408
    s_waitcnt lgkmcnt(6)
    buffer_store_dwordx4 v[14:17], v8, s[8:11], s5 offen sc1
    s_add_u32 s5, s5, 1024
    ds_read_b64_tr_b16 v[30:31], v7 offset:20480
    ds_read_b64_tr_b16 v[32:33], v7 offset:21504
    s_waitcnt lgkmcnt(6)
    buffer_store_dwordx4 v[18:21], v8, s[8:11], s5 offen sc1
    s_add_u32 s5, s5, 1024
    ds_read_b64_tr_b16 v[34:35], v7 offset:24576
    ds_read_b64_tr_b16 v[36:37], v7 offset:25600
    s_waitcnt lgkmcnt(6)
    buffer_store_dwordx4 v[22:25], v8, s[8:11], s5 offen sc1
    s_add_u32 s5, s5, 1024
    ds_read_b64_tr_b16 v[38:39], v7 offset:28672
    ds_read_b64_tr_b16 v[40:41], v7 offset:29696
    s_waitcnt lgkmcnt(6)
    buffer_store_dwordx4 v[26:29], v8, s[8:11], s5 offen sc1
    s_add_u32 s5, s5, 1024
    ds_read_b64_tr_b16 v[42:43], v7 offset:32768
    ds_read_b64_tr_b16 v[44:45], v7 offset:33792
    s_waitcnt lgkmcnt(6)
    buffer_store_dwordx4 v[30:33], v8, s[8:11], s5 offen sc1
    s_add_u32 s5, s5, 1024
    ds_read_b64_tr_b16 v[46:47], v7 offset:36864
    ds_read_b64_tr_b16 v[48:49], v7 offset:37888
    s_waitcnt lgkmcnt(6)
    buffer_store_dwordx4 v[34:37], v8, s[8:11], s5 offen sc1
    s_add_u32 s5, s5, 1024
    ds_read_b64_tr_b16 v[50:51], v7 offset:40960
    ds_read_b64_tr_b16 v[52:53], v7 offset:41984
    s_waitcnt lgkmcnt(6)
    buffer_store_dwordx4 v[38:41], v8, s[8:11], s5 offen sc1
    s_add_u32 s5, s5, 1024
    ds_read_b64_tr_b16 v[54:55], v7 offset:45056
    ds_read_b64_tr_b16 v[56:57], v7 offset:46080
    s_waitcnt lgkmcnt(6)
    buffer_store_dwordx4 v[42:45], v8, s[8:11], s5 offen sc1
    s_add_u32 s5, s5, 1024
    ds_read_b64_tr_b16 v[58:59], v7 offset:49152
    ds_read_b64_tr_b16 v[60:61], v7 offset:50176
    s_waitcnt lgkmcnt(6)
    buffer_store_dwordx4 v[46:49], v8, s[8:11], s5 offen sc1
    s_add_u32 s5, s5, 1024
    ds_read_b64_tr_b16 v[62:63], v7 offset:53248
    ds_read_b64_tr_b16 v[64:65], v7 offset:54272
    s_waitcnt lgkmcnt(6)
    buffer_store_dwordx4 v[50:53], v8, s[8:11], s5 offen sc1
    s_add_u32 s5, s5, 1024
    s_waitcnt lgkmcnt(4)
    buffer_store_dwordx4 v[54:57], v8, s[8:11], s5 offen sc1
    s_add_u32 s5, s5, 1024
    s_waitcnt lgkmcnt(2)
    buffer_store_dwordx4 v[58:61], v8, s[8:11], s5 offen sc1
    s_add_u32 s5, s5, 1024
    s_cmp_ge_u32 s44, 2
    s_cbranch_scc1 L_wd_skip_54
    s_waitcnt lgkmcnt(0)
    buffer_store_dwordx4 v[62:65], v8, s[8:11], s5 offen sc1
    s_add_u32 s5, s5, 1024
L_wd_skip_54:
    s_waitcnt lgkmcnt(0)
    s_and_b32 s35, s2, 7
    s_add_u32 s35, s35, 32
    s_waitcnt vmcnt(0)
    s_barrier
    s_cmp_eq_u32 s4, 0
    s_cbranch_scc0 L_w0_55
    s_lshl_b32 s96, s35, 7
    s_add_u32 s96, s96, 5373952
    v_mov_b32 v2, 1
    v_mov_b32 v3, 0
    s_mov_b64 s[36:37], exec
    s_mov_b64 exec, 1
    buffer_atomic_add v2, v3, s[8:11], s96 offen sc1
    s_mov_b64 exec, s[36:37]
L_w0_55:
    s_branch L_pdone_33
L_idle_34:
    s_waitcnt vmcnt(10)
    v_lshlrev_b32 v10, 16, v10
    v_mul_f32 v70, 0xbfb8aa3b, v10
    v_exp_f32 v70, v70
    s_nop 0
    v_add_f32 v70, 1.0, v70
    v_rcp_f32 v70, v70
    s_nop 0
    v_mul_f32 v10, v10, v70
    v_cvt_pk_bf16_f32 v10, v10, v10
    v_lshlrev_b32 v10, 16, v10
    v_lshlrev_b32 v11, 16, v11
    v_mul_f32 v70, 0xbfb8aa3b, v11
    v_exp_f32 v70, v70
    s_nop 0
    v_add_f32 v70, 1.0, v70
    v_rcp_f32 v70, v70
    s_nop 0
    v_mul_f32 v11, v11, v70
    v_cvt_pk_bf16_f32 v11, v11, v11
    v_lshlrev_b32 v11, 16, v11
    v_lshlrev_b32 v12, 16, v12
    v_mul_f32 v70, 0xbfb8aa3b, v12
    v_exp_f32 v70, v70
    s_nop 0
    v_add_f32 v70, 1.0, v70
    v_rcp_f32 v70, v70
    s_nop 0
    v_mul_f32 v12, v12, v70
    v_cvt_pk_bf16_f32 v12, v12, v12
    v_lshlrev_b32 v12, 16, v12
    v_lshlrev_b32 v13, 16, v13
    v_mul_f32 v70, 0xbfb8aa3b, v13
    v_exp_f32 v70, v70
    s_nop 0
    v_add_f32 v70, 1.0, v70
    v_rcp_f32 v70, v70
    s_nop 0
    v_mul_f32 v13, v13, v70
    v_cvt_pk_bf16_f32 v13, v13, v13
    v_lshlrev_b32 v13, 16, v13
    v_lshlrev_b32 v14, 16, v14
    v_mul_f32 v70, 0xbfb8aa3b, v14
    v_exp_f32 v70, v70
    s_nop 0
    v_add_f32 v70, 1.0, v70
    v_rcp_f32 v70, v70
    s_nop 0
    v_mul_f32 v14, v14, v70
    v_cvt_pk_bf16_f32 v14, v14, v14
    v_lshlrev_b32 v14, 16, v14
    v_lshlrev_b32 v15, 16, v15
    v_mul_f32 v70, 0xbfb8aa3b, v15
    v_exp_f32 v70, v70
    s_nop 0
    v_add_f32 v70, 1.0, v70
    v_rcp_f32 v70, v70
    s_nop 0
    v_mul_f32 v15, v15, v70
    v_cvt_pk_bf16_f32 v15, v15, v15
    v_lshlrev_b32 v15, 16, v15
    v_lshlrev_b32 v16, 16, v16
    v_mul_f32 v70, 0xbfb8aa3b, v16
    v_exp_f32 v70, v70
    s_nop 0
    v_add_f32 v70, 1.0, v70
    v_rcp_f32 v70, v70
    s_nop 0
    v_mul_f32 v16, v16, v70
    v_cvt_pk_bf16_f32 v16, v16, v16
    v_lshlrev_b32 v16, 16, v16
    v_lshlrev_b32 v17, 16, v17
    v_mul_f32 v70, 0xbfb8aa3b, v17
    v_exp_f32 v70, v70
    s_nop 0
    v_add_f32 v70, 1.0, v70
    v_rcp_f32 v70, v70
    s_nop 0
    v_mul_f32 v17, v17, v70
    v_cvt_pk_bf16_f32 v17, v17, v17
    v_lshlrev_b32 v17, 16, v17
    v_lshlrev_b32 v18, 16, v18
    v_mul_f32 v70, 0xbfb8aa3b, v18
    v_exp_f32 v70, v70
    s_nop 0
    v_add_f32 v70, 1.0, v70
    v_rcp_f32 v70, v70
    s_nop 0
    v_mul_f32 v18, v18, v70
    v_cvt_pk_bf16_f32 v18, v18, v18
    v_lshlrev_b32 v18, 16, v18
    v_lshlrev_b32 v19, 16, v19
    v_mul_f32 v70, 0xbfb8aa3b, v19
    v_exp_f32 v70, v70
    s_nop 0
    v_add_f32 v70, 1.0, v70
    v_rcp_f32 v70, v70
    s_nop 0
    v_mul_f32 v19, v19, v70
    v_cvt_pk_bf16_f32 v19, v19, v19
    v_lshlrev_b32 v19, 16, v19
    s_waitcnt vmcnt(9)
    v_lshlrev_b32_e64 v70, 16, v20
    v_and_b32 v71, 0xffff0000, v20
    v_pk_mul_f32 v[60:61], v[70:71], v[10:11] op_sel_hi:[1,0]
    v_lshlrev_b32_e64 v70, 16, v21
    v_and_b32 v71, 0xffff0000, v21
    v_pk_mul_f32 v[62:63], v[70:71], v[10:11] op_sel_hi:[1,0]
    v_lshlrev_b32_e64 v70, 16, v22
    v_and_b32 v71, 0xffff0000, v22
    v_pk_mul_f32 v[64:65], v[70:71], v[10:11] op_sel_hi:[1,0]
    v_lshlrev_b32_e64 v70, 16, v23
    v_and_b32 v71, 0xffff0000, v23
    v_pk_mul_f32 v[66:67], v[70:71], v[10:11] op_sel_hi:[1,0]
    s_waitcnt vmcnt(8)
    v_lshlrev_b32 v70, 16, v24
    v_and_b32 v71, 0xffff0000, v24
    v_pk_fma_f32 v[60:61], v[70:71], v[10:11], v[60:61] op_sel:[0,1,0] op_sel_hi:[1,1,1]
    v_lshlrev_b32_e64 v70, 16, v25
    v_and_b32 v71, 0xffff0000, v25
    v_pk_fma_f32 v[62:63], v[70:71], v[10:11], v[62:63] op_sel:[0,1,0] op_sel_hi:[1,1,1]
    v_lshlrev_b32_e64 v70, 16, v26
    v_and_b32 v71, 0xffff0000, v26
    v_pk_fma_f32 v[64:65], v[70:71], v[10:11], v[64:65] op_sel:[0,1,0] op_sel_hi:[1,1,1]
    v_lshlrev_b32_e64 v70, 16, v27
    v_and_b32 v71, 0xffff0000, v27
    v_pk_fma_f32 v[66:67], v[70:71], v[10:11], v[66:67] op_sel:[0,1,0] op_sel_hi:[1,1,1]
    s_waitcnt vmcnt(7)
    v_lshlrev_b32 v70, 16, v28
    v_and_b32 v71, 0xffff0000, v28
    v_pk_fma_f32 v[60:61], v[70:71], v[12:13], v[60:61] op_sel_hi:[1,0,1]
    v_lshlrev_b32_e64 v70, 16, v29
    v_and_b32 v71, 0xffff0000, v29
    v_pk_fma_f32 v[62:63], v[70:71], v[12:13], v[62:63] op_sel_hi:[1,0,1]
    v_lshlrev_b32_e64 v70, 16, v30
    v_and_b32 v71, 0xffff0000, v30
    v_pk_fma_f32 v[64:65], v[70:71], v[12:13], v[64:65] op_sel_hi:[1,0,1]
    v_lshlrev_b32_e64 v70, 16, v31
    v_and_b32 v71, 0xffff0000, v31
    v_pk_fma_f32 v[66:67], v[70:71], v[12:13], v[66:67] op_sel_hi:[1,0,1]
    s_waitcnt vmcnt(6)
    v_lshlrev_b32 v70, 16, v32
    v_and_b32 v71, 0xffff0000, v32
    v_pk_fma_f32 v[60:61], v[70:71], v[12:13], v[60:61] op_sel:[0,1,0] op_sel_hi:[1,1,1]
    v_lshlrev_b32_e64 v70, 16, v33
    v_and_b32 v71, 0xffff0000, v33
    v_pk_fma_f32 v[62:63], v[70:71], v[12:13], v[62:63] op_sel:[0,1,0] op_sel_hi:[1,1,1]
    v_lshlrev_b32_e64 v70, 16, v34
    v_and_b32 v71, 0xffff0000, v34
    v_pk_fma_f32 v[64:65], v[70:71], v[12:13], v[64:65] op_sel:[0,1,0] op_sel_hi:[1,1,1]
    v_lshlrev_b32_e64 v70, 16, v35
    v_and_b32 v71, 0xffff0000, v35
    v_pk_fma_f32 v[66:67], v[70:71], v[12:13], v[66:67] op_sel:[0,1,0] op_sel_hi:[1,1,1]
    s_waitcnt vmcnt(5)
    v_lshlrev_b32 v70, 16, v36
    v_and_b32 v71, 0xffff0000, v36
    v_pk_fma_f32 v[60:61], v[70:71], v[14:15], v[60:61] op_sel_hi:[1,0,1]
    v_lshlrev_b32_e64 v70, 16, v37
    v_and_b32 v71, 0xffff0000, v37
    v_pk_fma_f32 v[62:63], v[70:71], v[14:15], v[62:63] op_sel_hi:[1,0,1]
    v_lshlrev_b32_e64 v70, 16, v38
    v_and_b32 v71, 0xffff0000, v38
    v_pk_fma_f32 v[64:65], v[70:71], v[14:15], v[64:65] op_sel_hi:[1,0,1]
    v_lshlrev_b32_e64 v70, 16, v39
    v_and_b32 v71, 0xffff0000, v39
    v_pk_fma_f32 v[66:67], v[70:71], v[14:15], v[66:67] op_sel_hi:[1,0,1]
    s_waitcnt vmcnt(4)
    v_lshlrev_b32 v70, 16, v40
    v_and_b32 v71, 0xffff0000, v40
    v_pk_fma_f32 v[60:61], v[70:71], v[14:15], v[60:61] op_sel:[0,1,0] op_sel_hi:[1,1,1]
    v_lshlrev_b32_e64 v70, 16, v41
    v_and_b32 v71, 0xffff0000, v41
    v_pk_fma_f32 v[62:63], v[70:71], v[14:15], v[62:63] op_sel:[0,1,0] op_sel_hi:[1,1,1]
    v_lshlrev_b32_e64 v70, 16, v42
    v_and_b32 v71, 0xffff0000, v42
    v_pk_fma_f32 v[64:65], v[70:71], v[14:15], v[64:65] op_sel:[0,1,0] op_sel_hi:[1,1,1]
    v_lshlrev_b32_e64 v70, 16, v43
    v_and_b32 v71, 0xffff0000, v43
    v_pk_fma_f32 v[66:67], v[70:71], v[14:15], v[66:67] op_sel:[0,1,0] op_sel_hi:[1,1,1]
    s_waitcnt vmcnt(3)
    v_lshlrev_b32 v70, 16, v44
    v_and_b32 v71, 0xffff0000, v44
    v_pk_fma_f32 v[60:61], v[70:71], v[16:17], v[60:61] op_sel_hi:[1,0,1]
    v_lshlrev_b32_e64 v70, 16, v45
    v_and_b32 v71, 0xffff0000, v45
    v_pk_fma_f32 v[62:63], v[70:71], v[16:17], v[62:63] op_sel_hi:[1,0,1]
    v_lshlrev_b32_e64 v70, 16, v46
    v_and_b32 v71, 0xffff0000, v46
    v_pk_fma_f32 v[64:65], v[70:71], v[16:17], v[64:65] op_sel_hi:[1,0,1]
    v_lshlrev_b32_e64 v70, 16, v47
    v_and_b32 v71, 0xffff0000, v47
    v_pk_fma_f32 v[66:67], v[70:71], v[16:17], v[66:67] op_sel_hi:[1,0,1]
    s_waitcnt vmcnt(2)
    v_lshlrev_b32 v70, 16, v48
    v_and_b32 v71, 0xffff0000, v48
    v_pk_fma_f32 v[60:61], v[70:71], v[16:17], v[60:61] op_sel:[0,1,0] op_sel_hi:[1,1,1]
    v_lshlrev_b32_e64 v70, 16, v49
    v_and_b32 v71, 0xffff0000, v49
    v_pk_fma_f32 v[62:63], v[70:71], v[16:17], v[62:63] op_sel:[0,1,0] op_sel_hi:[1,1,1]
    v_lshlrev_b32_e64 v70, 16, v50
    v_and_b32 v71, 0xffff0000, v50
    v_pk_fma_f32 v[64:65], v[70:71], v[16:17], v[64:65] op_sel:[0,1,0] op_sel_hi:[1,1,1]
    v_lshlrev_b32_e64 v70, 16, v51
    v_and_b32 v71, 0xffff0000, v51
    v_pk_fma_f32 v[66:67], v[70:71], v[16:17], v[66:67] op_sel:[0,1,0] op_sel_hi:[1,1,1]
    s_waitcnt vmcnt(1)
    v_lshlrev_b32 v70, 16, v52
    v_and_b32 v71, 0xffff0000, v52
    v_pk_fma_f32 v[60:61], v[70:71], v[18:19], v[60:61] op_sel_hi:[1,0,1]
    v_lshlrev_b32_e64 v70, 16, v53
    v_and_b32 v71, 0xffff0000, v53
    v_pk_fma_f32 v[62:63], v[70:71], v[18:19], v[62:63] op_sel_hi:[1,0,1]
    v_lshlrev_b32_e64 v70, 16, v54
    v_and_b32 v71, 0xffff0000, v54
    v_pk_fma_f32 v[64:65], v[70:71], v[18:19], v[64:65] op_sel_hi:[1,0,1]
    v_lshlrev_b32_e64 v70, 16, v55
    v_and_b32 v71, 0xffff0000, v55
    v_pk_fma_f32 v[66:67], v[70:71], v[18:19], v[66:67] op_sel_hi:[1,0,1]
    s_waitcnt vmcnt(0)
    v_lshlrev_b32 v70, 16, v56
    v_and_b32 v71, 0xffff0000, v56
    v_pk_fma_f32 v[60:61], v[70:71], v[18:19], v[60:61] op_sel:[0,1,0] op_sel_hi:[1,1,1]
    v_lshlrev_b32_e64 v70, 16, v57
    v_and_b32 v71, 0xffff0000, v57
    v_pk_fma_f32 v[62:63], v[70:71], v[18:19], v[62:63] op_sel:[0,1,0] op_sel_hi:[1,1,1]
    v_lshlrev_b32_e64 v70, 16, v58
    v_and_b32 v71, 0xffff0000, v58
    v_pk_fma_f32 v[64:65], v[70:71], v[18:19], v[64:65] op_sel:[0,1,0] op_sel_hi:[1,1,1]
    v_lshlrev_b32_e64 v70, 16, v59
    v_and_b32 v71, 0xffff0000, v59
    v_pk_fma_f32 v[66:67], v[70:71], v[18:19], v[66:67] op_sel:[0,1,0] op_sel_hi:[1,1,1]
    v_add_f32_dpp v60, v60, v60 row_ror:8 row_mask:0xf bank_mask:0xf
    v_add_f32_dpp v61, v61, v61 row_ror:8 row_mask:0xf bank_mask:0xf
    v_add_f32_dpp v62, v62, v62 row_ror:8 row_mask:0xf bank_mask:0xf
    v_add_f32_dpp v63, v63, v63 row_ror:8 row_mask:0xf bank_mask:0xf
    v_add_f32_dpp v64, v64, v64 row_ror:8 row_mask:0xf bank_mask:0xf
    v_add_f32_dpp v65, v65, v65 row_ror:8 row_mask:0xf bank_mask:0xf
    v_add_f32_dpp v66, v66, v66 row_ror:8 row_mask:0xf bank_mask:0xf
    v_add_f32_dpp v67, v67, v67 row_ror:8 row_mask:0xf bank_mask:0xf
    v_mov_b32 v70, v60
    s_nop 1
    v_permlane16_swap_b32 v70, v60
    v_add_f32 v60, v60, v70
    v_mov_b32 v70, v60
    s_nop 1
    v_permlane32_swap_b32 v70, v60
    v_add_f32 v60, v60, v70
    v_mov_b32 v71, v61
    s_nop 1
    v_permlane16_swap_b32 v71, v61
    v_add_f32 v61, v61, v71
    v_mov_b32 v71, v61
    s_nop 1
    v_permlane32_swap_b32 v71, v61
    v_add_f32 v61, v61, v71
    v_mov_b32 v70, v62
    s_nop 1
    v_permlane16_swap_b32 v70, v62
    v_add_f32 v62, v62, v70
    v_mov_b32 v70, v62
    s_nop 1
    v_permlane32_swap_b32 v70, v62
    v_add_f32 v62, v62, v70
    v_mov_b32 v71, v63
    s_nop 1
    v_permlane16_swap_b32 v71, v63
    v_add_f32 v63, v63, v71
    v_mov_b32 v71, v63
    s_nop 1
    v_permlane32_swap_b32 v71, v63
    v_add_f32 v63, v63, v71
    v_mov_b32 v70, v64
    s_nop 1
    v_permlane16_swap_b32 v70, v64
    v_add_f32 v64, v64, v70
    v_mov_b32 v70, v64
    s_nop 1
    v_permlane32_swap_b32 v70, v64
    v_add_f32 v64, v64, v70
    v_mov_b32 v71, v65
    s_nop 1
    v_permlane16_swap_b32 v71, v65
    v_add_f32 v65, v65, v71
    v_mov_b32 v71, v65
    s_nop 1
    v_permlane32_swap_b32 v71, v65
    v_add_f32 v65, v65, v71
    v_mov_b32 v70, v66
    s_nop 1
    v_permlane16_swap_b32 v70, v66
    v_add_f32 v66, v66, v70
    v_mov_b32 v70, v66
    s_nop 1
    v_permlane32_swap_b32 v70, v66
    v_add_f32 v66, v66, v70
    v_mov_b32 v71, v67
    s_nop 1
    v_permlane16_swap_b32 v71, v67
    v_add_f32 v67, v67, v71
    v_mov_b32 v71, v67
    s_nop 1
    v_permlane32_swap_b32 v71, v67
    v_add_f32 v67, v67, v71
    v_and_b32 v3, 7, v1
    s_lshl_b32 s5, s4, 8
    v_lshlrev_b32_e64 v6, 5, v3
    v_add_u32 v6, s5, v6
    s_mov_b64 s[36:37], exec
    s_mov_b64 exec, 0xff
    ds_write_b128 v6, v[60:63]
    ds_write_b128 v6, v[64:67] offset:16
    s_mov_b64 exec, s[36:37]
    s_waitcnt lgkmcnt(0)
    s_barrier
    s_cmp_eq_u32 s4, 0
    s_cbranch_scc0 L_w0_56
    v_lshlrev_b32 v6, 2, v1
    ds_read_b32 v70, v6 offset:0
    ds_read_b32 v71, v6 offset:256
    ds_read_b32 v72, v6 offset:512
    ds_read_b32 v73, v6 offset:768
    s_mul_i32 s32, s32, 15360
    s_lshl_b32 s33, s33, 8
    s_add_u32 s32, s32, s33
    s_add_u32 s32, s32, 5242880
    s_waitcnt lgkmcnt(0)
    v_add_f32 v70, v70, v71
    v_add_f32_e64 v72, v72, v73
    v_add_f32 v70, v70, v72
    buffer_store_dword v70, v6, s[8:11], s32 offen sc1
L_w0_56:
    s_barrier
    s_and_b32 s35, s2, 7
    s_add_u32 s35, s35, 8
    s_cmp_eq_u32 s4, 0
    s_cbranch_scc0 L_w0_57
    s_mov_b32 s28, s92
    s_mov_b32 s29, s93
    s_mov_b32 s30, 0x100
    s_mov_b32 s31, 0x00020000
    v_mov_b32 v10, 0
    s_mov_b64 s[36:37], exec
    s_mov_b64 exec, 0x1
    s_mov_b32 s97, 0
L_poll_58:
    buffer_load_dword v11, v10, s[28:31], 0 offen sc1
    s_waitcnt vmcnt(0)
    v_cmp_eq_u32 vcc, 0, v11
    s_nop 0
    s_cbranch_vccz L_polld_59
    s_add_u32 s97, s97, 1
    s_cmp_lt_u32 s97, 262144
    s_cbranch_scc1 L_poll_58
L_polld_59:
    s_mov_b64 exec, s[36:37]
L_w0_57:
    s_waitcnt vmcnt(0)
    s_barrier
    s_cmp_eq_u32 s4, 0
    s_cbranch_scc0 L_w0_60
    s_lshl_b32 s96, s35, 7
    s_add_u32 s96, s96, 5373952
    v_mov_b32 v10, 1
    v_mov_b32 v11, 0
    s_mov_b64 s[36:37], exec
    s_mov_b64 exec, 1
    buffer_atomic_add v10, v11, s[8:11], s96 offen sc1
    s_mov_b64 exec, s[36:37]
L_w0_60:
L_pdone_33:
    s_getpc_b64 s[98:99]
L_pcx4:
    s_sub_u32 s98, s98, (L_pcx4-adaLN_cond__ssm_conv_s4d__glu_gated_geglu__prompt_kernel)
    s_subb_u32 s99, s99, 0
    s_add_u32 s28, s98, (adaLN_cond__ssm_conv_s4d__glu_gated_geglu__prompt_kernel-adaLN_cond__ssm_conv_s4d__glu_gated_geglu__prompt_kernel)
    s_addc_u32 s29, s99, 0
    s_mov_b32 s30, (L_codeend-adaLN_cond__ssm_conv_s4d__glu_gated_geglu__prompt_kernel)
    s_mov_b32 s31, 0x00020000
    v_lshlrev_b32 v250, 7, v0
    buffer_load_dword v251, v250, s[28:31], 0 offen
    s_getpc_b64 s[98:99]
L_pcx5:
    s_sub_u32 s98, s98, (L_pcx5-adaLN_cond__ssm_conv_s4d__glu_gated_geglu__prompt_kernel)
    s_subb_u32 s99, s99, 0
    s_add_u32 s28, s98, (L_convend-adaLN_cond__ssm_conv_s4d__glu_gated_geglu__prompt_kernel)
    s_addc_u32 s29, s99, 0
    s_mov_b32 s30, (L_codeend-L_convend)
    s_mov_b32 s31, 0x00020000
    v_lshlrev_b32_e64 v250, 7, v0
    buffer_load_dword v251, v250, s[28:31], 0 offen
    s_and_b32 s5, s2, 7
    s_lshr_b32 s6, s2, 3
    s_and_b32 s44, s5, 1
    s_lshl_b32 s44, s44, 3
    s_and_b32 s7, s6, 7
    s_add_u32 s44, s44, s7
    s_lshr_b32 s54, s5, 1
    s_lshl_b32 s54, s54, 3
    s_add_u32 s54, s54, s7
    s_and_b32 s55, s5, 1
    s_lshl_b32 s55, s55, 2
    s_lshr_b32 s5, s5, 1
    s_lshr_b32 s6, s6, 3
    s_add_u32 s55, s55, s6
    s_mul_i32 s46, s5, 27
    s_mul_i32 s7, s6, 7
    s_add_u32 s46, s46, s7
    s_cmp_eq_u32 s6, 3
    s_cselect_b32 s47, 6, 7
    s_lshl_b32 s48, s44, 2
    s_add_u32 s48, s48, s4
    v_lshlrev_b32 v6, 4, v1
    s_cmp_eq_u32 s4, 0
    s_cbranch_scc0 L_w0_61
    v_mov_b32 v2, 5373952
    v_mov_b32 v3, 0
    v_lshlrev_b32 v4, 7, v1
    v_add_u32 v2, 5377024, v4
    v_mov_b32 v3, 5
    s_mov_b32 s96, 7
    v_writelane_b32 v3, s96, 0
    s_mov_b32 s96, 7
    v_writelane_b32 v3, s96, 1
    s_mov_b32 s96, 7
    v_writelane_b32 v3, s96, 2
    s_mov_b32 s96, 7
    v_writelane_b32 v3, s96, 3
    s_mov_b32 s96, 7
    v_writelane_b32 v3, s96, 4
    s_mov_b32 s96, 7
    v_writelane_b32 v3, s96, 5
    s_mov_b32 s96, 6
    v_writelane_b32 v3, s96, 6
    s_mov_b32 s96, 6
    v_writelane_b32 v3, s96, 7
    s_mov_b64 s[36:37], exec
    s_mov_b64 exec, 0xffff
    s_mov_b32 s97, 0
L_poll_62:
    buffer_load_dword v4, v2, s[8:11], 0 offen sc1
    s_waitcnt vmcnt(0)
    v_cmp_lt_u32 vcc, v4, v3
    s_nop 0
    s_cbranch_vccz L_polld_63
    s_add_u32 s97, s97, 1
    s_cmp_lt_u32 s97, 262144
    s_cbranch_scc1 L_poll_62
L_polld_63:
    s_mov_b64 exec, s[36:37]
L_w0_61:
    s_barrier
    s_lshr_b32 s5, s2, 3
    s_sub_u32 s5, s5, 20
    s_and_b32 s6, s5, 3
    s_lshr_b32 s5, s5, 2
    s_mul_i32 s5, s5, 28672
    s_mul_i32 s6, s6, 7
    s_and_b32 s7, s2, 7
    s_lshr_b32 s7, s7, 1
    s_mul_i32 s7, s7, 27
    s_add_u32 s6, s6, s7
    s_mul_i32 s6, s6, 41984
    s_add_u32 s5, s5, s6
    s_add_u32 s5, s5, 6291456
    v_lshlrev_b32 v7, 7, v0
    buffer_load_dword v8, v7, s[8:11], s5 offen sc1
    s_mov_b32 s12, s8
    s_mov_b32 s13, s9
    s_mov_b32 s14, 0x2000000
    s_mov_b32 s15, 0x00020000
    s_mul_i32 s53, s4, 10240
    s_mul_i32 s51, s46, 41984
    s_add_u32 s51, s51, s53
    s_add_u32 s51, s51, 6291456
    s_add_u32 m0, s53, 84992
    s_mov_b32 s5, s51
    buffer_load_dwordx4 v6, s[12:15], s5 offen offset:0 sc1 lds
    buffer_load_dwordx4 v6, s[12:15], s5 offen offset:1024 sc1 lds
    buffer_load_dwordx4 v6, s[12:15], s5 offen offset:2048 sc1 lds
    buffer_load_dwordx4 v6, s[12:15], s5 offen offset:3072 sc1 lds
    s_add_u32 m0, m0, 4096
    s_add_u32 s5, s5, 4096
    buffer_load_dwordx4 v6, s[12:15], s5 offen offset:0 sc1 lds
    buffer_load_dwordx4 v6, s[12:15], s5 offen offset:1024 sc1 lds
    buffer_load_dwordx4 v6, s[12:15], s5 offen offset:2048 sc1 lds
    buffer_load_dwordx4 v6, s[12:15], s5 offen offset:3072 sc1 lds
    s_add_u32 m0, m0, 4096
    s_add_u32 s5, s5, 4096
    buffer_load_dwordx4 v6, s[12:15], s5 offen offset:0 sc1 lds
    buffer_load_dwordx4 v6, s[12:15], s5 offen offset:1024 sc1 lds
    buffer_load_dwordx4 v6, s[12:15], s5 offen offset:2048 sc1 lds
    s_add_u32 s51, s51, 41984
    v_lshlrev_b32_e64 v6, 4, v1
    s_add_u32 m0, s53, 0
    s_mov_b32 s5, s51
    buffer_load_dwordx4 v6, s[12:15], s5 offen offset:0 sc1 lds
    buffer_load_dwordx4 v6, s[12:15], s5 offen offset:1024 sc1 lds
    buffer_load_dwordx4 v6, s[12:15], s5 offen offset:2048 sc1 lds
    buffer_load_dwordx4 v6, s[12:15], s5 offen offset:3072 sc1 lds
    s_add_u32 m0, m0, 4096
    s_add_u32 s5, s5, 4096
    buffer_load_dwordx4 v6, s[12:15], s5 offen offset:0 sc1 lds
    buffer_load_dwordx4 v6, s[12:15], s5 offen offset:1024 sc1 lds
    buffer_load_dwordx4 v6, s[12:15], s5 offen offset:2048 sc1 lds
    buffer_load_dwordx4 v6, s[12:15], s5 offen offset:3072 sc1 lds
    s_add_u32 m0, m0, 4096
    s_add_u32 s5, s5, 4096
    buffer_load_dwordx4 v6, s[12:15], s5 offen offset:0 sc1 lds
    buffer_load_dwordx4 v6, s[12:15], s5 offen offset:1024 sc1 lds
    buffer_load_dwordx4 v6, s[12:15], s5 offen offset:2048 sc1 lds
    s_add_u32 s51, s51, 41984
    s_mov_b32 s3, 0x7040100
    s_cmp_eq_u32 s4, 1
    s_cselect_b32 s3, 0x1512110e, s3
    s_cmp_eq_u32 s4, 2
    s_cselect_b32 s3, 0x221f1c1b, s3
    s_cmp_eq_u32 s4, 3
    s_cselect_b32 s3, 0x302d2c29, s3
    s_bfe_u32 s64, s3, 0x80000
    s_lshl_b32 s64, s64, 10
    s_bfe_u32 s65, s3, 0x80008
    s_lshl_b32 s65, s65, 10
    s_bfe_u32 s66, s3, 0x80010
    s_lshl_b32 s66, s66, 10
    s_bfe_u32 s67, s3, 0x80018
    s_lshl_b32 s67, s67, 10
    s_mov_b32 s3, 0x3020b08
    s_cmp_eq_u32 s4, 1
    s_cselect_b32 s3, 0x100f1918, s3
    s_cmp_eq_u32 s4, 2
    s_cselect_b32 s3, 0x201e2623, s3
    s_cmp_eq_u32 s4, 3
    s_cselect_b32 s3, 0x2b2a3433, s3
    s_bfe_u32 s68, s3, 0x80000
    s_lshl_b32 s68, s68, 10
    s_bfe_u32 s69, s3, 0x80008
    s_lshl_b32 s69, s69, 10
    s_bfe_u32 s70, s3, 0x80010
    s_lshl_b32 s70, s70, 10
    s_bfe_u32 s71, s3, 0x80018
    s_lshl_b32 s71, s71, 10
    s_mov_b32 s3, 0xa090605
    s_cmp_eq_u32 s4, 1
    s_cselect_b32 s3, 0x17161413, s3
    s_cmp_eq_u32 s4, 2
    s_cselect_b32 s3, 0x27252421, s3
    s_cmp_eq_u32 s4, 3
    s_cselect_b32 s3, 0x32312f2e, s3
    s_bfe_u32 s72, s3, 0x80000
    s_lshl_b32 s72, s72, 10
    s_bfe_u32 s73, s3, 0x80008
    s_lshl_b32 s73, s73, 10
    s_bfe_u32 s74, s3, 0x80010
    s_lshl_b32 s74, s74, 10
    s_bfe_u32 s75, s3, 0x80018
    s_lshl_b32 s75, s75, 10
    s_mov_b32 s3, 0xd0c
    s_cmp_eq_u32 s4, 1
    s_cselect_b32 s3, 0x1d1a, s3
    s_cmp_eq_u32 s4, 2
    s_cselect_b32 s3, 0x2828, s3
    s_cmp_eq_u32 s4, 3
    s_cselect_b32 s3, 0x3535, s3
    s_bfe_u32 s76, s3, 0x80000
    s_lshl_b32 s76, s76, 10
    s_bfe_u32 s77, s3, 0x80008
    s_lshl_b32 s77, s77, 10
    s_mul_i32 s5, s55, 5
    s_add_u32 s5, s5, 0
    s_mul_i32 s5, s5, 55296
    s_add_u32 s57, s5, 10878976
    s_mul_i32 s5, s55, 5
    s_add_u32 s5, s5, 1
    s_mul_i32 s5, s5, 55296
    s_add_u32 s58, s5, 10878976
    s_mul_i32 s5, s55, 5
    s_add_u32 s5, s5, 2
    s_mul_i32 s5, s5, 55296
    s_add_u32 s59, s5, 10878976
    s_mul_i32 s5, s55, 5
    s_add_u32 s5, s5, 3
    s_mul_i32 s5, s5, 55296
    s_add_u32 s60, s5, 10878976
    s_mul_i32 s5, s55, 5
    s_add_u32 s5, s5, 4
    s_mul_i32 s5, s5, 55296
    s_add_u32 s61, s5, 10878976
L_Bdone_4:
L_gemm1:
    s_waitcnt vmcnt(0)
    s_cmp_eq_u32 s4, 0
    s_cbranch_scc0 L_w0_64
    v_mov_b32 v2, 5373952
    v_mov_b32 v3, 0
    v_lshlrev_b32_e64 v4, 7, v1
    v_add_u32 v2, 5376000, v4
    v_mov_b32 v3, 20
    s_mov_b64 s[36:37], exec
    s_mov_b64 exec, 0xff
    s_mov_b32 s97, 0
L_poll_65:
    buffer_load_dword v4, v2, s[8:11], 0 offen sc1
    s_waitcnt vmcnt(0)
    v_cmp_lt_u32_e64 vcc, v4, v3
    s_nop 0
    s_cbranch_vccz L_polld_66
    s_add_u32 s97, s97, 1
    s_cmp_lt_u32 s97, 262144
    s_cbranch_scc1 L_poll_65
L_polld_66:
    s_mov_b64 exec, s[36:37]
L_w0_64:
    s_barrier
    s_mul_i32 s3, s48, 40960
    s_add_u32 s3, s3, 2621440
    buffer_load_dwordx4 v[10:13], v6, s[8:11], s3 offen offset:0 sc1
    buffer_load_dwordx4 v[14:17], v6, s[8:11], s3 offen offset:1024 sc1
    buffer_load_dwordx4 v[18:21], v6, s[8:11], s3 offen offset:2048 sc1
    buffer_load_dwordx4 v[22:25], v6, s[8:11], s3 offen offset:3072 sc1
    s_add_u32 s3, s3, 4096
    buffer_load_dwordx4 v[26:29], v6, s[8:11], s3 offen offset:0 sc1
    buffer_load_dwordx4 v[30:33], v6, s[8:11], s3 offen offset:1024 sc1
    buffer_load_dwordx4 v[34:37], v6, s[8:11], s3 offen offset:2048 sc1
    buffer_load_dwordx4 v[38:41], v6, s[8:11], s3 offen offset:3072 sc1
    s_add_u32 s3, s3, 4096
    buffer_load_dwordx4 v[42:45], v6, s[8:11], s3 offen offset:0 sc1
    buffer_load_dwordx4 v[46:49], v6, s[8:11], s3 offen offset:1024 sc1
    buffer_load_dwordx4 v[50:53], v6, s[8:11], s3 offen offset:2048 sc1
    buffer_load_dwordx4 v[54:57], v6, s[8:11], s3 offen offset:3072 sc1
    s_add_u32 s3, s3, 4096
    buffer_load_dwordx4 v[58:61], v6, s[8:11], s3 offen offset:0 sc1
    buffer_load_dwordx4 v[62:65], v6, s[8:11], s3 offen offset:1024 sc1
    buffer_load_dwordx4 v[66:69], v6, s[8:11], s3 offen offset:2048 sc1
    buffer_load_dwordx4 v[70:73], v6, s[8:11], s3 offen offset:3072 sc1
    s_add_u32 s3, s3, 4096
    buffer_load_dwordx4 v[74:77], v6, s[8:11], s3 offen offset:0 sc1
    buffer_load_dwordx4 v[78:81], v6, s[8:11], s3 offen offset:1024 sc1
    buffer_load_dwordx4 v[82:85], v6, s[8:11], s3 offen offset:2048 sc1
    buffer_load_dwordx4 v[86:89], v6, s[8:11], s3 offen offset:3072 sc1
    s_add_u32 s3, s3, 4096
    v_add_u32 v2, 84992, v6
    v_add_u32_e64 v3, 0, v6
    ds_read_b128 a[0:3], v2 offset:0
    ds_read_b128 a[4:7], v2 offset:1024
    ds_read_b128 a[8:11], v2 offset:2048
    ds_read_b128 a[12:15], v2 offset:3072
    v_lshrrev_b32_e64 v7, 5, v1
    v_bfe_u32 v8, v1, 4, 1
    v_mul_u32_u24 v5, 55296, v8
    v_lshl_add_u32 v5, v7, 8, v5
    v_and_b32_e64 v8, 15, v1
    v_lshl_add_u32 v5, v8, 4, v5
    s_mul_i32 s52, s48, 110592
    s_lshl_b32 s5, s46, 9
    s_add_u32 s52, s52, s5
    s_add_u32 s52, s52, 13107200
    v_mov_b32 v226, 0x3f803f80
    v_mov_b32 v227, 0x3f803f80
    v_accvgpr_write_b32 a24, 0
    v_accvgpr_write_b32 a28, 0
    v_accvgpr_write_b32 a25, 0
    v_accvgpr_write_b32 a29, 0
    v_accvgpr_write_b32 a26, 0
    v_accvgpr_write_b32 a30, 0
    v_accvgpr_write_b32 a27, 0
    v_accvgpr_write_b32 a31, 0
    s_waitcnt vmcnt(19)
    v_permlane16_swap_b32 v10, v12
    v_permlane16_swap_b32 v11, v13
    s_waitcnt vmcnt(18)
    s_waitcnt lgkmcnt(2)
    v_mfma_f32_32x32x16_bf16 v[170:185], a[0:3], v[10:13], 0
    v_permlane16_swap_b32 v14, v16
    v_mfma_f32_4x4x4_16b_bf16 a[24:27], v[226:227], v[10:11], a[24:27]
    v_permlane16_swap_b32 v15, v17
    v_mfma_f32_4x4x4_16b_bf16 a[28:31], v[10:11], v[10:11], a[28:31]
    ds_read_b128 a[16:19], v2 offset:4096
    v_mfma_f32_4x4x4_16b_bf16 a[24:27], v[226:227], v[12:13], a[24:27]
    buffer_load_dwordx4 v[90:93], v6, s[8:11], s3 offen offset:0 sc1
    v_mfma_f32_4x4x4_16b_bf16 a[28:31], v[12:13], v[12:13], a[28:31]
    s_waitcnt vmcnt(18)
    v_mfma_f32_32x32x16_bf16 v[170:185], a[4:7], v[14:17], v[170:185]
    v_permlane16_swap_b32 v18, v20
    v_mfma_f32_4x4x4_16b_bf16 a[24:27], v[226:227], v[14:15], a[24:27]
    v_permlane16_swap_b32 v19, v21
    v_mfma_f32_4x4x4_16b_bf16 a[28:31], v[14:15], v[14:15], a[28:31]
    ds_read_b128 a[20:23], v2 offset:5120
    v_mfma_f32_4x4x4_16b_bf16 a[24:27], v[226:227], v[16:17], a[24:27]
    buffer_load_dwordx4 v[94:97], v6, s[8:11], s3 offen offset:1024 sc1
    v_mfma_f32_4x4x4_16b_bf16 a[28:31], v[16:17], v[16:17], a[28:31]
    s_waitcnt vmcnt(18)
    s_waitcnt lgkmcnt(2)
    v_mfma_f32_32x32x16_bf16 v[170:185], a[8:11], v[18:21], v[170:185]
    v_permlane16_swap_b32 v22, v24
    v_mfma_f32_4x4x4_16b_bf16 a[24:27], v[226:227], v[18:19], a[24:27]
    v_permlane16_swap_b32 v23, v25
    v_mfma_f32_4x4x4_16b_bf16 a[28:31], v[18:19], v[18:19], a[28:31]
    ds_read_b128 a[0:3], v2 offset:6144
    v_mfma_f32_4x4x4_16b_bf16 a[24:27], v[226:227], v[20:21], a[24:27]
    buffer_load_dwordx4 v[98:101], v6, s[8:11], s3 offen offset:2048 sc1
    v_mfma_f32_4x4x4_16b_bf16 a[28:31], v[20:21], v[20:21], a[28:31]
    s_waitcnt vmcnt(18)
    s_nop 0
    v_mfma_f32_32x32x16_bf16 v[170:185], a[12:15], v[22:25], v[170:185]
    v_permlane16_swap_b32 v26, v28
    v_mfma_f32_4x4x4_16b_bf16 a[24:27], v[226:227], v[22:23], a[24:27]
    v_permlane16_swap_b32 v27, v29
    v_mfma_f32_4x4x4_16b_bf16 a[28:31], v[22:23], v[22:23], a[28:31]
    ds_read_b128 a[4:7], v2 offset:7168
    v_mfma_f32_4x4x4_16b_bf16 a[24:27], v[226:227], v[24:25], a[24:27]
    buffer_load_dwordx4 v[102:105], v6, s[8:11], s3 offen offset:3072 sc1
    s_add_u32 s3, s3, 4096
    v_mfma_f32_4x4x4_16b_bf16 a[28:31], v[24:25], v[24:25], a[28:31]
    s_waitcnt vmcnt(18)
    s_waitcnt lgkmcnt(2)
    v_mfma_f32_32x32x16_bf16 v[170:185], a[16:19], v[26:29], v[170:185]
    v_permlane16_swap_b32 v30, v32
    v_mfma_f32_4x4x4_16b_bf16 a[24:27], v[226:227], v[26:27], a[24:27]
    v_permlane16_swap_b32 v31, v33
    v_mfma_f32_4x4x4_16b_bf16 a[28:31], v[26:27], v[26:27], a[28:31]
    ds_read_b128 a[8:11], v2 offset:8192
    v_mfma_f32_4x4x4_16b_bf16 a[24:27], v[226:227], v[28:29], a[24:27]
    buffer_load_dwordx4 v[106:109], v6, s[8:11], s3 offen offset:0 sc1
    v_mfma_f32_4x4x4_16b_bf16 a[28:31], v[28:29], v[28:29], a[28:31]
    s_waitcnt vmcnt(18)
    s_nop 0
    v_mfma_f32_32x32x16_bf16 v[170:185], a[20:23], v[30:33], v[170:185]
    v_permlane16_swap_b32 v34, v36
    v_mfma_f32_4x4x4_16b_bf16 a[24:27], v[226:227], v[30:31], a[24:27]
    v_permlane16_swap_b32 v35, v37
    v_mfma_f32_4x4x4_16b_bf16 a[28:31], v[30:31], v[30:31], a[28:31]
    ds_read_b128 a[12:15], v2 offset:9216
    v_mfma_f32_4x4x4_16b_bf16 a[24:27], v[226:227], v[32:33], a[24:27]
    buffer_load_dwordx4 v[110:113], v6, s[8:11], s3 offen offset:1024 sc1
    v_mfma_f32_4x4x4_16b_bf16 a[28:31], v[32:33], v[32:33], a[28:31]
    s_waitcnt vmcnt(18)
    s_waitcnt lgkmcnt(2)
    v_mfma_f32_32x32x16_bf16 v[170:185], a[0:3], v[34:37], v[170:185]
    v_permlane16_swap_b32 v38, v40
    v_mfma_f32_4x4x4_16b_bf16 a[24:27], v[226:227], v[34:35], a[24:27]
    v_permlane16_swap_b32 v39, v41
    v_mfma_f32_4x4x4_16b_bf16 a[28:31], v[34:35], v[34:35], a[28:31]
    ds_read_b128 a[16:19], v2 offset:10240
    v_mfma_f32_4x4x4_16b_bf16 a[24:27], v[226:227], v[36:37], a[24:27]
    buffer_load_dwordx4 v[114:117], v6, s[8:11], s3 offen offset:2048 sc1
    v_mfma_f32_4x4x4_16b_bf16 a[28:31], v[36:37], v[36:37], a[28:31]
    s_waitcnt vmcnt(18)
    s_nop 0
    v_mfma_f32_32x32x16_bf16 v[170:185], a[4:7], v[38:41], v[170:185]
    v_permlane16_swap_b32 v42, v44
    v_mfma_f32_4x4x4_16b_bf16 a[24:27], v[226:227], v[38:39], a[24:27]
    v_permlane16_swap_b32 v43, v45
    v_mfma_f32_4x4x4_16b_bf16 a[28:31], v[38:39], v[38:39], a[28:31]
    ds_read_b128 a[20:23], v2 offset:11264
    v_mfma_f32_4x4x4_16b_bf16 a[24:27], v[226:227], v[40:41], a[24:27]
    buffer_load_dwordx4 v[118:121], v6, s[8:11], s3 offen offset:3072 sc1
    s_add_u32 s3, s3, 4096
    v_mfma_f32_4x4x4_16b_bf16 a[28:31], v[40:41], v[40:41], a[28:31]
    s_waitcnt vmcnt(18)
    s_waitcnt lgkmcnt(2)
    v_mfma_f32_32x32x16_bf16 v[170:185], a[8:11], v[42:45], v[170:185]
    v_permlane16_swap_b32 v46, v48
    v_mfma_f32_4x4x4_16b_bf16 a[24:27], v[226:227], v[42:43], a[24:27]
    v_permlane16_swap_b32 v47, v49
    v_mfma_f32_4x4x4_16b_bf16 a[28:31], v[42:43], v[42:43], a[28:31]
    ds_read_b128 a[0:3], v2 offset:12288
    v_mfma_f32_4x4x4_16b_bf16 a[24:27], v[226:227], v[44:45], a[24:27]
    buffer_load_dwordx4 v[122:125], v6, s[8:11], s3 offen offset:0 sc1
    v_mfma_f32_4x4x4_16b_bf16 a[28:31], v[44:45], v[44:45], a[28:31]
    s_waitcnt vmcnt(18)
    s_nop 0
    v_mfma_f32_32x32x16_bf16 v[170:185], a[12:15], v[46:49], v[170:185]
    v_permlane16_swap_b32 v50, v52
    v_mfma_f32_4x4x4_16b_bf16 a[24:27], v[226:227], v[46:47], a[24:27]
    v_permlane16_swap_b32 v51, v53
    v_mfma_f32_4x4x4_16b_bf16 a[28:31], v[46:47], v[46:47], a[28:31]
    ds_read_b128 a[4:7], v2 offset:13312
    v_mfma_f32_4x4x4_16b_bf16 a[24:27], v[226:227], v[48:49], a[24:27]
    buffer_load_dwordx4 v[126:129], v6, s[8:11], s3 offen offset:1024 sc1
    v_mfma_f32_4x4x4_16b_bf16 a[28:31], v[48:49], v[48:49], a[28:31]
    s_waitcnt vmcnt(18)
    s_waitcnt lgkmcnt(2)
    v_mfma_f32_32x32x16_bf16 v[170:185], a[16:19], v[50:53], v[170:185]
    v_permlane16_swap_b32 v54, v56
    v_mfma_f32_4x4x4_16b_bf16 a[24:27], v[226:227], v[50:51], a[24:27]
    v_permlane16_swap_b32 v55, v57
    v_mfma_f32_4x4x4_16b_bf16 a[28:31], v[50:51], v[50:51], a[28:31]
    ds_read_b128 a[8:11], v2 offset:14336
    v_mfma_f32_4x4x4_16b_bf16 a[24:27], v[226:227], v[52:53], a[24:27]
    buffer_load_dwordx4 v[130:133], v6, s[8:11], s3 offen offset:2048 sc1
    v_mfma_f32_4x4x4_16b_bf16 a[28:31], v[52:53], v[52:53], a[28:31]
    s_waitcnt vmcnt(18)
    s_nop 0
    v_mfma_f32_32x32x16_bf16 v[170:185], a[20:23], v[54:57], v[170:185]
    v_permlane16_swap_b32 v58, v60
    v_mfma_f32_4x4x4_16b_bf16 a[24:27], v[226:227], v[54:55], a[24:27]
    v_permlane16_swap_b32 v59, v61
    v_mfma_f32_4x4x4_16b_bf16 a[28:31], v[54:55], v[54:55], a[28:31]
    ds_read_b128 a[12:15], v2 offset:15360
    v_mfma_f32_4x4x4_16b_bf16 a[24:27], v[226:227], v[56:57], a[24:27]
    buffer_load_dwordx4 v[134:137], v6, s[8:11], s3 offen offset:3072 sc1
    s_add_u32 s3, s3, 4096
    v_mfma_f32_4x4x4_16b_bf16 a[28:31], v[56:57], v[56:57], a[28:31]
    s_waitcnt vmcnt(18)
    s_waitcnt lgkmcnt(2)
    v_mfma_f32_32x32x16_bf16 v[170:185], a[0:3], v[58:61], v[170:185]
    v_permlane16_swap_b32 v62, v64
    v_mfma_f32_4x4x4_16b_bf16 a[24:27], v[226:227], v[58:59], a[24:27]
    v_permlane16_swap_b32 v63, v65
    v_mfma_f32_4x4x4_16b_bf16 a[28:31], v[58:59], v[58:59], a[28:31]
    ds_read_b128 a[16:19], v2 offset:16384
    v_mfma_f32_4x4x4_16b_bf16 a[24:27], v[226:227], v[60:61], a[24:27]
    buffer_load_dwordx4 v[138:141], v6, s[8:11], s3 offen offset:0 sc1
    v_mfma_f32_4x4x4_16b_bf16 a[28:31], v[60:61], v[60:61], a[28:31]
    s_waitcnt vmcnt(18)
    s_nop 0
    v_mfma_f32_32x32x16_bf16 v[170:185], a[4:7], v[62:65], v[170:185]
    v_permlane16_swap_b32 v66, v68
    v_mfma_f32_4x4x4_16b_bf16 a[24:27], v[226:227], v[62:63], a[24:27]
    v_permlane16_swap_b32 v67, v69
    v_mfma_f32_4x4x4_16b_bf16 a[28:31], v[62:63], v[62:63], a[28:31]
    ds_read_b128 a[20:23], v2 offset:17408
    v_mfma_f32_4x4x4_16b_bf16 a[24:27], v[226:227], v[64:65], a[24:27]
    buffer_load_dwordx4 v[142:145], v6, s[8:11], s3 offen offset:1024 sc1
    v_mfma_f32_4x4x4_16b_bf16 a[28:31], v[64:65], v[64:65], a[28:31]
    s_waitcnt vmcnt(18)
    s_waitcnt lgkmcnt(2)
    v_mfma_f32_32x32x16_bf16 v[170:185], a[8:11], v[66:69], v[170:185]
    v_permlane16_swap_b32 v70, v72
    v_mfma_f32_4x4x4_16b_bf16 a[24:27], v[226:227], v[66:67], a[24:27]
    v_permlane16_swap_b32 v71, v73
    v_mfma_f32_4x4x4_16b_bf16 a[28:31], v[66:67], v[66:67], a[28:31]
    ds_read_b128 a[0:3], v2 offset:18432
    v_mfma_f32_4x4x4_16b_bf16 a[24:27], v[226:227], v[68:69], a[24:27]
    buffer_load_dwordx4 v[146:149], v6, s[8:11], s3 offen offset:2048 sc1
    v_mfma_f32_4x4x4_16b_bf16 a[28:31], v[68:69], v[68:69], a[28:31]
    s_waitcnt vmcnt(18)
    s_nop 0
    v_mfma_f32_32x32x16_bf16 v[170:185], a[12:15], v[70:73], v[170:185]
    v_permlane16_swap_b32 v74, v76
    v_mfma_f32_4x4x4_16b_bf16 a[24:27], v[226:227], v[70:71], a[24:27]
    v_permlane16_swap_b32 v75, v77
    v_mfma_f32_4x4x4_16b_bf16 a[28:31], v[70:71], v[70:71], a[28:31]
    ds_read_b128 a[4:7], v2 offset:19456
    v_mfma_f32_4x4x4_16b_bf16 a[24:27], v[226:227], v[72:73], a[24:27]
    buffer_load_dwordx4 v[150:153], v6, s[8:11], s3 offen offset:3072 sc1
    s_add_u32 s3, s3, 4096
    v_mfma_f32_4x4x4_16b_bf16 a[28:31], v[72:73], v[72:73], a[28:31]
    s_waitcnt vmcnt(18)
    s_waitcnt lgkmcnt(2)
    v_mfma_f32_32x32x16_bf16 v[170:185], a[16:19], v[74:77], v[170:185]
    v_permlane16_swap_b32 v78, v80
    v_mfma_f32_4x4x4_16b_bf16 a[24:27], v[226:227], v[74:75], a[24:27]
    v_permlane16_swap_b32 v79, v81
    v_mfma_f32_4x4x4_16b_bf16 a[28:31], v[74:75], v[74:75], a[28:31]
    ds_read_b128 a[8:11], v2 offset:20480
    v_mfma_f32_4x4x4_16b_bf16 a[24:27], v[226:227], v[76:77], a[24:27]
    buffer_load_dwordx4 v[154:157], v6, s[8:11], s3 offen offset:0 sc1
    v_mfma_f32_4x4x4_16b_bf16 a[28:31], v[76:77], v[76:77], a[28:31]
    s_waitcnt vmcnt(18)
    s_nop 0
    v_mfma_f32_32x32x16_bf16 v[170:185], a[20:23], v[78:81], v[170:185]
    v_permlane16_swap_b32 v82, v84
    v_mfma_f32_4x4x4_16b_bf16 a[24:27], v[226:227], v[78:79], a[24:27]
    v_permlane16_swap_b32 v83, v85
    v_mfma_f32_4x4x4_16b_bf16 a[28:31], v[78:79], v[78:79], a[28:31]
    ds_read_b128 a[12:15], v2 offset:21504
    v_mfma_f32_4x4x4_16b_bf16 a[24:27], v[226:227], v[80:81], a[24:27]
    buffer_load_dwordx4 v[158:161], v6, s[8:11], s3 offen offset:1024 sc1
    v_mfma_f32_4x4x4_16b_bf16 a[28:31], v[80:81], v[80:81], a[28:31]
    s_waitcnt vmcnt(18)
    s_waitcnt lgkmcnt(2)
    v_mfma_f32_32x32x16_bf16 v[170:185], a[0:3], v[82:85], v[170:185]
    v_permlane16_swap_b32 v86, v88
    v_mfma_f32_4x4x4_16b_bf16 a[24:27], v[226:227], v[82:83], a[24:27]
    v_permlane16_swap_b32 v87, v89
    v_mfma_f32_4x4x4_16b_bf16 a[28:31], v[82:83], v[82:83], a[28:31]
    ds_read_b128 a[16:19], v2 offset:22528
    v_mfma_f32_4x4x4_16b_bf16 a[24:27], v[226:227], v[84:85], a[24:27]
    buffer_load_dwordx4 v[162:165], v6, s[8:11], s3 offen offset:2048 sc1
    v_mfma_f32_4x4x4_16b_bf16 a[28:31], v[84:85], v[84:85], a[28:31]
    s_waitcnt vmcnt(18)
    s_nop 0
    v_mfma_f32_32x32x16_bf16 v[170:185], a[4:7], v[86:89], v[170:185]
    v_permlane16_swap_b32 v90, v92
    v_mfma_f32_4x4x4_16b_bf16 a[24:27], v[226:227], v[86:87], a[24:27]
    v_permlane16_swap_b32 v91, v93
    v_mfma_f32_4x4x4_16b_bf16 a[28:31], v[86:87], v[86:87], a[28:31]
    ds_read_b128 a[20:23], v2 offset:23552
    v_mfma_f32_4x4x4_16b_bf16 a[24:27], v[226:227], v[88:89], a[24:27]
    buffer_load_dwordx4 v[166:169], v6, s[8:11], s3 offen offset:3072 sc1
    v_mfma_f32_4x4x4_16b_bf16 a[28:31], v[88:89], v[88:89], a[28:31]
    s_waitcnt vmcnt(18)
    s_waitcnt lgkmcnt(2)
    v_mfma_f32_32x32x16_bf16 v[170:185], a[8:11], v[90:93], v[170:185]
    v_permlane16_swap_b32 v94, v96
    v_mfma_f32_4x4x4_16b_bf16 a[24:27], v[226:227], v[90:91], a[24:27]
    v_permlane16_swap_b32 v95, v97
    v_mfma_f32_4x4x4_16b_bf16 a[28:31], v[90:91], v[90:91], a[28:31]
    ds_read_b128 a[0:3], v2 offset:24576
    v_mfma_f32_4x4x4_16b_bf16 a[24:27], v[226:227], v[92:93], a[24:27]
    s_add_u32 m0, s53, 41984
    s_mov_b32 s5, s51
    buffer_load_dwordx4 v6, s[12:15], s5 offen offset:0 sc1 lds
    v_mfma_f32_4x4x4_16b_bf16 a[28:31], v[92:93], v[92:93], a[28:31]
    s_waitcnt vmcnt(18)
    v_mfma_f32_32x32x16_bf16 v[170:185], a[12:15], v[94:97], v[170:185]
    v_permlane16_swap_b32 v98, v100
    v_mfma_f32_4x4x4_16b_bf16 a[24:27], v[226:227], v[94:95], a[24:27]
    v_permlane16_swap_b32 v99, v101
    v_mfma_f32_4x4x4_16b_bf16 a[28:31], v[94:95], v[94:95], a[28:31]
    ds_read_b128 a[4:7], v2 offset:25600
    v_mfma_f32_4x4x4_16b_bf16 a[24:27], v[226:227], v[96:97], a[24:27]
    buffer_load_dwordx4 v6, s[12:15], s5 offen offset:1024 sc1 lds
    v_mfma_f32_4x4x4_16b_bf16 a[28:31], v[96:97], v[96:97], a[28:31]
    s_waitcnt vmcnt(18)
    s_waitcnt lgkmcnt(2)
    v_mfma_f32_32x32x16_bf16 v[170:185], a[16:19], v[98:101], v[170:185]
    v_permlane16_swap_b32 v102, v104
    v_mfma_f32_4x4x4_16b_bf16 a[24:27], v[226:227], v[98:99], a[24:27]
    v_permlane16_swap_b32 v103, v105
    v_mfma_f32_4x4x4_16b_bf16 a[28:31], v[98:99], v[98:99], a[28:31]
    ds_read_b128 a[8:11], v2 offset:26624
    v_mfma_f32_4x4x4_16b_bf16 a[24:27], v[226:227], v[100:101], a[24:27]
    buffer_load_dwordx4 v6, s[12:15], s5 offen offset:2048 sc1 lds
    v_mfma_f32_4x4x4_16b_bf16 a[28:31], v[100:101], v[100:101], a[28:31]
    s_waitcnt vmcnt(18)
    s_nop 0
    v_mfma_f32_32x32x16_bf16 v[170:185], a[20:23], v[102:105], v[170:185]
    v_permlane16_swap_b32 v106, v108
    v_mfma_f32_4x4x4_16b_bf16 a[24:27], v[226:227], v[102:103], a[24:27]
    v_permlane16_swap_b32 v107, v109
    v_mfma_f32_4x4x4_16b_bf16 a[28:31], v[102:103], v[102:103], a[28:31]
    ds_read_b128 a[12:15], v2 offset:27648
    v_mfma_f32_4x4x4_16b_bf16 a[24:27], v[226:227], v[104:105], a[24:27]
    buffer_load_dwordx4 v6, s[12:15], s5 offen offset:3072 sc1 lds
    v_mfma_f32_4x4x4_16b_bf16 a[28:31], v[104:105], v[104:105], a[28:31]
    s_waitcnt vmcnt(18)
    s_waitcnt lgkmcnt(2)
    v_mfma_f32_32x32x16_bf16 v[170:185], a[0:3], v[106:109], v[170:185]
    v_permlane16_swap_b32 v110, v112
    v_mfma_f32_4x4x4_16b_bf16 a[24:27], v[226:227], v[106:107], a[24:27]
    v_permlane16_swap_b32 v111, v113
    v_mfma_f32_4x4x4_16b_bf16 a[28:31], v[106:107], v[106:107], a[28:31]
    ds_read_b128 a[16:19], v2 offset:28672
    v_mfma_f32_4x4x4_16b_bf16 a[24:27], v[226:227], v[108:109], a[24:27]
    s_add_u32 m0, m0, 4096
    s_add_u32 s5, s5, 4096
    buffer_load_dwordx4 v6, s[12:15], s5 offen offset:0 sc1 lds
    v_mfma_f32_4x4x4_16b_bf16 a[28:31], v[108:109], v[108:109], a[28:31]
    s_waitcnt vmcnt(18)
    s_nop 0
    v_mfma_f32_32x32x16_bf16 v[170:185], a[4:7], v[110:113], v[170:185]
    v_permlane16_swap_b32 v114, v116
    v_mfma_f32_4x4x4_16b_bf16 a[24:27], v[226:227], v[110:111], a[24:27]
    v_permlane16_swap_b32 v115, v117
    v_mfma_f32_4x4x4_16b_bf16 a[28:31], v[110:111], v[110:111], a[28:31]
    ds_read_b128 a[20:23], v2 offset:29696
    v_mfma_f32_4x4x4_16b_bf16 a[24:27], v[226:227], v[112:113], a[24:27]
    buffer_load_dwordx4 v6, s[12:15], s5 offen offset:1024 sc1 lds
    v_mfma_f32_4x4x4_16b_bf16 a[28:31], v[112:113], v[112:113], a[28:31]
    s_waitcnt vmcnt(18)
    s_waitcnt lgkmcnt(2)
    v_mfma_f32_32x32x16_bf16 v[170:185], a[8:11], v[114:117], v[170:185]
    v_permlane16_swap_b32 v118, v120
    v_mfma_f32_4x4x4_16b_bf16 a[24:27], v[226:227], v[114:115], a[24:27]
    v_permlane16_swap_b32 v119, v121
    v_mfma_f32_4x4x4_16b_bf16 a[28:31], v[114:115], v[114:115], a[28:31]
    ds_read_b128 a[0:3], v2 offset:30720
    v_mfma_f32_4x4x4_16b_bf16 a[24:27], v[226:227], v[116:117], a[24:27]
    buffer_load_dwordx4 v6, s[12:15], s5 offen offset:2048 sc1 lds
    v_mfma_f32_4x4x4_16b_bf16 a[28:31], v[116:117], v[116:117], a[28:31]
    s_waitcnt vmcnt(18)
    s_nop 0
    v_mfma_f32_32x32x16_bf16 v[170:185], a[12:15], v[118:121], v[170:185]
    v_permlane16_swap_b32 v122, v124
    v_mfma_f32_4x4x4_16b_bf16 a[24:27], v[226:227], v[118:119], a[24:27]
    v_permlane16_swap_b32 v123, v125
    v_mfma_f32_4x4x4_16b_bf16 a[28:31], v[118:119], v[118:119], a[28:31]
    ds_read_b128 a[4:7], v2 offset:31744
    v_mfma_f32_4x4x4_16b_bf16 a[24:27], v[226:227], v[120:121], a[24:27]
    buffer_load_dwordx4 v6, s[12:15], s5 offen offset:3072 sc1 lds
    v_mfma_f32_4x4x4_16b_bf16 a[28:31], v[120:121], v[120:121], a[28:31]
    s_waitcnt vmcnt(18)
    s_waitcnt lgkmcnt(2)
    v_mfma_f32_32x32x16_bf16 v[170:185], a[16:19], v[122:125], v[170:185]
    v_permlane16_swap_b32 v126, v128
    v_mfma_f32_4x4x4_16b_bf16 a[24:27], v[226:227], v[122:123], a[24:27]
    v_permlane16_swap_b32 v127, v129
    v_mfma_f32_4x4x4_16b_bf16 a[28:31], v[122:123], v[122:123], a[28:31]
    ds_read_b128 a[8:11], v2 offset:32768
    v_mfma_f32_4x4x4_16b_bf16 a[24:27], v[226:227], v[124:125], a[24:27]
    s_add_u32 m0, m0, 4096
    s_add_u32 s5, s5, 4096
    buffer_load_dwordx4 v6, s[12:15], s5 offen offset:0 sc1 lds
    v_mfma_f32_4x4x4_16b_bf16 a[28:31], v[124:125], v[124:125], a[28:31]
    s_waitcnt vmcnt(18)
    s_nop 0
    v_mfma_f32_32x32x16_bf16 v[170:185], a[20:23], v[126:129], v[170:185]
    v_permlane16_swap_b32 v130, v132
    v_mfma_f32_4x4x4_16b_bf16 a[24:27], v[226:227], v[126:127], a[24:27]
    v_permlane16_swap_b32 v131, v133
    v_mfma_f32_4x4x4_16b_bf16 a[28:31], v[126:127], v[126:127], a[28:31]
    ds_read_b128 a[12:15], v2 offset:33792
    v_mfma_f32_4x4x4_16b_bf16 a[24:27], v[226:227], v[128:129], a[24:27]
    buffer_load_dwordx4 v6, s[12:15], s5 offen offset:1024 sc1 lds
    v_mfma_f32_4x4x4_16b_bf16 a[28:31], v[128:129], v[128:129], a[28:31]
    s_waitcnt vmcnt(18)
    s_waitcnt lgkmcnt(2)
    v_mfma_f32_32x32x16_bf16 v[170:185], a[0:3], v[130:133], v[170:185]
    v_permlane16_swap_b32 v134, v136
    v_mfma_f32_4x4x4_16b_bf16 a[24:27], v[226:227], v[130:131], a[24:27]
    v_permlane16_swap_b32 v135, v137
    v_mfma_f32_4x4x4_16b_bf16 a[28:31], v[130:131], v[130:131], a[28:31]
    ds_read_b128 a[16:19], v2 offset:34816
    v_mfma_f32_4x4x4_16b_bf16 a[24:27], v[226:227], v[132:133], a[24:27]
    buffer_load_dwordx4 v6, s[12:15], s5 offen offset:2048 sc1 lds
    s_add_u32 s51, s51, 41984
    v_mfma_f32_4x4x4_16b_bf16 a[28:31], v[132:133], v[132:133], a[28:31]
    s_waitcnt vmcnt(18)
    v_mfma_f32_32x32x16_bf16 v[170:185], a[4:7], v[134:137], v[170:185]
    v_permlane16_swap_b32 v138, v140
    v_mfma_f32_4x4x4_16b_bf16 a[24:27], v[226:227], v[134:135], a[24:27]
    v_permlane16_swap_b32 v139, v141
    v_mfma_f32_4x4x4_16b_bf16 a[28:31], v[134:135], v[134:135], a[28:31]
    ds_read_b128 a[20:23], v2 offset:35840
    v_mfma_f32_4x4x4_16b_bf16 a[24:27], v[226:227], v[136:137], a[24:27]
    s_add_u32 s6, s57, s64
    buffer_load_dwordx4 a[32:35], v6, s[8:11], s6 offen sc1
    v_mfma_f32_4x4x4_16b_bf16 a[28:31], v[136:137], v[136:137], a[28:31]
    s_waitcnt vmcnt(18)
    s_waitcnt lgkmcnt(2)
    v_mfma_f32_32x32x16_bf16 v[170:185], a[8:11], v[138:141], v[170:185]
    v_permlane16_swap_b32 v142, v144
    v_mfma_f32_4x4x4_16b_bf16 a[24:27], v[226:227], v[138:139], a[24:27]
    v_permlane16_swap_b32 v143, v145
    v_mfma_f32_4x4x4_16b_bf16 a[28:31], v[138:139], v[138:139], a[28:31]
    ds_read_b128 a[0:3], v2 offset:36864
    v_mfma_f32_4x4x4_16b_bf16 a[24:27], v[226:227], v[140:141], a[24:27]
    s_add_u32 s6, s58, s64
    buffer_load_dwordx4 a[36:39], v6, s[8:11], s6 offen sc1
    v_mfma_f32_4x4x4_16b_bf16 a[28:31], v[140:141], v[140:141], a[28:31]
    s_waitcnt vmcnt(18)
    v_mfma_f32_32x32x16_bf16 v[170:185], a[12:15], v[142:145], v[170:185]
    v_permlane16_swap_b32 v146, v148
    v_mfma_f32_4x4x4_16b_bf16 a[24:27], v[226:227], v[142:143], a[24:27]
    v_permlane16_swap_b32 v147, v149
    v_mfma_f32_4x4x4_16b_bf16 a[28:31], v[142:143], v[142:143], a[28:31]
    ds_read_b128 a[4:7], v2 offset:37888
    v_mfma_f32_4x4x4_16b_bf16 a[24:27], v[226:227], v[144:145], a[24:27]
    s_add_u32 s6, s59, s64
    s_nop 0
    buffer_load_dwordx4 a[40:43], v6, s[8:11], s6 offen sc1
    v_mfma_f32_4x4x4_16b_bf16 a[28:31], v[144:145], v[144:145], a[28:31]
    s_waitcnt vmcnt(18)
    s_waitcnt lgkmcnt(2)
    v_mfma_f32_32x32x16_bf16 v[170:185], a[16:19], v[146:149], v[170:185]
    v_permlane16_swap_b32 v150, v152
    v_mfma_f32_4x4x4_16b_bf16 a[24:27], v[226:227], v[146:147], a[24:27]
    v_permlane16_swap_b32 v151, v153
    v_mfma_f32_4x4x4_16b_bf16 a[28:31], v[146:147], v[146:147], a[28:31]
    ds_read_b128 a[8:11], v2 offset:38912
    v_mfma_f32_4x4x4_16b_bf16 a[24:27], v[226:227], v[148:149], a[24:27]
    s_add_u32 s6, s60, s64
    buffer_load_dwordx4 a[44:47], v6, s[8:11], s6 offen sc1
    v_mfma_f32_4x4x4_16b_bf16 a[28:31], v[148:149], v[148:149], a[28:31]
    s_waitcnt vmcnt(18)
    v_mfma_f32_32x32x16_bf16 v[170:185], a[20:23], v[150:153], v[170:185]
    v_permlane16_swap_b32 v154, v156
    v_mfma_f32_4x4x4_16b_bf16 a[24:27], v[226:227], v[150:151], a[24:27]
    v_permlane16_swap_b32 v155, v157
    v_mfma_f32_4x4x4_16b_bf16 a[28:31], v[150:151], v[150:151], a[28:31]
    ds_read_b128 a[12:15], v2 offset:39936
    v_mfma_f32_4x4x4_16b_bf16 a[24:27], v[226:227], v[152:153], a[24:27]
    s_add_u32 s6, s61, s64
    buffer_load_dwordx4 a[48:51], v6, s[8:11], s6 offen sc1
    v_mfma_f32_4x4x4_16b_bf16 a[28:31], v[152:153], v[152:153], a[28:31]
    s_waitcnt vmcnt(18)
    s_waitcnt lgkmcnt(2)
    v_mfma_f32_32x32x16_bf16 v[170:185], a[0:3], v[154:157], v[170:185]
    v_permlane16_swap_b32 v158, v160
    v_mfma_f32_4x4x4_16b_bf16 a[24:27], v[226:227], v[154:155], a[24:27]
    v_permlane16_swap_b32 v159, v161
    v_mfma_f32_4x4x4_16b_bf16 a[28:31], v[154:155], v[154:155], a[28:31]
    ds_read_b128 a[16:19], v2 offset:40960
    v_mfma_f32_4x4x4_16b_bf16 a[24:27], v[226:227], v[156:157], a[24:27]
    s_add_u32 s6, s57, s65
    buffer_load_dwordx4 a[52:55], v6, s[8:11], s6 offen sc1
    v_mfma_f32_4x4x4_16b_bf16 a[28:31], v[156:157], v[156:157], a[28:31]
    s_waitcnt vmcnt(18)
    v_mfma_f32_32x32x16_bf16 v[170:185], a[4:7], v[158:161], v[170:185]
    v_permlane16_swap_b32 v162, v164
    v_mfma_f32_4x4x4_16b_bf16 a[24:27], v[226:227], v[158:159], a[24:27]
    v_permlane16_swap_b32 v163, v165
    v_mfma_f32_4x4x4_16b_bf16 a[28:31], v[158:159], v[158:159], a[28:31]
    v_mfma_f32_4x4x4_16b_bf16 a[24:27], v[226:227], v[160:161], a[24:27]
    s_add_u32 s6, s58, s65
    buffer_load_dwordx4 a[56:59], v6, s[8:11], s6 offen sc1
    v_mfma_f32_4x4x4_16b_bf16 a[28:31], v[160:161], v[160:161], a[28:31]
    s_waitcnt lgkmcnt(0)
    s_barrier
    ds_read_b128 a[0:3], v3 offset:0
    s_waitcnt vmcnt(18)
    v_mfma_f32_32x32x16_bf16 v[170:185], a[8:11], v[162:165], v[170:185]
    v_permlane16_swap_b32 v166, v168
    v_mfma_f32_4x4x4_16b_bf16 a[24:27], v[226:227], v[162:163], a[24:27]
    v_permlane16_swap_b32 v167, v169
    v_mfma_f32_4x4x4_16b_bf16 a[28:31], v[162:163], v[162:163], a[28:31]
    v_mfma_f32_4x4x4_16b_bf16 a[24:27], v[226:227], v[164:165], a[24:27]
    s_add_u32 s6, s59, s65
    buffer_load_dwordx4 a[60:63], v6, s[8:11], s6 offen sc1
    v_mfma_f32_4x4x4_16b_bf16 a[28:31], v[164:165], v[164:165], a[28:31]
    ds_read_b128 a[4:7], v3 offset:1024
    v_mfma_f32_32x32x16_bf16 v[170:185], a[12:15], v[166:169], v[170:185]
    v_mfma_f32_4x4x4_16b_bf16 a[24:27], v[226:227], v[166:167], a[24:27]
    v_mfma_f32_4x4x4_16b_bf16 a[28:31], v[166:167], v[166:167], a[28:31]
    s_nop 0
    v_mfma_f32_4x4x4_16b_bf16 a[24:27], v[226:227], v[168:169], a[24:27]
    v_mfma_f32_4x4x4_16b_bf16 a[28:31], v[168:169], v[168:169], a[28:31]
    ds_read_b128 a[8:11], v3 offset:2048
    s_nop 2
    v_accvgpr_read_b32 v228, a24
    v_accvgpr_read_b32 v230, a28
    v_accvgpr_read_b32 v231, a29
    v_accvgpr_read_b32 v232, a30
    v_accvgpr_read_b32 v233, a31
    v_and_b32 v7, 3, v1
    v_cmp_eq_u32 vcc, 1, v7
    s_nop 1
    v_cndmask_b32 v230, v230, v231, vcc
    v_cmp_eq_u32 vcc, 2, v7
    s_nop 1
    v_cndmask_b32 v230, v230, v232, vcc
    v_cmp_eq_u32 vcc, 3, v7
    s_nop 1
    v_cndmask_b32 v230, v230, v233, vcc
    v_mov_b32 v234, v228
    s_nop 1
    v_permlane32_swap_b32 v234, v228
    v_add_f32 v228, v228, v234
    v_mov_b32 v234, v230
    s_nop 1
    v_permlane32_swap_b32 v234, v230
    v_add_f32 v230, v230, v234
    v_mul_f32 v228, 0xbacccccd, v228
    v_mul_f32 v230, 0x3acccccd, v230
    v_fma_f32 v230, -v228, v228, v230
    v_max_f32_e64 v230, 0, v230
    v_add_f32 v208, 0x3727c5ac, v230
    v_rsq_f32 v229, v208
    v_sqrt_f32 v231, v208
    v_mul_f32 v206, 0xc0135761, v229
    v_mul_f32 v232, v229, v229
    v_mul_f32 v232, v232, v229
    v_mul_f32 v207, 0xbdd2d3e8, v232
    v_cvt_pk_bf16_f32 v233, v228, v228
    v_lshlrev_b32 v233, 16, v233
    v_sub_f32 v234, v228, v233
    v_cvt_pk_bf16_f32 v235, v231, v231
    v_lshlrev_b32 v235, 16, v235
    v_sub_f32 v236, v231, v235
    v_cvt_pk_bf16_f32 v202, v233, v234
    v_cvt_pk_bf16_f32 v203, v233, v235
    v_cvt_pk_bf16_f32 v204, v236, v235
    v_mov_b32 v205, 0
    s_nop 1
    v_mfma_f32_32x32x16_bf16 v[170:185], a[16:19], v[202:205], v[170:185]
    ds_read_b128 a[12:15], v3 offset:3072
    v_mov_b32 v2, v3
    v_add_u32 v3, 41984, v6
    s_getpc_b64 s[98:99]
L_pcx6:
    s_sub_u32 s98, s98, (L_pcx6-adaLN_cond__ssm_conv_s4d__glu_gated_geglu__prompt_kernel)
    s_subb_u32 s99, s99, 0
    s_add_u32 s28, s98, (L_g1fin1x-adaLN_cond__ssm_conv_s4d__glu_gated_geglu__prompt_kernel)
    s_addc_u32 s29, s99, 0
    s_mov_b32 s30, (L_codeend-L_g1fin1x)
    s_mov_b32 s31, 0x00020000
    v_lshlrev_b32_e64 v228, 7, v0
    buffer_load_dword v229, v228, s[28:31], 0 offen
    s_cmp_gt_u32 s47, 3
    s_cselect_b32 s14, 0x2000000, 0
    s_waitcnt lgkmcnt(2)
    v_mfma_f32_32x32x16_bf16 v[186:201], a[0:3], v[10:13], 0
    ds_read_b128 a[16:19], v2 offset:4096
    s_add_u32 m0, s53, 84992
    s_mov_b32 s5, s51
    buffer_load_dwordx4 v6, s[12:15], s5 offen offset:0 sc1 lds
    v_mfma_f32_32x32x16_bf16 v[186:201], a[4:7], v[14:17], v[186:201]
    ds_read_b128 a[20:23], v2 offset:5120
    s_waitcnt lgkmcnt(2)
    v_mfma_f32_32x32x16_bf16 v[186:201], a[8:11], v[18:21], v[186:201]
    ds_read_b128 a[0:3], v2 offset:6144
    buffer_load_dwordx4 v6, s[12:15], s5 offen offset:1024 sc1 lds
    v_mul_f32 v210, v170, v170
    v_mul_f32 v211, v171, v171
    v_mfma_f32_32x32x16_bf16 v[186:201], a[12:15], v[22:25], v[186:201]
    ds_read_b128 a[4:7], v2 offset:7168
    v_mul_f32_e64 v212, v172, v172
    v_mul_f32 v213, v173, v173
    s_waitcnt lgkmcnt(2)
    v_mfma_f32_32x32x16_bf16 v[186:201], a[16:19], v[26:29], v[186:201]
    ds_read_b128 a[8:11], v2 offset:8192
    buffer_load_dwordx4 v6, s[12:15], s5 offen offset:2048 sc1 lds
    v_fma_f32 v214, v210, v207, v206
    v_fma_f32 v215, v211, v207, v206
    v_mfma_f32_32x32x16_bf16 v[186:201], a[20:23], v[30:33], v[186:201]
    ds_read_b128 a[12:15], v2 offset:9216
    v_fma_f32 v216, v212, v207, v206
    v_fma_f32 v217, v213, v207, v206
    s_waitcnt lgkmcnt(2)
    v_mfma_f32_32x32x16_bf16 v[186:201], a[0:3], v[34:37], v[186:201]
    ds_read_b128 a[16:19], v2 offset:10240
    buffer_load_dwordx4 v6, s[12:15], s5 offen offset:3072 sc1 lds
    v_mul_f32 v214, v170, v214
    v_mul_f32_e64 v215, v171, v215
    v_mfma_f32_32x32x16_bf16 v[186:201], a[4:7], v[38:41], v[186:201]
    ds_read_b128 a[20:23], v2 offset:11264
    v_mul_f32_e64 v216, v172, v216
    v_mul_f32 v217, v173, v217
    s_waitcnt lgkmcnt(2)
    v_mfma_f32_32x32x16_bf16 v[186:201], a[8:11], v[42:45], v[186:201]
    ds_read_b128 a[0:3], v2 offset:12288
    s_add_u32 m0, m0, 4096
    s_add_u32 s5, s5, 4096
    buffer_load_dwordx4 v6, s[12:15], s5 offen offset:0 sc1 lds
    v_exp_f32 v214, v214
    v_exp_f32 v215, v215
    v_mfma_f32_32x32x16_bf16 v[186:201], a[12:15], v[46:49], v[186:201]
    ds_read_b128 a[4:7], v2 offset:13312
    v_exp_f32_e64 v216, v216
    v_exp_f32 v217, v217
    s_waitcnt lgkmcnt(2)
    v_mfma_f32_32x32x16_bf16 v[186:201], a[16:19], v[50:53], v[186:201]
    ds_read_b128 a[8:11], v2 offset:14336
    buffer_load_dwordx4 v6, s[12:15], s5 offen offset:1024 sc1 lds
    v_mul_f32 v218, v170, v178
    v_mul_f32 v219, v171, v179
    v_mfma_f32_32x32x16_bf16 v[186:201], a[20:23], v[54:57], v[186:201]
    ds_read_b128 a[12:15], v2 offset:15360
    v_mul_f32_e64 v220, v172, v180
    v_mul_f32 v221, v173, v181
    s_waitcnt lgkmcnt(2)
    v_mfma_f32_32x32x16_bf16 v[186:201], a[0:3], v[58:61], v[186:201]
    ds_read_b128 a[16:19], v2 offset:16384
    buffer_load_dwordx4 v6, s[12:15], s5 offen offset:2048 sc1 lds
    v_fma_f32 v214, v214, v208, v208
    v_fma_f32 v215, v215, v208, v208
    v_mfma_f32_32x32x16_bf16 v[186:201], a[4:7], v[62:65], v[186:201]
    ds_read_b128 a[20:23], v2 offset:17408
    v_fma_f32 v216, v216, v208, v208
    v_fma_f32 v217, v217, v208, v208
    s_waitcnt lgkmcnt(2)
    v_mfma_f32_32x32x16_bf16 v[186:201], a[8:11], v[66:69], v[186:201]
    ds_read_b128 a[0:3], v2 offset:18432
    buffer_load_dwordx4 v6, s[12:15], s5 offen offset:3072 sc1 lds
    v_rcp_f32 v214, v214
    v_rcp_f32_e64 v215, v215
    v_mfma_f32_32x32x16_bf16 v[186:201], a[12:15], v[70:73], v[186:201]
    ds_read_b128 a[4:7], v2 offset:19456
    v_rcp_f32_e64 v216, v216
    v_rcp_f32 v217, v217
    s_waitcnt lgkmcnt(2)
    v_mfma_f32_32x32x16_bf16 v[186:201], a[16:19], v[74:77], v[186:201]
    ds_read_b128 a[8:11], v2 offset:20480
    s_add_u32 m0, m0, 4096
    s_add_u32 s5, s5, 4096
    buffer_load_dwordx4 v6, s[12:15], s5 offen offset:0 sc1 lds
    v_mul_f32 v218, v218, v214
    v_mul_f32 v219, v219, v215
    v_mfma_f32_32x32x16_bf16 v[186:201], a[20:23], v[78:81], v[186:201]
    ds_read_b128 a[12:15], v2 offset:21504
    v_mul_f32_e64 v220, v220, v216
    v_mul_f32 v221, v221, v217
    s_waitcnt lgkmcnt(2)
    v_mfma_f32_32x32x16_bf16 v[186:201], a[0:3], v[82:85], v[186:201]
    ds_read_b128 a[16:19], v2 offset:22528
    buffer_load_dwordx4 v6, s[12:15], s5 offen offset:1024 sc1 lds
    v_cvt_pk_bf16_f32 v222, v218, v219
    v_cvt_pk_bf16_f32 v223, v220, v221
    v_mfma_f32_32x32x16_bf16 v[186:201], a[4:7], v[86:89], v[186:201]
    ds_read_b128 a[20:23], v2 offset:23552
    v_mul_f32_e64 v210, v174, v174
    v_mul_f32 v211, v175, v175
    s_waitcnt lgkmcnt(2)
    v_mfma_f32_32x32x16_bf16 v[186:201], a[8:11], v[90:93], v[186:201]
    ds_read_b128 a[0:3], v2 offset:24576
    buffer_load_dwordx4 v6, s[12:15], s5 offen offset:2048 sc1 lds
    v_mul_f32 v212, v176, v176
    v_mul_f32 v213, v177, v177
    v_mfma_f32_32x32x16_bf16 v[186:201], a[12:15], v[94:97], v[186:201]
    ds_read_b128 a[4:7], v2 offset:25600
    v_fma_f32 v214, v210, v207, v206
    v_fma_f32 v215, v211, v207, v206
    s_waitcnt lgkmcnt(2)
    s_nop 0
    v_mfma_f32_32x32x16_bf16 v[186:201], a[16:19], v[98:101], v[186:201]
    ds_read_b128 a[8:11], v2 offset:26624
    s_add_u32 s51, s51, 41984
    v_fma_f32 v216, v212, v207, v206
    v_fma_f32 v217, v213, v207, v206
    v_mfma_f32_32x32x16_bf16 v[186:201], a[20:23], v[102:105], v[186:201]
    ds_read_b128 a[12:15], v2 offset:27648
    s_add_u32 s6, s60, s65
    buffer_load_dwordx4 a[64:67], v6, s[8:11], s6 offen sc1
    v_mul_f32 v214, v174, v214
    v_mul_f32 v215, v175, v215
    s_waitcnt lgkmcnt(2)
    v_mfma_f32_32x32x16_bf16 v[186:201], a[0:3], v[106:109], v[186:201]
    ds_read_b128 a[16:19], v2 offset:28672
    v_mul_f32 v216, v176, v216
    v_mul_f32 v217, v177, v217
    v_mfma_f32_32x32x16_bf16 v[186:201], a[4:7], v[110:113], v[186:201]
    ds_read_b128 a[20:23], v2 offset:29696
    s_add_u32 s6, s61, s65
    buffer_load_dwordx4 a[68:71], v6, s[8:11], s6 offen sc1
    v_exp_f32 v214, v214
    v_exp_f32 v215, v215
    s_waitcnt lgkmcnt(2)
    v_mfma_f32_32x32x16_bf16 v[186:201], a[8:11], v[114:117], v[186:201]
    ds_read_b128 a[0:3], v2 offset:30720
    v_exp_f32 v216, v216
    v_exp_f32 v217, v217
    v_mfma_f32_32x32x16_bf16 v[186:201], a[12:15], v[118:121], v[186:201]
    ds_read_b128 a[4:7], v2 offset:31744
    s_add_u32 s6, s57, s66
    buffer_load_dwordx4 a[72:75], v6, s[8:11], s6 offen sc1
    v_mul_f32 v218, v174, v182
    v_mul_f32 v219, v175, v183
    s_waitcnt lgkmcnt(2)
    v_mfma_f32_32x32x16_bf16 v[186:201], a[16:19], v[122:125], v[186:201]
    ds_read_b128 a[8:11], v2 offset:32768
    v_mul_f32 v220, v176, v184
    v_mul_f32 v221, v177, v185
    v_mfma_f32_32x32x16_bf16 v[186:201], a[20:23], v[126:129], v[186:201]
    ds_read_b128 a[12:15], v2 offset:33792
    s_add_u32 s6, s58, s66
    buffer_load_dwordx4 a[76:79], v6, s[8:11], s6 offen sc1
    v_fma_f32 v214, v214, v208, v208
    v_fma_f32 v215, v215, v208, v208
    s_waitcnt lgkmcnt(2)
    v_mfma_f32_32x32x16_bf16 v[186:201], a[0:3], v[130:133], v[186:201]
    ds_read_b128 a[16:19], v2 offset:34816
    v_fma_f32 v216, v216, v208, v208
    v_fma_f32 v217, v217, v208, v208
    v_mfma_f32_32x32x16_bf16 v[186:201], a[4:7], v[134:137], v[186:201]
    ds_read_b128 a[20:23], v2 offset:35840
    s_add_u32 s6, s59, s66
    buffer_load_dwordx4 a[80:83], v6, s[8:11], s6 offen sc1
    v_rcp_f32 v214, v214
    v_rcp_f32 v215, v215
    s_waitcnt lgkmcnt(2)
    v_mfma_f32_32x32x16_bf16 v[186:201], a[8:11], v[138:141], v[186:201]
    ds_read_b128 a[0:3], v2 offset:36864
    v_rcp_f32 v216, v216
    v_rcp_f32 v217, v217
    v_mfma_f32_32x32x16_bf16 v[186:201], a[12:15], v[142:145], v[186:201]
    ds_read_b128 a[4:7], v2 offset:37888
    s_add_u32 s6, s60, s66
    buffer_load_dwordx4 a[84:87], v6, s[8:11], s6 offen sc1
    v_mul_f32 v218, v218, v214
    v_mul_f32 v219, v219, v215
    s_waitcnt lgkmcnt(2)
    v_mfma_f32_32x32x16_bf16 v[186:201], a[16:19], v[146:149], v[186:201]
    ds_read_b128 a[8:11], v2 offset:38912
    v_mul_f32 v220, v220, v216
    v_mul_f32 v221, v221, v217
    v_mfma_f32_32x32x16_bf16 v[186:201], a[20:23], v[150:153], v[186:201]
    ds_read_b128 a[12:15], v2 offset:39936
    v_cvt_pk_bf16_f32 v224, v218, v219
    v_cvt_pk_bf16_f32 v225, v220, v221
    s_waitcnt lgkmcnt(2)
    s_nop 0
    v_mfma_f32_32x32x16_bf16 v[186:201], a[0:3], v[154:157], v[186:201]
    ds_read_b128 a[16:19], v2 offset:40960
    buffer_store_dwordx4 v[222:225], v5, s[8:11], s52 offen sc1
    s_add_u32 s52, s52, 512
    v_mfma_f32_32x32x16_bf16 v[186:201], a[4:7], v[158:161], v[186:201]
    s_waitcnt vmcnt(27) lgkmcnt(0)
    s_barrier
    ds_read_b128 a[0:3], v3 offset:0
    v_mfma_f32_32x32x16_bf16 v[186:201], a[8:11], v[162:165], v[186:201]
    ds_read_b128 a[4:7], v3 offset:1024
    v_mfma_f32_32x32x16_bf16 v[186:201], a[12:15], v[166:169], v[186:201]
    ds_read_b128 a[8:11], v3 offset:2048
    v_mfma_f32_32x32x16_bf16 v[186:201], a[16:19], v[202:205], v[186:201]
    ds_read_b128 a[12:15], v3 offset:3072
    v_mov_b32_e64 v2, v3
    v_add_u32 v3, 84992, v6
    s_cmp_gt_u32 s47, 4
    s_cselect_b32 s14, 0x2000000, 0
    s_waitcnt lgkmcnt(2)
    v_mfma_f32_32x32x16_bf16 v[170:185], a[0:3], v[10:13], 0
    ds_read_b128 a[16:19], v2 offset:4096
    s_add_u32 m0, s53, 0
    s_mov_b32 s5, s51
    buffer_load_dwordx4 v6, s[12:15], s5 offen offset:0 sc1 lds
    v_mfma_f32_32x32x16_bf16 v[170:185], a[4:7], v[14:17], v[170:185]
    ds_read_b128 a[20:23], v2 offset:5120
    s_waitcnt lgkmcnt(2)
    v_mfma_f32_32x32x16_bf16 v[170:185], a[8:11], v[18:21], v[170:185]
    ds_read_b128 a[0:3], v2 offset:6144
    buffer_load_dwordx4 v6, s[12:15], s5 offen offset:1024 sc1 lds
    v_mul_f32 v210, v186, v186
    v_mul_f32_e64 v211, v187, v187
    v_mfma_f32_32x32x16_bf16 v[170:185], a[12:15], v[22:25], v[170:185]
    ds_read_b128 a[4:7], v2 offset:7168
    v_mul_f32_e64 v212, v188, v188
    v_mul_f32 v213, v189, v189
    s_waitcnt lgkmcnt(2)
    v_mfma_f32_32x32x16_bf16 v[170:185], a[16:19], v[26:29], v[170:185]
    ds_read_b128 a[8:11], v2 offset:8192
    buffer_load_dwordx4 v6, s[12:15], s5 offen offset:2048 sc1 lds
    v_fma_f32 v214, v210, v207, v206
    v_fma_f32 v215, v211, v207, v206
    v_mfma_f32_32x32x16_bf16 v[170:185], a[20:23], v[30:33], v[170:185]
    ds_read_b128 a[12:15], v2 offset:9216
    v_fma_f32 v216, v212, v207, v206
    v_fma_f32 v217, v213, v207, v206
    s_waitcnt lgkmcnt(2)
    v_mfma_f32_32x32x16_bf16 v[170:185], a[0:3], v[34:37], v[170:185]
    ds_read_b128 a[16:19], v2 offset:10240
    buffer_load_dwordx4 v6, s[12:15], s5 offen offset:3072 sc1 lds
    v_mul_f32 v214, v186, v214
    v_mul_f32_e64 v215, v187, v215
    v_mfma_f32_32x32x16_bf16 v[170:185], a[4:7], v[38:41], v[170:185]
    ds_read_b128 a[20:23], v2 offset:11264
    v_mul_f32_e64 v216, v188, v216
    v_mul_f32 v217, v189, v217
    s_waitcnt lgkmcnt(2)
    v_mfma_f32_32x32x16_bf16 v[170:185], a[8:11], v[42:45], v[170:185]
    ds_read_b128 a[0:3], v2 offset:12288
    s_add_u32 m0, m0, 4096
    s_add_u32 s5, s5, 4096
    buffer_load_dwordx4 v6, s[12:15], s5 offen offset:0 sc1 lds
    v_exp_f32 v214, v214
    v_exp_f32 v215, v215
    v_mfma_f32_32x32x16_bf16 v[170:185], a[12:15], v[46:49], v[170:185]
    ds_read_b128 a[4:7], v2 offset:13312
    v_exp_f32_e64 v216, v216
    v_exp_f32 v217, v217
    s_waitcnt lgkmcnt(2)
    v_mfma_f32_32x32x16_bf16 v[170:185], a[16:19], v[50:53], v[170:185]
    ds_read_b128 a[8:11], v2 offset:14336
    buffer_load_dwordx4 v6, s[12:15], s5 offen offset:1024 sc1 lds
    v_mul_f32 v218, v186, v194
    v_mul_f32 v219, v187, v195
    v_mfma_f32_32x32x16_bf16 v[170:185], a[20:23], v[54:57], v[170:185]
    ds_read_b128 a[12:15], v2 offset:15360
    v_mul_f32_e64 v220, v188, v196
    v_mul_f32 v221, v189, v197
    s_waitcnt lgkmcnt(2)
    v_mfma_f32_32x32x16_bf16 v[170:185], a[0:3], v[58:61], v[170:185]
    ds_read_b128 a[16:19], v2 offset:16384
    buffer_load_dwordx4 v6, s[12:15], s5 offen offset:2048 sc1 lds
    v_fma_f32 v214, v214, v208, v208
    v_fma_f32 v215, v215, v208, v208
    v_mfma_f32_32x32x16_bf16 v[170:185], a[4:7], v[62:65], v[170:185]
    ds_read_b128 a[20:23], v2 offset:17408
    v_fma_f32 v216, v216, v208, v208
    v_fma_f32 v217, v217, v208, v208
    s_waitcnt lgkmcnt(2)
    v_mfma_f32_32x32x16_bf16 v[170:185], a[8:11], v[66:69], v[170:185]
    ds_read_b128 a[0:3], v2 offset:18432
    buffer_load_dwordx4 v6, s[12:15], s5 offen offset:3072 sc1 lds
    v_rcp_f32 v214, v214
    v_rcp_f32_e64 v215, v215
    v_mfma_f32_32x32x16_bf16 v[170:185], a[12:15], v[70:73], v[170:185]
    ds_read_b128 a[4:7], v2 offset:19456
    v_rcp_f32_e64 v216, v216
    v_rcp_f32 v217, v217
    s_waitcnt lgkmcnt(2)
    v_mfma_f32_32x32x16_bf16 v[170:185], a[16:19], v[74:77], v[170:185]
    ds_read_b128 a[8:11], v2 offset:20480
    s_add_u32 m0, m0, 4096
    s_add_u32 s5, s5, 4096
    buffer_load_dwordx4 v6, s[12:15], s5 offen offset:0 sc1 lds
    v_mul_f32 v218, v218, v214
    v_mul_f32 v219, v219, v215
    v_mfma_f32_32x32x16_bf16 v[170:185], a[20:23], v[78:81], v[170:185]
    ds_read_b128 a[12:15], v2 offset:21504
    v_mul_f32_e64 v220, v220, v216
    v_mul_f32 v221, v221, v217
    s_waitcnt lgkmcnt(2)
    v_mfma_f32_32x32x16_bf16 v[170:185], a[0:3], v[82:85], v[170:185]
    ds_read_b128 a[16:19], v2 offset:22528
    buffer_load_dwordx4 v6, s[12:15], s5 offen offset:1024 sc1 lds
    v_cvt_pk_bf16_f32 v222, v218, v219
    v_cvt_pk_bf16_f32 v223, v220, v221
    v_mfma_f32_32x32x16_bf16 v[170:185], a[4:7], v[86:89], v[170:185]
    ds_read_b128 a[20:23], v2 offset:23552
    v_mul_f32_e64 v210, v190, v190
    v_mul_f32 v211, v191, v191
    s_waitcnt lgkmcnt(2)
    v_mfma_f32_32x32x16_bf16 v[170:185], a[8:11], v[90:93], v[170:185]
    ds_read_b128 a[0:3], v2 offset:24576
    buffer_load_dwordx4 v6, s[12:15], s5 offen offset:2048 sc1 lds
    v_mul_f32 v212, v192, v192
    v_mul_f32 v213, v193, v193
    v_mfma_f32_32x32x16_bf16 v[170:185], a[12:15], v[94:97], v[170:185]
    ds_read_b128 a[4:7], v2 offset:25600
    v_fma_f32 v214, v210, v207, v206
    v_fma_f32 v215, v211, v207, v206
    s_waitcnt lgkmcnt(2)
    s_nop 0
    v_mfma_f32_32x32x16_bf16 v[170:185], a[16:19], v[98:101], v[170:185]
    ds_read_b128 a[8:11], v2 offset:26624
    s_add_u32 s51, s51, 41984
    v_fma_f32 v216, v212, v207, v206
    v_fma_f32 v217, v213, v207, v206
    v_mfma_f32_32x32x16_bf16 v[170:185], a[20:23], v[102:105], v[170:185]
    ds_read_b128 a[12:15], v2 offset:27648
    s_add_u32 s6, s61, s66
    buffer_load_dwordx4 a[88:91], v6, s[8:11], s6 offen sc1
    v_mul_f32 v214, v190, v214
    v_mul_f32 v215, v191, v215
    s_waitcnt lgkmcnt(2)
    v_mfma_f32_32x32x16_bf16 v[170:185], a[0:3], v[106:109], v[170:185]
    ds_read_b128 a[16:19], v2 offset:28672
    v_mul_f32 v216, v192, v216
    v_mul_f32 v217, v193, v217
    v_mfma_f32_32x32x16_bf16 v[170:185], a[4:7], v[110:113], v[170:185]
    ds_read_b128 a[20:23], v2 offset:29696
    s_add_u32 s6, s57, s67
    buffer_load_dwordx4 a[92:95], v6, s[8:11], s6 offen sc1
    v_exp_f32 v214, v214
    v_exp_f32 v215, v215
    s_waitcnt lgkmcnt(2)
    v_mfma_f32_32x32x16_bf16 v[170:185], a[8:11], v[114:117], v[170:185]
    ds_read_b128 a[0:3], v2 offset:30720
    v_exp_f32 v216, v216
    v_exp_f32 v217, v217
    v_mfma_f32_32x32x16_bf16 v[170:185], a[12:15], v[118:121], v[170:185]
    ds_read_b128 a[4:7], v2 offset:31744
    s_add_u32 s6, s58, s67
    buffer_load_dwordx4 a[96:99], v6, s[8:11], s6 offen sc1
    v_mul_f32 v218, v190, v198
    v_mul_f32 v219, v191, v199
    s_waitcnt lgkmcnt(2)
    v_mfma_f32_32x32x16_bf16 v[170:185], a[16:19], v[122:125], v[170:185]
    ds_read_b128 a[8:11], v2 offset:32768
    v_mul_f32 v220, v192, v200
    v_mul_f32 v221, v193, v201
    v_mfma_f32_32x32x16_bf16 v[170:185], a[20:23], v[126:129], v[170:185]
    ds_read_b128 a[12:15], v2 offset:33792
    s_add_u32 s6, s59, s67
    buffer_load_dwordx4 a[100:103], v6, s[8:11], s6 offen sc1
    v_fma_f32 v214, v214, v208, v208
    v_fma_f32 v215, v215, v208, v208
    s_waitcnt lgkmcnt(2)
    v_mfma_f32_32x32x16_bf16 v[170:185], a[0:3], v[130:133], v[170:185]
    ds_read_b128 a[16:19], v2 offset:34816
    v_fma_f32 v216, v216, v208, v208
    v_fma_f32 v217, v217, v208, v208
    v_mfma_f32_32x32x16_bf16 v[170:185], a[4:7], v[134:137], v[170:185]
    ds_read_b128 a[20:23], v2 offset:35840
    s_add_u32 s6, s60, s67
    buffer_load_dwordx4 a[104:107], v6, s[8:11], s6 offen sc1
    v_rcp_f32 v214, v214
    v_rcp_f32 v215, v215
    s_waitcnt lgkmcnt(2)
    v_mfma_f32_32x32x16_bf16 v[170:185], a[8:11], v[138:141], v[170:185]
    ds_read_b128 a[0:3], v2 offset:36864
    v_rcp_f32 v216, v216
    v_rcp_f32 v217, v217
    v_mfma_f32_32x32x16_bf16 v[170:185], a[12:15], v[142:145], v[170:185]
    ds_read_b128 a[4:7], v2 offset:37888
    s_add_u32 s6, s61, s67
    buffer_load_dwordx4 a[108:111], v6, s[8:11], s6 offen sc1
    v_mul_f32 v218, v218, v214
    v_mul_f32 v219, v219, v215
    s_waitcnt lgkmcnt(2)
    v_mfma_f32_32x32x16_bf16 v[170:185], a[16:19], v[146:149], v[170:185]
    ds_read_b128 a[8:11], v2 offset:38912
    v_mul_f32 v220, v220, v216
    v_mul_f32 v221, v221, v217
    v_mfma_f32_32x32x16_bf16 v[170:185], a[20:23], v[150:153], v[170:185]
    ds_read_b128 a[12:15], v2 offset:39936
    v_cvt_pk_bf16_f32 v224, v218, v219
    v_cvt_pk_bf16_f32 v225, v220, v221
    s_waitcnt lgkmcnt(2)
    s_nop 0
    v_mfma_f32_32x32x16_bf16 v[170:185], a[0:3], v[154:157], v[170:185]
    ds_read_b128 a[16:19], v2 offset:40960
    buffer_store_dwordx4 v[222:225], v5, s[8:11], s52 offen sc1
    s_add_u32 s52, s52, 512
    v_mfma_f32_32x32x16_bf16 v[170:185], a[4:7], v[158:161], v[170:185]
    s_waitcnt vmcnt(25) lgkmcnt(0)
    s_barrier
    ds_read_b128 a[0:3], v3 offset:0
    v_mfma_f32_32x32x16_bf16 v[170:185], a[8:11], v[162:165], v[170:185]
    ds_read_b128 a[4:7], v3 offset:1024
    v_mfma_f32_32x32x16_bf16 v[170:185], a[12:15], v[166:169], v[170:185]
    ds_read_b128 a[8:11], v3 offset:2048
    v_mfma_f32_32x32x16_bf16 v[170:185], a[16:19], v[202:205], v[170:185]
    ds_read_b128 a[12:15], v3 offset:3072
    v_mov_b32 v2, v3
    v_add_u32 v3, 0, v6
    s_cmp_gt_u32 s47, 5
    s_cselect_b32 s14, 0x2000000, 0
    s_waitcnt lgkmcnt(2)
    v_mfma_f32_32x32x16_bf16 v[186:201], a[0:3], v[10:13], 0
    ds_read_b128 a[16:19], v2 offset:4096
    s_add_u32 m0, s53, 41984
    s_mov_b32 s5, s51
    buffer_load_dwordx4 v6, s[12:15], s5 offen offset:0 sc1 lds
    v_mfma_f32_32x32x16_bf16 v[186:201], a[4:7], v[14:17], v[186:201]
    ds_read_b128 a[20:23], v2 offset:5120
    s_waitcnt lgkmcnt(2)
    v_mfma_f32_32x32x16_bf16 v[186:201], a[8:11], v[18:21], v[186:201]
    ds_read_b128 a[0:3], v2 offset:6144
    buffer_load_dwordx4 v6, s[12:15], s5 offen offset:1024 sc1 lds
    v_mul_f32 v210, v170, v170
    v_mul_f32 v211, v171, v171
    v_mfma_f32_32x32x16_bf16 v[186:201], a[12:15], v[22:25], v[186:201]
    ds_read_b128 a[4:7], v2 offset:7168
    v_mul_f32_e64 v212, v172, v172
    v_mul_f32 v213, v173, v173
    s_waitcnt lgkmcnt(2)
    v_mfma_f32_32x32x16_bf16 v[186:201], a[16:19], v[26:29], v[186:201]
    ds_read_b128 a[8:11], v2 offset:8192
    buffer_load_dwordx4 v6, s[12:15], s5 offen offset:2048 sc1 lds
    v_fma_f32 v214, v210, v207, v206
    v_fma_f32 v215, v211, v207, v206
    v_mfma_f32_32x32x16_bf16 v[186:201], a[20:23], v[30:33], v[186:201]
    ds_read_b128 a[12:15], v2 offset:9216
    v_fma_f32 v216, v212, v207, v206
    v_fma_f32 v217, v213, v207, v206
    s_waitcnt lgkmcnt(2)
    v_mfma_f32_32x32x16_bf16 v[186:201], a[0:3], v[34:37], v[186:201]
    ds_read_b128 a[16:19], v2 offset:10240
    buffer_load_dwordx4 v6, s[12:15], s5 offen offset:3072 sc1 lds
    v_mul_f32 v214, v170, v214
    v_mul_f32_e64 v215, v171, v215
    v_mfma_f32_32x32x16_bf16 v[186:201], a[4:7], v[38:41], v[186:201]
    ds_read_b128 a[20:23], v2 offset:11264
    v_mul_f32_e64 v216, v172, v216
    v_mul_f32 v217, v173, v217
    s_waitcnt lgkmcnt(2)
    v_mfma_f32_32x32x16_bf16 v[186:201], a[8:11], v[42:45], v[186:201]
    ds_read_b128 a[0:3], v2 offset:12288
    s_add_u32 m0, m0, 4096
    s_add_u32 s5, s5, 4096
    buffer_load_dwordx4 v6, s[12:15], s5 offen offset:0 sc1 lds
    v_exp_f32 v214, v214
    v_exp_f32 v215, v215
    v_mfma_f32_32x32x16_bf16 v[186:201], a[12:15], v[46:49], v[186:201]
    ds_read_b128 a[4:7], v2 offset:13312
    v_exp_f32_e64 v216, v216
    v_exp_f32 v217, v217
    s_waitcnt lgkmcnt(2)
    v_mfma_f32_32x32x16_bf16 v[186:201], a[16:19], v[50:53], v[186:201]
    ds_read_b128 a[8:11], v2 offset:14336
    buffer_load_dwordx4 v6, s[12:15], s5 offen offset:1024 sc1 lds
    v_mul_f32 v218, v170, v178
    v_mul_f32 v219, v171, v179
    v_mfma_f32_32x32x16_bf16 v[186:201], a[20:23], v[54:57], v[186:201]
    ds_read_b128 a[12:15], v2 offset:15360
    v_mul_f32_e64 v220, v172, v180
    v_mul_f32 v221, v173, v181
    s_waitcnt lgkmcnt(2)
    v_mfma_f32_32x32x16_bf16 v[186:201], a[0:3], v[58:61], v[186:201]
    ds_read_b128 a[16:19], v2 offset:16384
    buffer_load_dwordx4 v6, s[12:15], s5 offen offset:2048 sc1 lds
    v_fma_f32 v214, v214, v208, v208
    v_fma_f32 v215, v215, v208, v208
    v_mfma_f32_32x32x16_bf16 v[186:201], a[4:7], v[62:65], v[186:201]
    ds_read_b128 a[20:23], v2 offset:17408
    v_fma_f32 v216, v216, v208, v208
    v_fma_f32 v217, v217, v208, v208
    s_waitcnt lgkmcnt(2)
    v_mfma_f32_32x32x16_bf16 v[186:201], a[8:11], v[66:69], v[186:201]
    ds_read_b128 a[0:3], v2 offset:18432
    buffer_load_dwordx4 v6, s[12:15], s5 offen offset:3072 sc1 lds
    v_rcp_f32 v214, v214
    v_rcp_f32_e64 v215, v215
    v_mfma_f32_32x32x16_bf16 v[186:201], a[12:15], v[70:73], v[186:201]
    ds_read_b128 a[4:7], v2 offset:19456
    v_rcp_f32_e64 v216, v216
    v_rcp_f32 v217, v217
    s_waitcnt lgkmcnt(2)
    v_mfma_f32_32x32x16_bf16 v[186:201], a[16:19], v[74:77], v[186:201]
    ds_read_b128 a[8:11], v2 offset:20480
    s_add_u32 m0, m0, 4096
    s_add_u32 s5, s5, 4096
    buffer_load_dwordx4 v6, s[12:15], s5 offen offset:0 sc1 lds
    v_mul_f32 v218, v218, v214
    v_mul_f32 v219, v219, v215
    v_mfma_f32_32x32x16_bf16 v[186:201], a[20:23], v[78:81], v[186:201]
    ds_read_b128 a[12:15], v2 offset:21504
    v_mul_f32_e64 v220, v220, v216
    v_mul_f32 v221, v221, v217
    s_waitcnt lgkmcnt(2)
    v_mfma_f32_32x32x16_bf16 v[186:201], a[0:3], v[82:85], v[186:201]
    ds_read_b128 a[16:19], v2 offset:22528
    buffer_load_dwordx4 v6, s[12:15], s5 offen offset:1024 sc1 lds
    v_cvt_pk_bf16_f32 v222, v218, v219
    v_cvt_pk_bf16_f32 v223, v220, v221
    v_mfma_f32_32x32x16_bf16 v[186:201], a[4:7], v[86:89], v[186:201]
    ds_read_b128 a[20:23], v2 offset:23552
    v_mul_f32_e64 v210, v174, v174
    v_mul_f32 v211, v175, v175
    s_waitcnt lgkmcnt(2)
    v_mfma_f32_32x32x16_bf16 v[186:201], a[8:11], v[90:93], v[186:201]
    ds_read_b128 a[0:3], v2 offset:24576
    buffer_load_dwordx4 v6, s[12:15], s5 offen offset:2048 sc1 lds
    v_mul_f32 v212, v176, v176
    v_mul_f32 v213, v177, v177
    v_mfma_f32_32x32x16_bf16 v[186:201], a[12:15], v[94:97], v[186:201]
    ds_read_b128 a[4:7], v2 offset:25600
    v_fma_f32 v214, v210, v207, v206
    v_fma_f32 v215, v211, v207, v206
    s_waitcnt lgkmcnt(2)
    s_nop 0
    v_mfma_f32_32x32x16_bf16 v[186:201], a[16:19], v[98:101], v[186:201]
    ds_read_b128 a[8:11], v2 offset:26624
    s_add_u32 s51, s51, 41984
    v_fma_f32 v216, v212, v207, v206
    v_fma_f32 v217, v213, v207, v206
    v_mfma_f32_32x32x16_bf16 v[186:201], a[20:23], v[102:105], v[186:201]
    ds_read_b128 a[12:15], v2 offset:27648
    s_add_u32 s6, s57, s68
    buffer_load_dwordx4 a[112:115], v6, s[8:11], s6 offen sc1
    v_mul_f32 v214, v174, v214
    v_mul_f32 v215, v175, v215
    s_waitcnt lgkmcnt(2)
    v_mfma_f32_32x32x16_bf16 v[186:201], a[0:3], v[106:109], v[186:201]
    ds_read_b128 a[16:19], v2 offset:28672
    v_mul_f32 v216, v176, v216
    v_mul_f32 v217, v177, v217
    v_mfma_f32_32x32x16_bf16 v[186:201], a[4:7], v[110:113], v[186:201]
    ds_read_b128 a[20:23], v2 offset:29696
    s_add_u32 s6, s58, s68
    buffer_load_dwordx4 a[116:119], v6, s[8:11], s6 offen sc1
    v_exp_f32 v214, v214
    v_exp_f32 v215, v215
    s_waitcnt lgkmcnt(2)
    v_mfma_f32_32x32x16_bf16 v[186:201], a[8:11], v[114:117], v[186:201]
    ds_read_b128 a[0:3], v2 offset:30720
    v_exp_f32 v216, v216
    v_exp_f32 v217, v217
    v_mfma_f32_32x32x16_bf16 v[186:201], a[12:15], v[118:121], v[186:201]
    ds_read_b128 a[4:7], v2 offset:31744
    s_add_u32 s6, s59, s68
    buffer_load_dwordx4 a[120:123], v6, s[8:11], s6 offen sc1
    v_mul_f32 v218, v174, v182
    v_mul_f32 v219, v175, v183
    s_waitcnt lgkmcnt(2)
    v_mfma_f32_32x32x16_bf16 v[186:201], a[16:19], v[122:125], v[186:201]
    ds_read_b128 a[8:11], v2 offset:32768
    v_mul_f32 v220, v176, v184
    v_mul_f32 v221, v177, v185
    v_mfma_f32_32x32x16_bf16 v[186:201], a[20:23], v[126:129], v[186:201]
    ds_read_b128 a[12:15], v2 offset:33792
    s_add_u32 s6, s60, s68
    buffer_load_dwordx4 a[124:127], v6, s[8:11], s6 offen sc1
    v_fma_f32 v214, v214, v208, v208
    v_fma_f32 v215, v215, v208, v208
    s_waitcnt lgkmcnt(2)
    v_mfma_f32_32x32x16_bf16 v[186:201], a[0:3], v[130:133], v[186:201]
    ds_read_b128 a[16:19], v2 offset:34816
    v_fma_f32 v216, v216, v208, v208
    v_fma_f32 v217, v217, v208, v208
    v_mfma_f32_32x32x16_bf16 v[186:201], a[4:7], v[134:137], v[186:201]
    ds_read_b128 a[20:23], v2 offset:35840
    s_add_u32 s6, s61, s68
    buffer_load_dwordx4 a[128:131], v6, s[8:11], s6 offen sc1
    v_rcp_f32 v214, v214
    v_rcp_f32 v215, v215
    s_waitcnt lgkmcnt(2)
    v_mfma_f32_32x32x16_bf16 v[186:201], a[8:11], v[138:141], v[186:201]
    ds_read_b128 a[0:3], v2 offset:36864
    v_rcp_f32 v216, v216
    v_rcp_f32 v217, v217
    v_mfma_f32_32x32x16_bf16 v[186:201], a[12:15], v[142:145], v[186:201]
    ds_read_b128 a[4:7], v2 offset:37888
    s_add_u32 s6, s57, s69
    buffer_load_dwordx4 a[132:135], v6, s[8:11], s6 offen sc1
    v_mul_f32 v218, v218, v214
    v_mul_f32 v219, v219, v215
    s_waitcnt lgkmcnt(2)
    v_mfma_f32_32x32x16_bf16 v[186:201], a[16:19], v[146:149], v[186:201]
    ds_read_b128 a[8:11], v2 offset:38912
    v_mul_f32 v220, v220, v216
    v_mul_f32 v221, v221, v217
    v_mfma_f32_32x32x16_bf16 v[186:201], a[20:23], v[150:153], v[186:201]
    ds_read_b128 a[12:15], v2 offset:39936
    v_cvt_pk_bf16_f32 v224, v218, v219
    v_cvt_pk_bf16_f32 v225, v220, v221
    s_waitcnt lgkmcnt(2)
    s_nop 0
    v_mfma_f32_32x32x16_bf16 v[186:201], a[0:3], v[154:157], v[186:201]
    ds_read_b128 a[16:19], v2 offset:40960
    buffer_store_dwordx4 v[222:225], v5, s[8:11], s52 offen sc1
    s_add_u32 s52, s52, 512
    v_mfma_f32_32x32x16_bf16 v[186:201], a[4:7], v[158:161], v[186:201]
    s_waitcnt vmcnt(25) lgkmcnt(0)
    s_barrier
    ds_read_b128 a[0:3], v3 offset:0
    v_mfma_f32_32x32x16_bf16 v[186:201], a[8:11], v[162:165], v[186:201]
    ds_read_b128 a[4:7], v3 offset:1024
    v_mfma_f32_32x32x16_bf16 v[186:201], a[12:15], v[166:169], v[186:201]
    ds_read_b128 a[8:11], v3 offset:2048
    v_mfma_f32_32x32x16_bf16 v[186:201], a[16:19], v[202:205], v[186:201]
    ds_read_b128 a[12:15], v3 offset:3072
    v_mov_b32_e64 v2, v3
    v_add_u32 v3, 41984, v6
    s_cmp_gt_u32 s47, 6
    s_cselect_b32 s14, 0x2000000, 0
    s_waitcnt lgkmcnt(2)
    v_mfma_f32_32x32x16_bf16 v[170:185], a[0:3], v[10:13], 0
    ds_read_b128 a[16:19], v2 offset:4096
    s_add_u32 m0, s53, 84992
    s_mov_b32 s5, s51
    buffer_load_dwordx4 v6, s[12:15], s5 offen offset:0 sc1 lds
    v_mfma_f32_32x32x16_bf16 v[170:185], a[4:7], v[14:17], v[170:185]
    ds_read_b128 a[20:23], v2 offset:5120
    s_waitcnt lgkmcnt(2)
    v_mfma_f32_32x32x16_bf16 v[170:185], a[8:11], v[18:21], v[170:185]
    ds_read_b128 a[0:3], v2 offset:6144
    buffer_load_dwordx4 v6, s[12:15], s5 offen offset:1024 sc1 lds
    v_mul_f32 v210, v186, v186
    v_mul_f32 v211, v187, v187
    v_mfma_f32_32x32x16_bf16 v[170:185], a[12:15], v[22:25], v[170:185]
    ds_read_b128 a[4:7], v2 offset:7168
    v_mul_f32_e64 v212, v188, v188
    v_mul_f32 v213, v189, v189
    s_waitcnt lgkmcnt(2)
    v_mfma_f32_32x32x16_bf16 v[170:185], a[16:19], v[26:29], v[170:185]
    ds_read_b128 a[8:11], v2 offset:8192
    buffer_load_dwordx4 v6, s[12:15], s5 offen offset:2048 sc1 lds
    v_fma_f32 v214, v210, v207, v206
    v_fma_f32 v215, v211, v207, v206
    v_mfma_f32_32x32x16_bf16 v[170:185], a[20:23], v[30:33], v[170:185]
    ds_read_b128 a[12:15], v2 offset:9216
    v_fma_f32 v216, v212, v207, v206
    v_fma_f32 v217, v213, v207, v206
    s_waitcnt lgkmcnt(2)
    v_mfma_f32_32x32x16_bf16 v[170:185], a[0:3], v[34:37], v[170:185]
    ds_read_b128 a[16:19], v2 offset:10240
    buffer_load_dwordx4 v6, s[12:15], s5 offen offset:3072 sc1 lds
    v_mul_f32 v214, v186, v214
    v_mul_f32_e64 v215, v187, v215
    v_mfma_f32_32x32x16_bf16 v[170:185], a[4:7], v[38:41], v[170:185]
    ds_read_b128 a[20:23], v2 offset:11264
    v_mul_f32_e64 v216, v188, v216
    v_mul_f32 v217, v189, v217
    s_waitcnt lgkmcnt(2)
    v_mfma_f32_32x32x16_bf16 v[170:185], a[8:11], v[42:45], v[170:185]
    ds_read_b128 a[0:3], v2 offset:12288
    s_add_u32 m0, m0, 4096
    s_add_u32 s5, s5, 4096
    buffer_load_dwordx4 v6, s[12:15], s5 offen offset:0 sc1 lds
    v_exp_f32 v214, v214
    v_exp_f32 v215, v215
    v_mfma_f32_32x32x16_bf16 v[170:185], a[12:15], v[46:49], v[170:185]
    ds_read_b128 a[4:7], v2 offset:13312
    v_exp_f32_e64 v216, v216
    v_exp_f32 v217, v217
    s_waitcnt lgkmcnt(2)
    v_mfma_f32_32x32x16_bf16 v[170:185], a[16:19], v[50:53], v[170:185]
    ds_read_b128 a[8:11], v2 offset:14336
    buffer_load_dwordx4 v6, s[12:15], s5 offen offset:1024 sc1 lds
    v_mul_f32 v218, v186, v194
    v_mul_f32 v219, v187, v195
    v_mfma_f32_32x32x16_bf16 v[170:185], a[20:23], v[54:57], v[170:185]
    ds_read_b128 a[12:15], v2 offset:15360
    v_mul_f32_e64 v220, v188, v196
    v_mul_f32 v221, v189, v197
    s_waitcnt lgkmcnt(2)
    v_mfma_f32_32x32x16_bf16 v[170:185], a[0:3], v[58:61], v[170:185]
    ds_read_b128 a[16:19], v2 offset:16384
    buffer_load_dwordx4 v6, s[12:15], s5 offen offset:2048 sc1 lds
    v_fma_f32 v214, v214, v208, v208
    v_fma_f32 v215, v215, v208, v208
    v_mfma_f32_32x32x16_bf16 v[170:185], a[4:7], v[62:65], v[170:185]
    ds_read_b128 a[20:23], v2 offset:17408
    v_fma_f32 v216, v216, v208, v208
    v_fma_f32 v217, v217, v208, v208
    s_waitcnt lgkmcnt(2)
    v_mfma_f32_32x32x16_bf16 v[170:185], a[8:11], v[66:69], v[170:185]
    ds_read_b128 a[0:3], v2 offset:18432
    buffer_load_dwordx4 v6, s[12:15], s5 offen offset:3072 sc1 lds
    v_rcp_f32 v214, v214
    v_rcp_f32_e64 v215, v215
    v_mfma_f32_32x32x16_bf16 v[170:185], a[12:15], v[70:73], v[170:185]
    ds_read_b128 a[4:7], v2 offset:19456
    v_rcp_f32_e64 v216, v216
    v_rcp_f32 v217, v217
    s_waitcnt lgkmcnt(2)
    v_mfma_f32_32x32x16_bf16 v[170:185], a[16:19], v[74:77], v[170:185]
    ds_read_b128 a[8:11], v2 offset:20480
    s_add_u32 m0, m0, 4096
    s_add_u32 s5, s5, 4096
    buffer_load_dwordx4 v6, s[12:15], s5 offen offset:0 sc1 lds
    v_mul_f32 v218, v218, v214
    v_mul_f32 v219, v219, v215
    v_mfma_f32_32x32x16_bf16 v[170:185], a[20:23], v[78:81], v[170:185]
    ds_read_b128 a[12:15], v2 offset:21504
    v_mul_f32_e64 v220, v220, v216
    v_mul_f32 v221, v221, v217
    s_waitcnt lgkmcnt(2)
    v_mfma_f32_32x32x16_bf16 v[170:185], a[0:3], v[82:85], v[170:185]
    ds_read_b128 a[16:19], v2 offset:22528
    buffer_load_dwordx4 v6, s[12:15], s5 offen offset:1024 sc1 lds
    v_cvt_pk_bf16_f32 v222, v218, v219
    v_cvt_pk_bf16_f32 v223, v220, v221
    v_mfma_f32_32x32x16_bf16 v[170:185], a[4:7], v[86:89], v[170:185]
    ds_read_b128 a[20:23], v2 offset:23552
    v_mul_f32_e64 v210, v190, v190
    v_mul_f32 v211, v191, v191
    s_waitcnt lgkmcnt(2)
    v_mfma_f32_32x32x16_bf16 v[170:185], a[8:11], v[90:93], v[170:185]
    ds_read_b128 a[0:3], v2 offset:24576
    buffer_load_dwordx4 v6, s[12:15], s5 offen offset:2048 sc1 lds
    v_mul_f32 v212, v192, v192
    v_mul_f32 v213, v193, v193
    v_mfma_f32_32x32x16_bf16 v[170:185], a[12:15], v[94:97], v[170:185]
    ds_read_b128 a[4:7], v2 offset:25600
    v_fma_f32 v214, v210, v207, v206
    v_fma_f32 v215, v211, v207, v206
    s_waitcnt lgkmcnt(2)
    s_nop 0
    v_mfma_f32_32x32x16_bf16 v[170:185], a[16:19], v[98:101], v[170:185]
    ds_read_b128 a[8:11], v2 offset:26624
    s_add_u32 s51, s51, 41984
    v_fma_f32 v216, v212, v207, v206
    v_fma_f32 v217, v213, v207, v206
    v_mfma_f32_32x32x16_bf16 v[170:185], a[20:23], v[102:105], v[170:185]
    ds_read_b128 a[12:15], v2 offset:27648
    s_add_u32 s6, s58, s69
    buffer_load_dwordx4 a[136:139], v6, s[8:11], s6 offen sc1
    v_mul_f32 v214, v190, v214
    v_mul_f32 v215, v191, v215
    s_waitcnt lgkmcnt(2)
    v_mfma_f32_32x32x16_bf16 v[170:185], a[0:3], v[106:109], v[170:185]
    ds_read_b128 a[16:19], v2 offset:28672
    v_mul_f32 v216, v192, v216
    v_mul_f32 v217, v193, v217
    v_mfma_f32_32x32x16_bf16 v[170:185], a[4:7], v[110:113], v[170:185]
    ds_read_b128 a[20:23], v2 offset:29696
    s_add_u32 s6, s59, s69
    buffer_load_dwordx4 a[140:143], v6, s[8:11], s6 offen sc1
    v_exp_f32 v214, v214
    v_exp_f32 v215, v215
    s_waitcnt lgkmcnt(2)
    v_mfma_f32_32x32x16_bf16 v[170:185], a[8:11], v[114:117], v[170:185]
    ds_read_b128 a[0:3], v2 offset:30720
    v_exp_f32 v216, v216
    v_exp_f32 v217, v217
    v_mfma_f32_32x32x16_bf16 v[170:185], a[12:15], v[118:121], v[170:185]
    ds_read_b128 a[4:7], v2 offset:31744
    s_add_u32 s6, s60, s69
    buffer_load_dwordx4 a[144:147], v6, s[8:11], s6 offen sc1
    v_mul_f32 v218, v190, v198
    v_mul_f32 v219, v191, v199
    s_waitcnt lgkmcnt(2)
    v_mfma_f32_32x32x16_bf16 v[170:185], a[16:19], v[122:125], v[170:185]
    ds_read_b128 a[8:11], v2 offset:32768
    v_mul_f32 v220, v192, v200
    v_mul_f32 v221, v193, v201
    v_mfma_f32_32x32x16_bf16 v[170:185], a[20:23], v[126:129], v[170:185]
    ds_read_b128 a[12:15], v2 offset:33792
    s_add_u32 s6, s61, s69
    buffer_load_dwordx4 a[148:151], v6, s[8:11], s6 offen sc1
    v_fma_f32 v214, v214, v208, v208
    v_fma_f32 v215, v215, v208, v208
    s_waitcnt lgkmcnt(2)
    v_mfma_f32_32x32x16_bf16 v[170:185], a[0:3], v[130:133], v[170:185]
    ds_read_b128 a[16:19], v2 offset:34816
    v_fma_f32 v216, v216, v208, v208
    v_fma_f32 v217, v217, v208, v208
    v_mfma_f32_32x32x16_bf16 v[170:185], a[4:7], v[134:137], v[170:185]
    ds_read_b128 a[20:23], v2 offset:35840
    s_add_u32 s6, s57, s70
    buffer_load_dwordx4 a[152:155], v6, s[8:11], s6 offen sc1
    v_rcp_f32 v214, v214
    v_rcp_f32 v215, v215
    s_waitcnt lgkmcnt(2)
    v_mfma_f32_32x32x16_bf16 v[170:185], a[8:11], v[138:141], v[170:185]
    ds_read_b128 a[0:3], v2 offset:36864
    v_rcp_f32 v216, v216
    v_rcp_f32 v217, v217
    v_mfma_f32_32x32x16_bf16 v[170:185], a[12:15], v[142:145], v[170:185]
    ds_read_b128 a[4:7], v2 offset:37888
    s_add_u32 s6, s58, s70
    buffer_load_dwordx4 a[156:159], v6, s[8:11], s6 offen sc1
    v_mul_f32 v218, v218, v214
    v_mul_f32 v219, v219, v215
    s_waitcnt lgkmcnt(2)
    v_mfma_f32_32x32x16_bf16 v[170:185], a[16:19], v[146:149], v[170:185]
    ds_read_b128 a[8:11], v2 offset:38912
    v_mul_f32 v220, v220, v216
    v_mul_f32 v221, v221, v217
    v_mfma_f32_32x32x16_bf16 v[170:185], a[20:23], v[150:153], v[170:185]
    ds_read_b128 a[12:15], v2 offset:39936
    v_cvt_pk_bf16_f32 v224, v218, v219
    v_cvt_pk_bf16_f32 v225, v220, v221
    s_waitcnt lgkmcnt(2)
    s_nop 0
    v_mfma_f32_32x32x16_bf16 v[170:185], a[0:3], v[154:157], v[170:185]
    ds_read_b128 a[16:19], v2 offset:40960
    buffer_store_dwordx4 v[222:225], v5, s[8:11], s52 offen sc1
    s_add_u32 s52, s52, 512
    v_mfma_f32_32x32x16_bf16 v[170:185], a[4:7], v[158:161], v[170:185]
    s_waitcnt vmcnt(25) lgkmcnt(0)
    s_barrier
    ds_read_b128 a[0:3], v3 offset:0
    v_mfma_f32_32x32x16_bf16 v[170:185], a[8:11], v[162:165], v[170:185]
    ds_read_b128 a[4:7], v3 offset:1024
    v_mfma_f32_32x32x16_bf16 v[170:185], a[12:15], v[166:169], v[170:185]
    ds_read_b128 a[8:11], v3 offset:2048
    v_mfma_f32_32x32x16_bf16 v[170:185], a[16:19], v[202:205], v[170:185]
    ds_read_b128 a[12:15], v3 offset:3072
    v_mov_b32_e64 v2, v3
    v_add_u32 v3, 84992, v6
    s_cmp_gt_u32 s47, 7
    s_cselect_b32 s14, 0x2000000, 0
    s_waitcnt lgkmcnt(2)
    v_mfma_f32_32x32x16_bf16 v[186:201], a[0:3], v[10:13], 0
    ds_read_b128 a[16:19], v2 offset:4096
    v_mfma_f32_32x32x16_bf16 v[186:201], a[4:7], v[14:17], v[186:201]
    ds_read_b128 a[20:23], v2 offset:5120
    s_waitcnt lgkmcnt(2)
    v_mfma_f32_32x32x16_bf16 v[186:201], a[8:11], v[18:21], v[186:201]
    ds_read_b128 a[0:3], v2 offset:6144
    v_mul_f32 v210, v170, v170
    v_mul_f32_e64 v211, v171, v171
    v_mfma_f32_32x32x16_bf16 v[186:201], a[12:15], v[22:25], v[186:201]
    ds_read_b128 a[4:7], v2 offset:7168
    s_add_u32 s6, s59, s70
    buffer_load_dwordx4 a[160:163], v6, s[8:11], s6 offen sc1
    v_mul_f32 v212, v172, v172
    v_mul_f32 v213, v173, v173
    s_waitcnt lgkmcnt(2)
    v_mfma_f32_32x32x16_bf16 v[186:201], a[16:19], v[26:29], v[186:201]
    ds_read_b128 a[8:11], v2 offset:8192
    v_fma_f32 v214, v210, v207, v206
    v_fma_f32 v215, v211, v207, v206
    v_mfma_f32_32x32x16_bf16 v[186:201], a[20:23], v[30:33], v[186:201]
    ds_read_b128 a[12:15], v2 offset:9216
    s_add_u32 s6, s60, s70
    buffer_load_dwordx4 a[164:167], v6, s[8:11], s6 offen sc1
    v_fma_f32 v216, v212, v207, v206
    v_fma_f32 v217, v213, v207, v206
    s_waitcnt lgkmcnt(2)
    v_mfma_f32_32x32x16_bf16 v[186:201], a[0:3], v[34:37], v[186:201]
    ds_read_b128 a[16:19], v2 offset:10240
    v_mul_f32 v214, v170, v214
    v_mul_f32 v215, v171, v215
    v_mfma_f32_32x32x16_bf16 v[186:201], a[4:7], v[38:41], v[186:201]
    ds_read_b128 a[20:23], v2 offset:11264
    s_add_u32 s6, s61, s70
    buffer_load_dwordx4 a[168:171], v6, s[8:11], s6 offen sc1
    v_mul_f32 v216, v172, v216
    v_mul_f32 v217, v173, v217
    s_waitcnt lgkmcnt(2)
    v_mfma_f32_32x32x16_bf16 v[186:201], a[8:11], v[42:45], v[186:201]
    ds_read_b128 a[0:3], v2 offset:12288
    v_exp_f32 v214, v214
    v_exp_f32 v215, v215
    v_mfma_f32_32x32x16_bf16 v[186:201], a[12:15], v[46:49], v[186:201]
    ds_read_b128 a[4:7], v2 offset:13312
    s_add_u32 s6, s57, s71
    buffer_load_dwordx4 a[172:175], v6, s[8:11], s6 offen sc1
    v_exp_f32 v216, v216
    v_exp_f32 v217, v217
    s_waitcnt lgkmcnt(2)
    v_mfma_f32_32x32x16_bf16 v[186:201], a[16:19], v[50:53], v[186:201]
    ds_read_b128 a[8:11], v2 offset:14336
    v_mul_f32 v218, v170, v178
    v_mul_f32 v219, v171, v179
    v_mfma_f32_32x32x16_bf16 v[186:201], a[20:23], v[54:57], v[186:201]
    ds_read_b128 a[12:15], v2 offset:15360
    s_add_u32 s6, s58, s71
    buffer_load_dwordx4 a[176:179], v6, s[8:11], s6 offen sc1
    v_mul_f32 v220, v172, v180
    v_mul_f32 v221, v173, v181
    s_waitcnt lgkmcnt(2)
    v_mfma_f32_32x32x16_bf16 v[186:201], a[0:3], v[58:61], v[186:201]
    ds_read_b128 a[16:19], v2 offset:16384
    v_fma_f32 v214, v214, v208, v208
    v_fma_f32 v215, v215, v208, v208
    v_mfma_f32_32x32x16_bf16 v[186:201], a[4:7], v[62:65], v[186:201]
    ds_read_b128 a[20:23], v2 offset:17408
    s_add_u32 s6, s59, s71
    buffer_load_dwordx4 a[180:183], v6, s[8:11], s6 offen sc1
    v_fma_f32 v216, v216, v208, v208
    v_fma_f32 v217, v217, v208, v208
    s_waitcnt lgkmcnt(2)
    v_mfma_f32_32x32x16_bf16 v[186:201], a[8:11], v[66:69], v[186:201]
    ds_read_b128 a[0:3], v2 offset:18432
    v_rcp_f32 v214, v214
    v_rcp_f32 v215, v215
    v_mfma_f32_32x32x16_bf16 v[186:201], a[12:15], v[70:73], v[186:201]
    ds_read_b128 a[4:7], v2 offset:19456
    s_add_u32 s6, s60, s71
    buffer_load_dwordx4 a[184:187], v6, s[8:11], s6 offen sc1
    v_rcp_f32 v216, v216
    v_rcp_f32 v217, v217
    s_waitcnt lgkmcnt(2)
    v_mfma_f32_32x32x16_bf16 v[186:201], a[16:19], v[74:77], v[186:201]
    ds_read_b128 a[8:11], v2 offset:20480
    v_mul_f32 v218, v218, v214
    v_mul_f32 v219, v219, v215
    v_mfma_f32_32x32x16_bf16 v[186:201], a[20:23], v[78:81], v[186:201]
    ds_read_b128 a[12:15], v2 offset:21504
    s_add_u32 s6, s61, s71
    buffer_load_dwordx4 a[188:191], v6, s[8:11], s6 offen sc1
    v_mul_f32 v220, v220, v216
    v_mul_f32 v221, v221, v217
    s_waitcnt lgkmcnt(2)
    v_mfma_f32_32x32x16_bf16 v[186:201], a[0:3], v[82:85], v[186:201]
    ds_read_b128 a[16:19], v2 offset:22528
    v_cvt_pk_bf16_f32 v222, v218, v219
    v_cvt_pk_bf16_f32 v223, v220, v221
    v_mfma_f32_32x32x16_bf16 v[186:201], a[4:7], v[86:89], v[186:201]
    ds_read_b128 a[20:23], v2 offset:23552
    s_add_u32 s6, s57, s72
    buffer_load_dwordx4 a[192:195], v6, s[8:11], s6 offen sc1
    v_mul_f32 v210, v174, v174
    v_mul_f32 v211, v175, v175
    s_waitcnt lgkmcnt(2)
    v_mfma_f32_32x32x16_bf16 v[186:201], a[8:11], v[90:93], v[186:201]
    ds_read_b128 a[0:3], v2 offset:24576
    v_mul_f32 v212, v176, v176
    v_mul_f32 v213, v177, v177
    v_mfma_f32_32x32x16_bf16 v[186:201], a[12:15], v[94:97], v[186:201]
    ds_read_b128 a[4:7], v2 offset:25600
    s_add_u32 s6, s58, s72
    buffer_load_dwordx4 a[196:199], v6, s[8:11], s6 offen sc1
    v_fma_f32 v214, v210, v207, v206
    v_fma_f32 v215, v211, v207, v206
    s_waitcnt lgkmcnt(2)
    v_mfma_f32_32x32x16_bf16 v[186:201], a[16:19], v[98:101], v[186:201]
    ds_read_b128 a[8:11], v2 offset:26624
    v_fma_f32 v216, v212, v207, v206
    v_fma_f32 v217, v213, v207, v206
    v_mfma_f32_32x32x16_bf16 v[186:201], a[20:23], v[102:105], v[186:201]
    ds_read_b128 a[12:15], v2 offset:27648
    s_add_u32 s6, s59, s72
    buffer_load_dwordx4 a[200:203], v6, s[8:11], s6 offen sc1
    v_mul_f32 v214, v174, v214
    v_mul_f32 v215, v175, v215
    s_waitcnt lgkmcnt(2)
    v_mfma_f32_32x32x16_bf16 v[186:201], a[0:3], v[106:109], v[186:201]
    ds_read_b128 a[16:19], v2 offset:28672
    v_mul_f32 v216, v176, v216
    v_mul_f32 v217, v177, v217
    v_mfma_f32_32x32x16_bf16 v[186:201], a[4:7], v[110:113], v[186:201]
    ds_read_b128 a[20:23], v2 offset:29696
    s_add_u32 s6, s60, s72
    buffer_load_dwordx4 a[204:207], v6, s[8:11], s6 offen sc1
    v_exp_f32 v214, v214
    v_exp_f32 v215, v215
    s_waitcnt lgkmcnt(2)
    v_mfma_f32_32x32x16_bf16 v[186:201], a[8:11], v[114:117], v[186:201]
    ds_read_b128 a[0:3], v2 offset:30720
    v_exp_f32 v216, v216
    v_exp_f32 v217, v217
    v_mfma_f32_32x32x16_bf16 v[186:201], a[12:15], v[118:121], v[186:201]
    ds_read_b128 a[4:7], v2 offset:31744
    v_mul_f32_e64 v218, v174, v182
    v_mul_f32 v219, v175, v183
    s_waitcnt lgkmcnt(2)
    v_mfma_f32_32x32x16_bf16 v[186:201], a[16:19], v[122:125], v[186:201]
    ds_read_b128 a[8:11], v2 offset:32768
    v_mul_f32 v220, v176, v184
    v_mul_f32 v221, v177, v185
    v_mfma_f32_32x32x16_bf16 v[186:201], a[20:23], v[126:129], v[186:201]
    ds_read_b128 a[12:15], v2 offset:33792
    v_fma_f32 v214, v214, v208, v208
    v_fma_f32 v215, v215, v208, v208
    s_waitcnt lgkmcnt(2)
    s_nop 0
    v_mfma_f32_32x32x16_bf16 v[186:201], a[0:3], v[130:133], v[186:201]
    ds_read_b128 a[16:19], v2 offset:34816
    v_fma_f32 v216, v216, v208, v208
    v_fma_f32 v217, v217, v208, v208
    v_mfma_f32_32x32x16_bf16 v[186:201], a[4:7], v[134:137], v[186:201]
    ds_read_b128 a[20:23], v2 offset:35840
    v_rcp_f32_e64 v214, v214
    v_rcp_f32 v215, v215
    s_waitcnt lgkmcnt(2)
    v_mfma_f32_32x32x16_bf16 v[186:201], a[8:11], v[138:141], v[186:201]
    ds_read_b128 a[0:3], v2 offset:36864
    v_rcp_f32 v216, v216
    v_rcp_f32 v217, v217
    v_mfma_f32_32x32x16_bf16 v[186:201], a[12:15], v[142:145], v[186:201]
    ds_read_b128 a[4:7], v2 offset:37888
    v_mul_f32_e64 v218, v218, v214
    v_mul_f32 v219, v219, v215
    s_waitcnt lgkmcnt(2)
    v_mfma_f32_32x32x16_bf16 v[186:201], a[16:19], v[146:149], v[186:201]
    ds_read_b128 a[8:11], v2 offset:38912
    v_mul_f32 v220, v220, v216
    v_mul_f32 v221, v221, v217
    v_mfma_f32_32x32x16_bf16 v[186:201], a[20:23], v[150:153], v[186:201]
    ds_read_b128 a[12:15], v2 offset:39936
    v_cvt_pk_bf16_f32 v224, v218, v219
    v_cvt_pk_bf16_f32 v225, v220, v221
    s_waitcnt lgkmcnt(2)
    s_nop 0
    v_mfma_f32_32x32x16_bf16 v[186:201], a[0:3], v[154:157], v[186:201]
    ds_read_b128 a[16:19], v2 offset:40960
    buffer_store_dwordx4 v[222:225], v5, s[8:11], s52 offen sc1
    s_add_u32 s52, s52, 512
    v_mfma_f32_32x32x16_bf16 v[186:201], a[4:7], v[158:161], v[186:201]
    s_waitcnt vmcnt(13) lgkmcnt(0)
    s_barrier
    s_add_u32 s56, s44, 64
    s_cmp_eq_u32 s4, 0
    s_cbranch_scc0 L_w0_69
    s_lshl_b32 s96, s56, 7
    s_add_u32 s96, s96, 5373952
    v_mov_b32_e64 v7, 1
    v_mov_b32 v8, 0
    s_mov_b64 s[36:37], exec
    s_mov_b64 exec, 1
    buffer_atomic_add v7, v8, s[8:11], s96 offen sc1
    s_mov_b64 exec, s[36:37]
L_w0_69:
    ds_read_b128 a[0:3], v3 offset:0
    v_mfma_f32_32x32x16_bf16 v[186:201], a[8:11], v[162:165], v[186:201]
    ds_read_b128 a[4:7], v3 offset:1024
    v_mfma_f32_32x32x16_bf16 v[186:201], a[12:15], v[166:169], v[186:201]
    ds_read_b128 a[8:11], v3 offset:2048
    v_mfma_f32_32x32x16_bf16 v[186:201], a[16:19], v[202:205], v[186:201]
    ds_read_b128 a[12:15], v3 offset:3072
    v_mov_b32 v2, v3
    v_add_u32 v3, 0, v6
    s_cmp_eq_u32 s47, 6
    s_cbranch_scc1 L_g1fin1_67
    s_cmp_gt_u32 s47, 8
    s_cselect_b32 s14, 0x2000000, 0
    s_waitcnt lgkmcnt(2)
    v_mfma_f32_32x32x16_bf16 v[170:185], a[0:3], v[10:13], 0
    ds_read_b128 a[16:19], v2 offset:4096
    v_mfma_f32_32x32x16_bf16 v[170:185], a[4:7], v[14:17], v[170:185]
    ds_read_b128 a[20:23], v2 offset:5120
    s_waitcnt lgkmcnt(2)
    v_mfma_f32_32x32x16_bf16 v[170:185], a[8:11], v[18:21], v[170:185]
    ds_read_b128 a[0:3], v2 offset:6144
    v_mul_f32 v210, v186, v186
    v_mul_f32_e64 v211, v187, v187
    v_mfma_f32_32x32x16_bf16 v[170:185], a[12:15], v[22:25], v[170:185]
    ds_read_b128 a[4:7], v2 offset:7168
    s_add_u32 s6, s61, s72
    buffer_load_dwordx4 a[208:211], v6, s[8:11], s6 offen sc1
    v_mul_f32 v212, v188, v188
    v_mul_f32 v213, v189, v189
    s_waitcnt lgkmcnt(2)
    v_mfma_f32_32x32x16_bf16 v[170:185], a[16:19], v[26:29], v[170:185]
    ds_read_b128 a[8:11], v2 offset:8192
    v_fma_f32 v214, v210, v207, v206
    v_fma_f32 v215, v211, v207, v206
    v_mfma_f32_32x32x16_bf16 v[170:185], a[20:23], v[30:33], v[170:185]
    ds_read_b128 a[12:15], v2 offset:9216
    s_add_u32 s6, s57, s73
    buffer_load_dwordx4 a[212:215], v6, s[8:11], s6 offen sc1
    v_fma_f32 v216, v212, v207, v206
    v_fma_f32 v217, v213, v207, v206
    s_waitcnt lgkmcnt(2)
    v_mfma_f32_32x32x16_bf16 v[170:185], a[0:3], v[34:37], v[170:185]
    ds_read_b128 a[16:19], v2 offset:10240
    v_mul_f32 v214, v186, v214
    v_mul_f32 v215, v187, v215
    v_mfma_f32_32x32x16_bf16 v[170:185], a[4:7], v[38:41], v[170:185]
    ds_read_b128 a[20:23], v2 offset:11264
    s_add_u32 s6, s58, s73
    buffer_load_dwordx4 a[216:219], v6, s[8:11], s6 offen sc1
    v_mul_f32 v216, v188, v216
    v_mul_f32 v217, v189, v217
    s_waitcnt lgkmcnt(2)
    v_mfma_f32_32x32x16_bf16 v[170:185], a[8:11], v[42:45], v[170:185]
    ds_read_b128 a[0:3], v2 offset:12288
    v_exp_f32 v214, v214
    v_exp_f32 v215, v215
    v_mfma_f32_32x32x16_bf16 v[170:185], a[12:15], v[46:49], v[170:185]
    ds_read_b128 a[4:7], v2 offset:13312
    s_add_u32 s6, s59, s73
    buffer_load_dwordx4 a[220:223], v6, s[8:11], s6 offen sc1
    v_exp_f32 v216, v216
    v_exp_f32 v217, v217
    s_waitcnt lgkmcnt(2)
    v_mfma_f32_32x32x16_bf16 v[170:185], a[16:19], v[50:53], v[170:185]
    ds_read_b128 a[8:11], v2 offset:14336
    v_mul_f32 v218, v186, v194
    v_mul_f32 v219, v187, v195
    v_mfma_f32_32x32x16_bf16 v[170:185], a[20:23], v[54:57], v[170:185]
    ds_read_b128 a[12:15], v2 offset:15360
    s_add_u32 s6, s60, s73
    buffer_load_dwordx4 a[224:227], v6, s[8:11], s6 offen sc1
    v_mul_f32 v220, v188, v196
    v_mul_f32 v221, v189, v197
    s_waitcnt lgkmcnt(2)
    v_mfma_f32_32x32x16_bf16 v[170:185], a[0:3], v[58:61], v[170:185]
    ds_read_b128 a[16:19], v2 offset:16384
    v_fma_f32 v214, v214, v208, v208
    v_fma_f32 v215, v215, v208, v208
    v_mfma_f32_32x32x16_bf16 v[170:185], a[4:7], v[62:65], v[170:185]
    ds_read_b128 a[20:23], v2 offset:17408
    s_add_u32 s6, s61, s73
    buffer_load_dwordx4 a[228:231], v6, s[8:11], s6 offen sc1
    v_fma_f32 v216, v216, v208, v208
    v_fma_f32 v217, v217, v208, v208
    s_waitcnt lgkmcnt(2)
    v_mfma_f32_32x32x16_bf16 v[170:185], a[8:11], v[66:69], v[170:185]
    ds_read_b128 a[0:3], v2 offset:18432
    v_rcp_f32 v214, v214
    v_rcp_f32 v215, v215
    v_mfma_f32_32x32x16_bf16 v[170:185], a[12:15], v[70:73], v[170:185]
    ds_read_b128 a[4:7], v2 offset:19456
    s_add_u32 s6, s57, s74
    buffer_load_dwordx4 a[232:235], v6, s[8:11], s6 offen sc1
    v_rcp_f32 v216, v216
    v_rcp_f32 v217, v217
    s_waitcnt lgkmcnt(2)
    v_mfma_f32_32x32x16_bf16 v[170:185], a[16:19], v[74:77], v[170:185]
    ds_read_b128 a[8:11], v2 offset:20480
    v_mul_f32 v218, v218, v214
    v_mul_f32 v219, v219, v215
    v_mfma_f32_32x32x16_bf16 v[170:185], a[20:23], v[78:81], v[170:185]
    ds_read_b128 a[12:15], v2 offset:21504
    s_add_u32 s6, s58, s74
    buffer_load_dwordx4 a[236:239], v6, s[8:11], s6 offen sc1
    v_mul_f32 v220, v220, v216
    v_mul_f32 v221, v221, v217
    s_waitcnt lgkmcnt(2)
    v_mfma_f32_32x32x16_bf16 v[170:185], a[0:3], v[82:85], v[170:185]
    ds_read_b128 a[16:19], v2 offset:22528
    v_cvt_pk_bf16_f32 v222, v218, v219
    v_cvt_pk_bf16_f32 v223, v220, v221
    v_mfma_f32_32x32x16_bf16 v[170:185], a[4:7], v[86:89], v[170:185]
    ds_read_b128 a[20:23], v2 offset:23552
    s_add_u32 s6, s59, s74
    buffer_load_dwordx4 a[240:243], v6, s[8:11], s6 offen sc1
    v_mul_f32 v210, v190, v190
    v_mul_f32 v211, v191, v191
    s_waitcnt lgkmcnt(2)
    v_mfma_f32_32x32x16_bf16 v[170:185], a[8:11], v[90:93], v[170:185]
    ds_read_b128 a[0:3], v2 offset:24576
    v_mul_f32 v212, v192, v192
    v_mul_f32 v213, v193, v193
    v_mfma_f32_32x32x16_bf16 v[170:185], a[12:15], v[94:97], v[170:185]
    ds_read_b128 a[4:7], v2 offset:25600
    s_add_u32 s6, s60, s74
    buffer_load_dwordx4 a[244:247], v6, s[8:11], s6 offen sc1
    v_fma_f32 v214, v210, v207, v206
    v_fma_f32 v215, v211, v207, v206
    s_waitcnt lgkmcnt(2)
    v_mfma_f32_32x32x16_bf16 v[170:185], a[16:19], v[98:101], v[170:185]
    ds_read_b128 a[8:11], v2 offset:26624
    v_fma_f32 v216, v212, v207, v206
    v_fma_f32 v217, v213, v207, v206
    v_mfma_f32_32x32x16_bf16 v[170:185], a[20:23], v[102:105], v[170:185]
    ds_read_b128 a[12:15], v2 offset:27648
    s_add_u32 s6, s61, s74
    buffer_load_dwordx4 a[248:251], v6, s[8:11], s6 offen sc1
    v_mul_f32 v214, v190, v214
    v_mul_f32 v215, v191, v215
    s_waitcnt lgkmcnt(2)
    v_mfma_f32_32x32x16_bf16 v[170:185], a[0:3], v[106:109], v[170:185]
    ds_read_b128 a[16:19], v2 offset:28672
    v_mul_f32 v216, v192, v216
    v_mul_f32 v217, v193, v217
    v_mfma_f32_32x32x16_bf16 v[170:185], a[4:7], v[110:113], v[170:185]
    ds_read_b128 a[20:23], v2 offset:29696
    s_add_u32 s6, s57, s75
    buffer_load_dwordx4 a[252:255], v6, s[8:11], s6 offen sc1
    v_exp_f32 v214, v214
    v_exp_f32 v215, v215
    s_waitcnt lgkmcnt(2)
    v_mfma_f32_32x32x16_bf16 v[170:185], a[8:11], v[114:117], v[170:185]
    ds_read_b128 a[0:3], v2 offset:30720
    v_exp_f32 v216, v216
    v_exp_f32 v217, v217
    v_mfma_f32_32x32x16_bf16 v[170:185], a[12:15], v[118:121], v[170:185]
    ds_read_b128 a[4:7], v2 offset:31744
    v_mul_f32_e64 v218, v190, v198
    v_mul_f32 v219, v191, v199
    s_waitcnt lgkmcnt(2)
    v_mfma_f32_32x32x16_bf16 v[170:185], a[16:19], v[122:125], v[170:185]
    ds_read_b128 a[8:11], v2 offset:32768
    v_mul_f32 v220, v192, v200
    v_mul_f32 v221, v193, v201
    v_mfma_f32_32x32x16_bf16 v[170:185], a[20:23], v[126:129], v[170:185]
    ds_read_b128 a[12:15], v2 offset:33792
    v_fma_f32 v214, v214, v208, v208
    v_fma_f32 v215, v215, v208, v208
    s_waitcnt lgkmcnt(2)
    v_mfma_f32_32x32x16_bf16 v[170:185], a[0:3], v[130:133], v[170:185]
    ds_read_b128 a[16:19], v2 offset:34816
    v_fma_f32 v216, v216, v208, v208
    v_fma_f32 v217, v217, v208, v208
    s_lshr_b32 s56, s54, 1
    s_add_u32 s56, s56, 64
    s_lshl_b32 s96, s56, 7
    s_add_u32 s96, s96, 5373952
    v_mov_b32_e64 v230, s96
    buffer_load_dword v231, v230, s[8:11], 0 offen sc1
    v_mfma_f32_32x32x16_bf16 v[170:185], a[4:7], v[134:137], v[170:185]
    ds_read_b128 a[20:23], v2 offset:35840
    v_rcp_f32_e64 v214, v214
    v_rcp_f32 v215, v215
    s_waitcnt lgkmcnt(2)
    v_mfma_f32_32x32x16_bf16 v[170:185], a[8:11], v[138:141], v[170:185]
    ds_read_b128 a[0:3], v2 offset:36864
    v_rcp_f32 v216, v216
    v_rcp_f32 v217, v217
    v_mfma_f32_32x32x16_bf16 v[170:185], a[12:15], v[142:145], v[170:185]
    ds_read_b128 a[4:7], v2 offset:37888
    v_mul_f32_e64 v218, v218, v214
    v_mul_f32 v219, v219, v215
    s_waitcnt lgkmcnt(2)
    v_mfma_f32_32x32x16_bf16 v[170:185], a[16:19], v[146:149], v[170:185]
    ds_read_b128 a[8:11], v2 offset:38912
    v_mul_f32 v220, v220, v216
    v_mul_f32 v221, v221, v217
    v_mfma_f32_32x32x16_bf16 v[170:185], a[20:23], v[150:153], v[170:185]
    ds_read_b128 a[12:15], v2 offset:39936
    v_cvt_pk_bf16_f32 v224, v218, v219
    v_cvt_pk_bf16_f32 v225, v220, v221
    s_waitcnt lgkmcnt(2)
    s_nop 0
    v_mfma_f32_32x32x16_bf16 v[170:185], a[0:3], v[154:157], v[170:185]
    ds_read_b128 a[16:19], v2 offset:40960
    buffer_store_dwordx4 v[222:225], v5, s[8:11], s52 offen sc1
    s_add_u32 s52, s52, 512
    v_mfma_f32_32x32x16_bf16 v[170:185], a[4:7], v[158:161], v[170:185]
    s_waitcnt lgkmcnt(0)
    s_barrier
    ds_read_b128 a[0:3], v3 offset:0
    v_mfma_f32_32x32x16_bf16 v[170:185], a[8:11], v[162:165], v[170:185]
    ds_read_b128 a[4:7], v3 offset:1024
    v_mfma_f32_32x32x16_bf16 v[170:185], a[12:15], v[166:169], v[170:185]
    ds_read_b128 a[8:11], v3 offset:2048
    v_mfma_f32_32x32x16_bf16 v[170:185], a[16:19], v[202:205], v[170:185]
    ds_read_b128 a[12:15], v3 offset:3072
    v_mov_b32_e64 v2, v3
    v_add_u32 v3, 41984, v6
    s_branch L_g1fin_68
L_g1fin1_67:
L_g1fin1x:
    s_lshr_b32 s56, s54, 1
    s_add_u32 s56, s56, 64
    s_add_u32 s6, s61, s72
    buffer_load_dwordx4 a[208:211], v6, s[8:11], s6 offen sc1
    s_add_u32 s6, s57, s73
    buffer_load_dwordx4 a[212:215], v6, s[8:11], s6 offen sc1
    s_add_u32 s6, s58, s73
    buffer_load_dwordx4 a[216:219], v6, s[8:11], s6 offen sc1
    s_add_u32 s6, s59, s73
    buffer_load_dwordx4 a[220:223], v6, s[8:11], s6 offen sc1
    s_add_u32 s6, s60, s73
    buffer_load_dwordx4 a[224:227], v6, s[8:11], s6 offen sc1
    s_add_u32 s6, s61, s73
    buffer_load_dwordx4 a[228:231], v6, s[8:11], s6 offen sc1
    s_add_u32 s6, s57, s74
    buffer_load_dwordx4 a[232:235], v6, s[8:11], s6 offen sc1
    s_add_u32 s6, s58, s74
    buffer_load_dwordx4 a[236:239], v6, s[8:11], s6 offen sc1
    s_add_u32 s6, s59, s74
    buffer_load_dwordx4 a[240:243], v6, s[8:11], s6 offen sc1
    s_add_u32 s6, s60, s74
    buffer_load_dwordx4 a[244:247], v6, s[8:11], s6 offen sc1
    s_add_u32 s6, s61, s74
    buffer_load_dwordx4 a[248:251], v6, s[8:11], s6 offen sc1
    s_add_u32 s6, s57, s75
    buffer_load_dwordx4 a[252:255], v6, s[8:11], s6 offen sc1
    s_lshl_b32 s96, s56, 7
    s_add_u32 s96, s96, 5373952
    v_mov_b32_e64 v230, s96
    buffer_load_dword v231, v230, s[8:11], 0 offen sc1
    s_nop 7
    v_mov_b32 v170, v186
    v_mov_b32 v171, v187
    v_mov_b32 v172, v188
    v_mov_b32 v173, v189
    v_mov_b32 v174, v190
    v_mov_b32 v175, v191
    v_mov_b32 v176, v192
    v_mov_b32 v177, v193
    v_mov_b32 v178, v194
    v_mov_b32 v179, v195
    v_mov_b32 v180, v196
    v_mov_b32 v181, v197
    v_mov_b32 v182, v198
    v_mov_b32 v183, v199
    v_mov_b32 v184, v200
    v_mov_b32 v185, v201
L_g1fin_68:
    s_nop 11
    v_mul_f32 v210, v170, v170
    v_mul_f32 v211, v171, v171
    v_mul_f32 v212, v172, v172
    v_mul_f32 v213, v173, v173
    v_fma_f32 v214, v210, v207, v206
    v_fma_f32 v215, v211, v207, v206
    v_fma_f32 v216, v212, v207, v206
    v_fma_f32 v217, v213, v207, v206
    v_mul_f32 v214, v170, v214
    v_mul_f32 v215, v171, v215
    v_mul_f32 v216, v172, v216
    v_mul_f32 v217, v173, v217
    v_exp_f32 v214, v214
    v_exp_f32 v215, v215
    v_exp_f32 v216, v216
    v_exp_f32 v217, v217
    v_mul_f32 v218, v170, v178
    v_mul_f32 v219, v171, v179
    v_mul_f32 v220, v172, v180
    v_mul_f32 v221, v173, v181
    v_fma_f32 v214, v214, v208, v208
    v_fma_f32 v215, v215, v208, v208
    v_fma_f32 v216, v216, v208, v208
    v_fma_f32 v217, v217, v208, v208
    v_rcp_f32 v214, v214
    v_rcp_f32 v215, v215
    v_rcp_f32 v216, v216
    v_rcp_f32 v217, v217
    v_mul_f32 v218, v218, v214
    v_mul_f32 v219, v219, v215
    v_mul_f32 v220, v220, v216
    v_mul_f32 v221, v221, v217
    v_cvt_pk_bf16_f32 v222, v218, v219
    v_cvt_pk_bf16_f32 v223, v220, v221
    v_mul_f32 v210, v174, v174
    v_mul_f32 v211, v175, v175
    v_mul_f32 v212, v176, v176
    v_mul_f32 v213, v177, v177
    v_fma_f32 v214, v210, v207, v206
    v_fma_f32 v215, v211, v207, v206
    v_fma_f32 v216, v212, v207, v206
    v_fma_f32 v217, v213, v207, v206
    v_mul_f32 v214, v174, v214
    v_mul_f32 v215, v175, v215
    v_mul_f32 v216, v176, v216
    v_mul_f32 v217, v177, v217
    v_exp_f32 v214, v214
    v_exp_f32 v215, v215
    v_exp_f32 v216, v216
    v_exp_f32 v217, v217
    v_mul_f32 v218, v174, v182
    v_mul_f32 v219, v175, v183
    v_mul_f32 v220, v176, v184
    v_mul_f32 v221, v177, v185
    v_fma_f32 v214, v214, v208, v208
    v_fma_f32 v215, v215, v208, v208
    v_fma_f32 v216, v216, v208, v208
    v_fma_f32 v217, v217, v208, v208
    v_rcp_f32 v214, v214
    v_rcp_f32 v215, v215
    v_rcp_f32 v216, v216
    v_rcp_f32 v217, v217
    v_mul_f32 v218, v218, v214
    v_mul_f32 v219, v219, v215
    v_mul_f32 v220, v220, v216
    v_mul_f32 v221, v221, v217
    v_cvt_pk_bf16_f32 v224, v218, v219
    v_cvt_pk_bf16_f32 v225, v220, v221
    buffer_store_dwordx4 v[222:225], v5, s[8:11], s52 offen sc1
    s_add_u32 s52, s52, 512
    s_add_u32 s48, s44, 48
    s_add_u32 s49, s44, 80
    s_mov_b32 s50, s47
    s_add_u32 s5, s4, 0
    s_and_b32 s5, s5, 3
    s_lshl_b32 s6, s54, 2
    s_add_u32 s5, s5, s6
    s_mul_i32 s5, s5, 55296
    s_add_u32 s44, s5, 13107200
    s_add_u32 s5, s4, 1
    s_and_b32 s5, s5, 3
    s_lshl_b32 s6, s54, 2
    s_add_u32 s5, s5, s6
    s_mul_i32 s5, s5, 55296
    s_add_u32 s45, s5, 13107200
    s_add_u32 s5, s4, 2
    s_and_b32 s5, s5, 3
    s_lshl_b32 s6, s54, 2
    s_add_u32 s5, s5, s6
    s_mul_i32 s5, s5, 55296
    s_add_u32 s46, s5, 13107200
    s_add_u32 s5, s4, 3
    s_and_b32 s5, s5, 3
    s_lshl_b32 s6, s54, 2
    s_add_u32 s5, s5, s6
    s_mul_i32 s5, s5, 55296
    s_add_u32 s47, s5, 13107200
    s_mov_b32 s16, s90
    s_mov_b32 s17, s91
    s_mov_b32 s18, 0x280000
    s_mov_b32 s19, 0x00020000
    s_waitcnt vmcnt(1)
    v_cmp_gt_u32 vcc, 16, v231
    s_nop 0
    s_cbranch_vccz L_lpok_70
    s_mov_b64 s[36:37], exec
    s_mov_b64 exec, 0x1
    s_mov_b32 s97, 0
L_poll_71:
    buffer_load_dword v231, v230, s[8:11], 0 offen sc1
    s_waitcnt vmcnt(0)
    v_cmp_gt_u32 vcc, 16, v231
    s_nop 0
    s_cbranch_vccz L_polld_72
    s_add_u32 s97, s97, 1
    s_cmp_lt_u32 s97, 262144
    s_cbranch_scc1 L_poll_71
L_polld_72:
    s_mov_b64 exec, s[36:37]
L_lpok_70:
    s_add_u32 s5, s44, s64
    buffer_load_dwordx4 v[146:149], v6, s[8:11], s5 offen sc1
    s_add_u32 s5, s45, s64
    buffer_load_dwordx4 v[150:153], v6, s[8:11], s5 offen sc1
    s_add_u32 s5, s46, s64
    buffer_load_dwordx4 v[154:157], v6, s[8:11], s5 offen sc1
    s_add_u32 s5, s47, s64
    buffer_load_dwordx4 v[158:161], v6, s[8:11], s5 offen sc1
    s_add_u32 s5, s44, s65
    buffer_load_dwordx4 v[162:165], v6, s[8:11], s5 offen sc1
    s_add_u32 s5, s45, s65
    buffer_load_dwordx4 v[166:169], v6, s[8:11], s5 offen sc1
    s_add_u32 s5, s46, s65
    buffer_load_dwordx4 v[170:173], v6, s[8:11], s5 offen sc1
    s_add_u32 s5, s47, s65
    buffer_load_dwordx4 v[174:177], v6, s[8:11], s5 offen sc1
    s_waitcnt vmcnt(8)
    s_barrier
    s_cmp_eq_u32 s4, 0
    s_cbranch_scc0 L_w0_73
    s_lshl_b32 s96, s48, 7
    s_add_u32 s96, s96, 5373952
    v_mov_b32 v2, 1
    v_mov_b32 v3, 0
    s_mov_b64 s[36:37], exec
    s_mov_b64 exec, 1
    buffer_atomic_add v2, v3, s[8:11], s96 offen sc1
    s_mov_b64 exec, s[36:37]
L_w0_73:
    s_add_u32 s5, s44, s66
    buffer_load_dwordx4 v[178:181], v6, s[8:11], s5 offen sc1
    s_add_u32 s5, s45, s66
    buffer_load_dwordx4 v[182:185], v6, s[8:11], s5 offen sc1
    s_add_u32 s5, s46, s66
    buffer_load_dwordx4 v[186:189], v6, s[8:11], s5 offen sc1
    s_add_u32 s5, s47, s66
    buffer_load_dwordx4 v[190:193], v6, s[8:11], s5 offen sc1
    s_add_u32 s5, s44, s67
    buffer_load_dwordx4 v[194:197], v6, s[8:11], s5 offen sc1
    s_add_u32 s5, s45, s67
    buffer_load_dwordx4 v[198:201], v6, s[8:11], s5 offen sc1
    s_add_u32 s5, s46, s67
    buffer_load_dwordx4 v[202:205], v6, s[8:11], s5 offen sc1
    s_add_u32 s5, s47, s67
    buffer_load_dwordx4 v[206:209], v6, s[8:11], s5 offen sc1
    s_lshr_b32 s56, s54, 1
    s_add_u32 s56, s56, 48
    s_lshr_b32 s51, s54, 1
    s_add_u32 s51, s51, 80
    s_waitcnt vmcnt(12)
    v_mfma_f32_16x16x32_bf16 v[10:13], a[32:35], v[146:149], 0
    v_mfma_f32_16x16x32_bf16 v[14:17], a[32:35], v[150:153], 0
    v_mfma_f32_16x16x32_bf16 v[18:21], a[32:35], v[154:157], 0
    v_mfma_f32_16x16x32_bf16 v[22:25], a[32:35], v[158:161], 0
    s_add_u32 s6, s58, s75
    buffer_load_dwordx4 v[90:93], v6, s[8:11], s6 offen sc1
    v_mfma_f32_16x16x32_bf16 v[26:29], a[36:39], v[146:149], 0
    v_mfma_f32_16x16x32_bf16 v[30:33], a[36:39], v[150:153], 0
    v_mfma_f32_16x16x32_bf16 v[34:37], a[36:39], v[154:157], 0
    v_mfma_f32_16x16x32_bf16 v[38:41], a[36:39], v[158:161], 0
    s_add_u32 s6, s59, s75
    buffer_load_dwordx4 v[94:97], v6, s[8:11], s6 offen sc1
    v_mfma_f32_16x16x32_bf16 v[42:45], a[40:43], v[146:149], 0
    v_mfma_f32_16x16x32_bf16 v[46:49], a[40:43], v[150:153], 0
    v_mfma_f32_16x16x32_bf16 v[50:53], a[40:43], v[154:157], 0
    v_mfma_f32_16x16x32_bf16 v[54:57], a[40:43], v[158:161], 0
    s_add_u32 s6, s60, s75
    buffer_load_dwordx4 v[98:101], v6, s[8:11], s6 offen sc1
    v_mfma_f32_16x16x32_bf16 v[58:61], a[44:47], v[146:149], 0
    v_mfma_f32_16x16x32_bf16 v[62:65], a[44:47], v[150:153], 0
    v_mfma_f32_16x16x32_bf16 v[66:69], a[44:47], v[154:157], 0
    v_mfma_f32_16x16x32_bf16 v[70:73], a[44:47], v[158:161], 0
    s_add_u32 s6, s61, s75
    buffer_load_dwordx4 v[102:105], v6, s[8:11], s6 offen sc1
    v_mfma_f32_16x16x32_bf16 v[74:77], a[48:51], v[146:149], 0
    v_mfma_f32_16x16x32_bf16 v[78:81], a[48:51], v[150:153], 0
    v_mfma_f32_16x16x32_bf16 v[82:85], a[48:51], v[154:157], 0
    v_mfma_f32_16x16x32_bf16 v[86:89], a[48:51], v[158:161], 0
    s_add_u32 s6, s57, s76
    buffer_load_dwordx4 v[106:109], v6, s[8:11], s6 offen sc1
    s_add_u32 s5, s44, s68
    buffer_load_dwordx4 v[146:149], v6, s[8:11], s5 offen sc1
    s_add_u32 s5, s45, s68
    buffer_load_dwordx4 v[150:153], v6, s[8:11], s5 offen sc1
    s_add_u32 s5, s46, s68
    buffer_load_dwordx4 v[154:157], v6, s[8:11], s5 offen sc1
    s_add_u32 s5, s47, s68
    buffer_load_dwordx4 v[158:161], v6, s[8:11], s5 offen sc1
    s_waitcnt vmcnt(17)
    v_mfma_f32_16x16x32_bf16 v[10:13], a[52:55], v[162:165], v[10:13]
    v_mfma_f32_16x16x32_bf16 v[14:17], a[52:55], v[166:169], v[14:17]
    v_mfma_f32_16x16x32_bf16 v[18:21], a[52:55], v[170:173], v[18:21]
    v_mfma_f32_16x16x32_bf16 v[22:25], a[52:55], v[174:177], v[22:25]
    s_add_u32 s6, s58, s76
    buffer_load_dwordx4 v[110:113], v6, s[8:11], s6 offen sc1
    v_mfma_f32_16x16x32_bf16 v[26:29], a[56:59], v[162:165], v[26:29]
    v_mfma_f32_16x16x32_bf16 v[30:33], a[56:59], v[166:169], v[30:33]
    v_mfma_f32_16x16x32_bf16 v[34:37], a[56:59], v[170:173], v[34:37]
    v_mfma_f32_16x16x32_bf16 v[38:41], a[56:59], v[174:177], v[38:41]
    s_add_u32 s6, s59, s76
    buffer_load_dwordx4 v[114:117], v6, s[8:11], s6 offen sc1
    v_mfma_f32_16x16x32_bf16 v[42:45], a[60:63], v[162:165], v[42:45]
    v_mfma_f32_16x16x32_bf16 v[46:49], a[60:63], v[166:169], v[46:49]
    v_mfma_f32_16x16x32_bf16 v[50:53], a[60:63], v[170:173], v[50:53]
    v_mfma_f32_16x16x32_bf16 v[54:57], a[60:63], v[174:177], v[54:57]
    s_add_u32 s6, s60, s76
    buffer_load_dwordx4 v[118:121], v6, s[8:11], s6 offen sc1
    v_mfma_f32_16x16x32_bf16 v[58:61], a[64:67], v[162:165], v[58:61]
    v_mfma_f32_16x16x32_bf16 v[62:65], a[64:67], v[166:169], v[62:65]
    v_mfma_f32_16x16x32_bf16 v[66:69], a[64:67], v[170:173], v[66:69]
    v_mfma_f32_16x16x32_bf16 v[70:73], a[64:67], v[174:177], v[70:73]
    s_add_u32 s6, s61, s76
    buffer_load_dwordx4 v[122:125], v6, s[8:11], s6 offen sc1
    v_mfma_f32_16x16x32_bf16 v[74:77], a[68:71], v[162:165], v[74:77]
    v_mfma_f32_16x16x32_bf16 v[78:81], a[68:71], v[166:169], v[78:81]
    v_mfma_f32_16x16x32_bf16 v[82:85], a[68:71], v[170:173], v[82:85]
    v_mfma_f32_16x16x32_bf16 v[86:89], a[68:71], v[174:177], v[86:89]
    s_add_u32 s6, s57, s77
    buffer_load_dwordx4 v[126:129], v6, s[8:11], s6 offen sc1
    s_lshl_b32 s96, s56, 7
    s_add_u32 s96, s96, 5373952
    v_mov_b32 v244, s96
    buffer_load_dword v245, v244, s[8:11], 0 offen sc1
    s_add_u32 s5, s44, s69
    buffer_load_dwordx4 v[162:165], v6, s[8:11], s5 offen sc1
    s_add_u32 s5, s45, s69
    buffer_load_dwordx4 v[166:169], v6, s[8:11], s5 offen sc1
    s_add_u32 s5, s46, s69
    buffer_load_dwordx4 v[170:173], v6, s[8:11], s5 offen sc1
    s_add_u32 s5, s47, s69
    buffer_load_dwordx4 v[174:177], v6, s[8:11], s5 offen sc1
    s_waitcnt vmcnt(23)
    v_mfma_f32_16x16x32_bf16 v[10:13], a[72:75], v[178:181], v[10:13]
    v_mfma_f32_16x16x32_bf16 v[14:17], a[72:75], v[182:185], v[14:17]
    v_mfma_f32_16x16x32_bf16 v[18:21], a[72:75], v[186:189], v[18:21]
    v_mfma_f32_16x16x32_bf16 v[22:25], a[72:75], v[190:193], v[22:25]
    s_add_u32 s6, s58, s77
    buffer_load_dwordx4 v[130:133], v6, s[8:11], s6 offen sc1
    v_mfma_f32_16x16x32_bf16 v[26:29], a[76:79], v[178:181], v[26:29]
    v_mfma_f32_16x16x32_bf16 v[30:33], a[76:79], v[182:185], v[30:33]
    v_mfma_f32_16x16x32_bf16 v[34:37], a[76:79], v[186:189], v[34:37]
    v_mfma_f32_16x16x32_bf16 v[38:41], a[76:79], v[190:193], v[38:41]
    s_add_u32 s6, s59, s77
    buffer_load_dwordx4 v[134:137], v6, s[8:11], s6 offen sc1
    v_mfma_f32_16x16x32_bf16 v[42:45], a[80:83], v[178:181], v[42:45]
    v_mfma_f32_16x16x32_bf16 v[46:49], a[80:83], v[182:185], v[46:49]
    v_mfma_f32_16x16x32_bf16 v[50:53], a[80:83], v[186:189], v[50:53]
    v_mfma_f32_16x16x32_bf16 v[54:57], a[80:83], v[190:193], v[54:57]
    s_add_u32 s6, s60, s77
    buffer_load_dwordx4 v[138:141], v6, s[8:11], s6 offen sc1
    v_mfma_f32_16x16x32_bf16 v[58:61], a[84:87], v[178:181], v[58:61]
    v_mfma_f32_16x16x32_bf16 v[62:65], a[84:87], v[182:185], v[62:65]
    v_mfma_f32_16x16x32_bf16 v[66:69], a[84:87], v[186:189], v[66:69]
    v_mfma_f32_16x16x32_bf16 v[70:73], a[84:87], v[190:193], v[70:73]
    s_add_u32 s6, s61, s77
    buffer_load_dwordx4 v[142:145], v6, s[8:11], s6 offen sc1
    v_mfma_f32_16x16x32_bf16 v[74:77], a[88:91], v[178:181], v[74:77]
    v_mfma_f32_16x16x32_bf16 v[78:81], a[88:91], v[182:185], v[78:81]
    v_mfma_f32_16x16x32_bf16 v[82:85], a[88:91], v[186:189], v[82:85]
    v_mfma_f32_16x16x32_bf16 v[86:89], a[88:91], v[190:193], v[86:89]
    s_waitcnt vmcnt(8)
    v_cmp_gt_u32 vcc, 16, v245
    s_nop 0
    s_cbranch_vccz L_lpok_75
    s_mov_b64 s[36:37], exec
    s_mov_b64 exec, 0x1
    s_mov_b32 s97, 0
L_poll_76:
    buffer_load_dword v245, v244, s[8:11], 0 offen sc1
    s_waitcnt vmcnt(0)
    v_cmp_gt_u32_e64 vcc, 16, v245
    s_nop 0
    s_cbranch_vccz L_polld_77
    s_add_u32 s97, s97, 1
    s_cmp_lt_u32 s97, 262144
    s_cbranch_scc1 L_poll_76
L_polld_77:
    s_mov_b64 exec, s[36:37]
L_lpok_75:
    s_add_u32 s5, s44, s70
    buffer_load_dwordx4 v[178:181], v6, s[8:11], s5 offen sc1
    s_add_u32 s5, s45, s70
    buffer_load_dwordx4 v[182:185], v6, s[8:11], s5 offen sc1
    s_add_u32 s5, s46, s70
    buffer_load_dwordx4 v[186:189], v6, s[8:11], s5 offen sc1
    s_add_u32 s5, s47, s70
    buffer_load_dwordx4 v[190:193], v6, s[8:11], s5 offen sc1
    s_waitcnt vmcnt(27)
    v_mfma_f32_16x16x32_bf16 v[10:13], a[92:95], v[194:197], v[10:13]
    v_mfma_f32_16x16x32_bf16 v[14:17], a[92:95], v[198:201], v[14:17]
    v_mfma_f32_16x16x32_bf16 v[18:21], a[92:95], v[202:205], v[18:21]
    v_mfma_f32_16x16x32_bf16 v[22:25], a[92:95], v[206:209], v[22:25]
    v_mfma_f32_16x16x32_bf16 v[26:29], a[96:99], v[194:197], v[26:29]
    v_mfma_f32_16x16x32_bf16 v[30:33], a[96:99], v[198:201], v[30:33]
    v_mfma_f32_16x16x32_bf16 v[34:37], a[96:99], v[202:205], v[34:37]
    v_mfma_f32_16x16x32_bf16 v[38:41], a[96:99], v[206:209], v[38:41]
    v_mfma_f32_16x16x32_bf16 v[42:45], a[100:103], v[194:197], v[42:45]
    v_mfma_f32_16x16x32_bf16 v[46:49], a[100:103], v[198:201], v[46:49]
    v_mfma_f32_16x16x32_bf16 v[50:53], a[100:103], v[202:205], v[50:53]
    v_mfma_f32_16x16x32_bf16 v[54:57], a[100:103], v[206:209], v[54:57]
    v_mfma_f32_16x16x32_bf16 v[58:61], a[104:107], v[194:197], v[58:61]
    v_mfma_f32_16x16x32_bf16 v[62:65], a[104:107], v[198:201], v[62:65]
    v_mfma_f32_16x16x32_bf16 v[66:69], a[104:107], v[202:205], v[66:69]
    v_mfma_f32_16x16x32_bf16 v[70:73], a[104:107], v[206:209], v[70:73]
    v_mfma_f32_16x16x32_bf16 v[74:77], a[108:111], v[194:197], v[74:77]
    v_mfma_f32_16x16x32_bf16 v[78:81], a[108:111], v[198:201], v[78:81]
    v_mfma_f32_16x16x32_bf16 v[82:85], a[108:111], v[202:205], v[82:85]
    v_mfma_f32_16x16x32_bf16 v[86:89], a[108:111], v[206:209], v[86:89]
    s_add_u32 s5, s44, s71
    s_nop 0
    buffer_load_dwordx4 v[194:197], v6, s[8:11], s5 offen sc1
    s_add_u32 s5, s45, s71
    buffer_load_dwordx4 v[198:201], v6, s[8:11], s5 offen sc1
    s_add_u32 s5, s46, s71
    buffer_load_dwordx4 v[202:205], v6, s[8:11], s5 offen sc1
    s_add_u32 s5, s47, s71
    buffer_load_dwordx4 v[206:209], v6, s[8:11], s5 offen sc1
    s_waitcnt vmcnt(22)
    v_mfma_f32_16x16x32_bf16 v[10:13], a[112:115], v[146:149], v[10:13]
    v_mfma_f32_16x16x32_bf16 v[14:17], a[112:115], v[150:153], v[14:17]
    v_mfma_f32_16x16x32_bf16 v[18:21], a[112:115], v[154:157], v[18:21]
    v_mfma_f32_16x16x32_bf16 v[22:25], a[112:115], v[158:161], v[22:25]
    v_mfma_f32_16x16x32_bf16 v[26:29], a[116:119], v[146:149], v[26:29]
    v_mfma_f32_16x16x32_bf16 v[30:33], a[116:119], v[150:153], v[30:33]
    v_mfma_f32_16x16x32_bf16 v[34:37], a[116:119], v[154:157], v[34:37]
    v_mfma_f32_16x16x32_bf16 v[38:41], a[116:119], v[158:161], v[38:41]
    v_mfma_f32_16x16x32_bf16 v[42:45], a[120:123], v[146:149], v[42:45]
    v_mfma_f32_16x16x32_bf16 v[46:49], a[120:123], v[150:153], v[46:49]
    v_mfma_f32_16x16x32_bf16 v[50:53], a[120:123], v[154:157], v[50:53]
    v_mfma_f32_16x16x32_bf16 v[54:57], a[120:123], v[158:161], v[54:57]
    v_mfma_f32_16x16x32_bf16 v[58:61], a[124:127], v[146:149], v[58:61]
    v_mfma_f32_16x16x32_bf16 v[62:65], a[124:127], v[150:153], v[62:65]
    v_mfma_f32_16x16x32_bf16 v[66:69], a[124:127], v[154:157], v[66:69]
    v_mfma_f32_16x16x32_bf16 v[70:73], a[124:127], v[158:161], v[70:73]
    v_mfma_f32_16x16x32_bf16 v[74:77], a[128:131], v[146:149], v[74:77]
    v_mfma_f32_16x16x32_bf16 v[78:81], a[128:131], v[150:153], v[78:81]
    v_mfma_f32_16x16x32_bf16 v[82:85], a[128:131], v[154:157], v[82:85]
    v_mfma_f32_16x16x32_bf16 v[86:89], a[128:131], v[158:161], v[86:89]
    s_add_u32 s5, s44, s72
    s_nop 0
    buffer_load_dwordx4 v[146:149], v6, s[8:11], s5 offen sc1
    s_add_u32 s5, s45, s72
    buffer_load_dwordx4 v[150:153], v6, s[8:11], s5 offen sc1
    s_add_u32 s5, s46, s72
    buffer_load_dwordx4 v[154:157], v6, s[8:11], s5 offen sc1
    s_add_u32 s5, s47, s72
    buffer_load_dwordx4 v[158:161], v6, s[8:11], s5 offen sc1
    s_waitcnt vmcnt(16)
    v_mfma_f32_16x16x32_bf16 v[10:13], a[132:135], v[162:165], v[10:13]
    v_mfma_f32_16x16x32_bf16 v[14:17], a[132:135], v[166:169], v[14:17]
    v_mfma_f32_16x16x32_bf16 v[18:21], a[132:135], v[170:173], v[18:21]
    v_mfma_f32_16x16x32_bf16 v[22:25], a[132:135], v[174:177], v[22:25]
    v_mfma_f32_16x16x32_bf16 v[26:29], a[136:139], v[162:165], v[26:29]
    v_mfma_f32_16x16x32_bf16 v[30:33], a[136:139], v[166:169], v[30:33]
    v_mfma_f32_16x16x32_bf16 v[34:37], a[136:139], v[170:173], v[34:37]
    v_mfma_f32_16x16x32_bf16 v[38:41], a[136:139], v[174:177], v[38:41]
    v_mfma_f32_16x16x32_bf16 v[42:45], a[140:143], v[162:165], v[42:45]
    v_mfma_f32_16x16x32_bf16 v[46:49], a[140:143], v[166:169], v[46:49]
    v_mfma_f32_16x16x32_bf16 v[50:53], a[140:143], v[170:173], v[50:53]
    v_mfma_f32_16x16x32_bf16 v[54:57], a[140:143], v[174:177], v[54:57]
    v_mfma_f32_16x16x32_bf16 v[58:61], a[144:147], v[162:165], v[58:61]
    v_mfma_f32_16x16x32_bf16 v[62:65], a[144:147], v[166:169], v[62:65]
    v_mfma_f32_16x16x32_bf16 v[66:69], a[144:147], v[170:173], v[66:69]
    v_mfma_f32_16x16x32_bf16 v[70:73], a[144:147], v[174:177], v[70:73]
    v_mfma_f32_16x16x32_bf16 v[74:77], a[148:151], v[162:165], v[74:77]
    v_mfma_f32_16x16x32_bf16 v[78:81], a[148:151], v[166:169], v[78:81]
    v_mfma_f32_16x16x32_bf16 v[82:85], a[148:151], v[170:173], v[82:85]
    v_mfma_f32_16x16x32_bf16 v[86:89], a[148:151], v[174:177], v[86:89]
    s_add_u32 s5, s44, s73
    s_nop 0
    buffer_load_dwordx4 v[162:165], v6, s[8:11], s5 offen sc1
    s_add_u32 s5, s45, s73
    buffer_load_dwordx4 v[166:169], v6, s[8:11], s5 offen sc1
    s_add_u32 s5, s46, s73
    buffer_load_dwordx4 v[170:173], v6, s[8:11], s5 offen sc1
    s_add_u32 s5, s47, s73
    buffer_load_dwordx4 v[174:177], v6, s[8:11], s5 offen sc1
    s_waitcnt vmcnt(12)
    v_mfma_f32_16x16x32_bf16 v[10:13], a[152:155], v[178:181], v[10:13]
    v_mfma_f32_16x16x32_bf16 v[14:17], a[152:155], v[182:185], v[14:17]
    v_mfma_f32_16x16x32_bf16 v[18:21], a[152:155], v[186:189], v[18:21]
    v_mfma_f32_16x16x32_bf16 v[22:25], a[152:155], v[190:193], v[22:25]
    v_mfma_f32_16x16x32_bf16 v[26:29], a[156:159], v[178:181], v[26:29]
    v_mfma_f32_16x16x32_bf16 v[30:33], a[156:159], v[182:185], v[30:33]
    v_mfma_f32_16x16x32_bf16 v[34:37], a[156:159], v[186:189], v[34:37]
    v_mfma_f32_16x16x32_bf16 v[38:41], a[156:159], v[190:193], v[38:41]
    v_mfma_f32_16x16x32_bf16 v[42:45], a[160:163], v[178:181], v[42:45]
    v_mfma_f32_16x16x32_bf16 v[46:49], a[160:163], v[182:185], v[46:49]
    v_mfma_f32_16x16x32_bf16 v[50:53], a[160:163], v[186:189], v[50:53]
    v_mfma_f32_16x16x32_bf16 v[54:57], a[160:163], v[190:193], v[54:57]
    v_mfma_f32_16x16x32_bf16 v[58:61], a[164:167], v[178:181], v[58:61]
    v_mfma_f32_16x16x32_bf16 v[62:65], a[164:167], v[182:185], v[62:65]
    v_mfma_f32_16x16x32_bf16 v[66:69], a[164:167], v[186:189], v[66:69]
    v_mfma_f32_16x16x32_bf16 v[70:73], a[164:167], v[190:193], v[70:73]
    v_mfma_f32_16x16x32_bf16 v[74:77], a[168:171], v[178:181], v[74:77]
    v_mfma_f32_16x16x32_bf16 v[78:81], a[168:171], v[182:185], v[78:81]
    v_mfma_f32_16x16x32_bf16 v[82:85], a[168:171], v[186:189], v[82:85]
    v_mfma_f32_16x16x32_bf16 v[86:89], a[168:171], v[190:193], v[86:89]
    s_add_u32 s5, s44, s74
    s_nop 0
    buffer_load_dwordx4 v[178:181], v6, s[8:11], s5 offen sc1
    s_add_u32 s5, s45, s74
    buffer_load_dwordx4 v[182:185], v6, s[8:11], s5 offen sc1
    s_add_u32 s5, s46, s74
    buffer_load_dwordx4 v[186:189], v6, s[8:11], s5 offen sc1
    s_add_u32 s5, s47, s74
    buffer_load_dwordx4 v[190:193], v6, s[8:11], s5 offen sc1
    s_waitcnt vmcnt(12)
    v_mfma_f32_16x16x32_bf16 v[10:13], a[172:175], v[194:197], v[10:13]
    v_mfma_f32_16x16x32_bf16 v[14:17], a[172:175], v[198:201], v[14:17]
    v_mfma_f32_16x16x32_bf16 v[18:21], a[172:175], v[202:205], v[18:21]
    v_mfma_f32_16x16x32_bf16 v[22:25], a[172:175], v[206:209], v[22:25]
    v_mfma_f32_16x16x32_bf16 v[26:29], a[176:179], v[194:197], v[26:29]
    v_mfma_f32_16x16x32_bf16 v[30:33], a[176:179], v[198:201], v[30:33]
    v_mfma_f32_16x16x32_bf16 v[34:37], a[176:179], v[202:205], v[34:37]
    v_mfma_f32_16x16x32_bf16 v[38:41], a[176:179], v[206:209], v[38:41]
    v_mfma_f32_16x16x32_bf16 v[42:45], a[180:183], v[194:197], v[42:45]
    v_mfma_f32_16x16x32_bf16 v[46:49], a[180:183], v[198:201], v[46:49]
    v_mfma_f32_16x16x32_bf16 v[50:53], a[180:183], v[202:205], v[50:53]
    v_mfma_f32_16x16x32_bf16 v[54:57], a[180:183], v[206:209], v[54:57]
    v_mfma_f32_16x16x32_bf16 v[58:61], a[184:187], v[194:197], v[58:61]
    v_mfma_f32_16x16x32_bf16 v[62:65], a[184:187], v[198:201], v[62:65]
    v_mfma_f32_16x16x32_bf16 v[66:69], a[184:187], v[202:205], v[66:69]
    v_mfma_f32_16x16x32_bf16 v[70:73], a[184:187], v[206:209], v[70:73]
    v_mfma_f32_16x16x32_bf16 v[74:77], a[188:191], v[194:197], v[74:77]
    v_mfma_f32_16x16x32_bf16 v[78:81], a[188:191], v[198:201], v[78:81]
    v_mfma_f32_16x16x32_bf16 v[82:85], a[188:191], v[202:205], v[82:85]
    v_mfma_f32_16x16x32_bf16 v[86:89], a[188:191], v[206:209], v[86:89]
    s_add_u32 s5, s44, s75
    s_nop 0
    buffer_load_dwordx4 v[194:197], v6, s[8:11], s5 offen sc1
    s_add_u32 s5, s45, s75
    buffer_load_dwordx4 v[198:201], v6, s[8:11], s5 offen sc1
    s_add_u32 s5, s46, s75
    buffer_load_dwordx4 v[202:205], v6, s[8:11], s5 offen sc1
    s_add_u32 s5, s47, s75
    buffer_load_dwordx4 v[206:209], v6, s[8:11], s5 offen sc1
    s_waitcnt vmcnt(12)
    v_mfma_f32_16x16x32_bf16 v[10:13], a[192:195], v[146:149], v[10:13]
    v_mfma_f32_16x16x32_bf16 v[14:17], a[192:195], v[150:153], v[14:17]
    v_mfma_f32_16x16x32_bf16 v[18:21], a[192:195], v[154:157], v[18:21]
    v_mfma_f32_16x16x32_bf16 v[22:25], a[192:195], v[158:161], v[22:25]
    v_mfma_f32_16x16x32_bf16 v[26:29], a[196:199], v[146:149], v[26:29]
    v_mfma_f32_16x16x32_bf16 v[30:33], a[196:199], v[150:153], v[30:33]
    v_mfma_f32_16x16x32_bf16 v[34:37], a[196:199], v[154:157], v[34:37]
    v_mfma_f32_16x16x32_bf16 v[38:41], a[196:199], v[158:161], v[38:41]
    v_mfma_f32_16x16x32_bf16 v[42:45], a[200:203], v[146:149], v[42:45]
    v_mfma_f32_16x16x32_bf16 v[46:49], a[200:203], v[150:153], v[46:49]
    v_mfma_f32_16x16x32_bf16 v[50:53], a[200:203], v[154:157], v[50:53]
    v_mfma_f32_16x16x32_bf16 v[54:57], a[200:203], v[158:161], v[54:57]
    v_mfma_f32_16x16x32_bf16 v[58:61], a[204:207], v[146:149], v[58:61]
    v_mfma_f32_16x16x32_bf16 v[62:65], a[204:207], v[150:153], v[62:65]
    v_mfma_f32_16x16x32_bf16 v[66:69], a[204:207], v[154:157], v[66:69]
    v_mfma_f32_16x16x32_bf16 v[70:73], a[204:207], v[158:161], v[70:73]
    v_mfma_f32_16x16x32_bf16 v[74:77], a[208:211], v[146:149], v[74:77]
    v_mfma_f32_16x16x32_bf16 v[78:81], a[208:211], v[150:153], v[78:81]
    v_mfma_f32_16x16x32_bf16 v[82:85], a[208:211], v[154:157], v[82:85]
    v_mfma_f32_16x16x32_bf16 v[86:89], a[208:211], v[158:161], v[86:89]
    s_add_u32 s5, s44, s76
    s_nop 0
    buffer_load_dwordx4 v[146:149], v6, s[8:11], s5 offen sc1
    s_add_u32 s5, s45, s76
    buffer_load_dwordx4 v[150:153], v6, s[8:11], s5 offen sc1
    s_add_u32 s5, s46, s76
    buffer_load_dwordx4 v[154:157], v6, s[8:11], s5 offen sc1
    s_add_u32 s5, s47, s76
    buffer_load_dwordx4 v[158:161], v6, s[8:11], s5 offen sc1
    s_waitcnt vmcnt(12)
    v_mfma_f32_16x16x32_bf16 v[10:13], a[212:215], v[162:165], v[10:13]
    v_mfma_f32_16x16x32_bf16 v[14:17], a[212:215], v[166:169], v[14:17]
    v_mfma_f32_16x16x32_bf16 v[18:21], a[212:215], v[170:173], v[18:21]
    v_mfma_f32_16x16x32_bf16 v[22:25], a[212:215], v[174:177], v[22:25]
    v_mfma_f32_16x16x32_bf16 v[26:29], a[216:219], v[162:165], v[26:29]
    v_mfma_f32_16x16x32_bf16 v[30:33], a[216:219], v[166:169], v[30:33]
    v_mfma_f32_16x16x32_bf16 v[34:37], a[216:219], v[170:173], v[34:37]
    v_mfma_f32_16x16x32_bf16 v[38:41], a[216:219], v[174:177], v[38:41]
    v_mfma_f32_16x16x32_bf16 v[42:45], a[220:223], v[162:165], v[42:45]
    v_mfma_f32_16x16x32_bf16 v[46:49], a[220:223], v[166:169], v[46:49]
    v_mfma_f32_16x16x32_bf16 v[50:53], a[220:223], v[170:173], v[50:53]
    v_mfma_f32_16x16x32_bf16 v[54:57], a[220:223], v[174:177], v[54:57]
    v_mfma_f32_16x16x32_bf16 v[58:61], a[224:227], v[162:165], v[58:61]
    v_mfma_f32_16x16x32_bf16 v[62:65], a[224:227], v[166:169], v[62:65]
    v_mfma_f32_16x16x32_bf16 v[66:69], a[224:227], v[170:173], v[66:69]
    v_mfma_f32_16x16x32_bf16 v[70:73], a[224:227], v[174:177], v[70:73]
    v_mfma_f32_16x16x32_bf16 v[74:77], a[228:231], v[162:165], v[74:77]
    v_mfma_f32_16x16x32_bf16 v[78:81], a[228:231], v[166:169], v[78:81]
    v_mfma_f32_16x16x32_bf16 v[82:85], a[228:231], v[170:173], v[82:85]
    v_mfma_f32_16x16x32_bf16 v[86:89], a[228:231], v[174:177], v[86:89]
    s_add_u32 s5, s44, s77
    s_nop 0
    buffer_load_dwordx4 v[162:165], v6, s[8:11], s5 offen sc1
    s_add_u32 s5, s45, s77
    buffer_load_dwordx4 v[166:169], v6, s[8:11], s5 offen sc1
    s_add_u32 s5, s46, s77
    buffer_load_dwordx4 v[170:173], v6, s[8:11], s5 offen sc1
    s_add_u32 s5, s47, s77
    buffer_load_dwordx4 v[174:177], v6, s[8:11], s5 offen sc1
    s_waitcnt vmcnt(12)
    v_mfma_f32_16x16x32_bf16 v[10:13], a[232:235], v[178:181], v[10:13]
    v_mfma_f32_16x16x32_bf16 v[14:17], a[232:235], v[182:185], v[14:17]
    v_mfma_f32_16x16x32_bf16 v[18:21], a[232:235], v[186:189], v[18:21]
    v_mfma_f32_16x16x32_bf16 v[22:25], a[232:235], v[190:193], v[22:25]
    v_mfma_f32_16x16x32_bf16 v[26:29], a[236:239], v[178:181], v[26:29]
    v_mfma_f32_16x16x32_bf16 v[30:33], a[236:239], v[182:185], v[30:33]
    v_mfma_f32_16x16x32_bf16 v[34:37], a[236:239], v[186:189], v[34:37]
    v_mfma_f32_16x16x32_bf16 v[38:41], a[236:239], v[190:193], v[38:41]
    v_mfma_f32_16x16x32_bf16 v[42:45], a[240:243], v[178:181], v[42:45]
    v_mfma_f32_16x16x32_bf16 v[46:49], a[240:243], v[182:185], v[46:49]
    v_mfma_f32_16x16x32_bf16 v[50:53], a[240:243], v[186:189], v[50:53]
    v_mfma_f32_16x16x32_bf16 v[54:57], a[240:243], v[190:193], v[54:57]
    v_mfma_f32_16x16x32_bf16 v[58:61], a[244:247], v[178:181], v[58:61]
    v_mfma_f32_16x16x32_bf16 v[62:65], a[244:247], v[182:185], v[62:65]
    v_mfma_f32_16x16x32_bf16 v[66:69], a[244:247], v[186:189], v[66:69]
    v_mfma_f32_16x16x32_bf16 v[70:73], a[244:247], v[190:193], v[70:73]
    v_mfma_f32_16x16x32_bf16 v[74:77], a[248:251], v[178:181], v[74:77]
    v_mfma_f32_16x16x32_bf16 v[78:81], a[248:251], v[182:185], v[78:81]
    v_mfma_f32_16x16x32_bf16 v[82:85], a[248:251], v[186:189], v[82:85]
    v_mfma_f32_16x16x32_bf16 v[86:89], a[248:251], v[190:193], v[86:89]
    s_waitcnt vmcnt(8)
    s_nop 0
    v_mfma_f32_16x16x32_bf16 v[10:13], a[252:255], v[194:197], v[10:13]
    v_mfma_f32_16x16x32_bf16 v[14:17], a[252:255], v[198:201], v[14:17]
    v_mfma_f32_16x16x32_bf16 v[18:21], a[252:255], v[202:205], v[18:21]
    v_mfma_f32_16x16x32_bf16 v[22:25], a[252:255], v[206:209], v[22:25]
    v_mfma_f32_16x16x32_bf16 v[26:29], v[90:93], v[194:197], v[26:29]
    v_mfma_f32_16x16x32_bf16 v[30:33], v[90:93], v[198:201], v[30:33]
    v_mfma_f32_16x16x32_bf16 v[34:37], v[90:93], v[202:205], v[34:37]
    v_mfma_f32_16x16x32_bf16 v[38:41], v[90:93], v[206:209], v[38:41]
    v_mfma_f32_16x16x32_bf16 v[42:45], v[94:97], v[194:197], v[42:45]
    v_mfma_f32_16x16x32_bf16 v[46:49], v[94:97], v[198:201], v[46:49]
    v_mfma_f32_16x16x32_bf16 v[50:53], v[94:97], v[202:205], v[50:53]
    v_mfma_f32_16x16x32_bf16 v[54:57], v[94:97], v[206:209], v[54:57]
    v_mfma_f32_16x16x32_bf16 v[58:61], v[98:101], v[194:197], v[58:61]
    v_mfma_f32_16x16x32_bf16 v[62:65], v[98:101], v[198:201], v[62:65]
    v_mfma_f32_16x16x32_bf16 v[66:69], v[98:101], v[202:205], v[66:69]
    v_mfma_f32_16x16x32_bf16 v[70:73], v[98:101], v[206:209], v[70:73]
    v_mfma_f32_16x16x32_bf16 v[74:77], v[102:105], v[194:197], v[74:77]
    v_mfma_f32_16x16x32_bf16 v[78:81], v[102:105], v[198:201], v[78:81]
    v_mfma_f32_16x16x32_bf16 v[82:85], v[102:105], v[202:205], v[82:85]
    v_mfma_f32_16x16x32_bf16 v[86:89], v[102:105], v[206:209], v[86:89]
    s_waitcnt vmcnt(4)
    s_nop 0
    v_mfma_f32_16x16x32_bf16 v[10:13], v[106:109], v[146:149], v[10:13]
    v_mfma_f32_16x16x32_bf16 v[14:17], v[106:109], v[150:153], v[14:17]
    v_mfma_f32_16x16x32_bf16 v[18:21], v[106:109], v[154:157], v[18:21]
    v_mfma_f32_16x16x32_bf16 v[22:25], v[106:109], v[158:161], v[22:25]
    v_mfma_f32_16x16x32_bf16 v[26:29], v[110:113], v[146:149], v[26:29]
    v_mfma_f32_16x16x32_bf16 v[30:33], v[110:113], v[150:153], v[30:33]
    v_mfma_f32_16x16x32_bf16 v[34:37], v[110:113], v[154:157], v[34:37]
    v_mfma_f32_16x16x32_bf16 v[38:41], v[110:113], v[158:161], v[38:41]
    v_mfma_f32_16x16x32_bf16 v[42:45], v[114:117], v[146:149], v[42:45]
    v_mfma_f32_16x16x32_bf16 v[46:49], v[114:117], v[150:153], v[46:49]
    v_mfma_f32_16x16x32_bf16 v[50:53], v[114:117], v[154:157], v[50:53]
    v_mfma_f32_16x16x32_bf16 v[54:57], v[114:117], v[158:161], v[54:57]
    v_mfma_f32_16x16x32_bf16 v[58:61], v[118:121], v[146:149], v[58:61]
    v_mfma_f32_16x16x32_bf16 v[62:65], v[118:121], v[150:153], v[62:65]
    v_mfma_f32_16x16x32_bf16 v[66:69], v[118:121], v[154:157], v[66:69]
    v_mfma_f32_16x16x32_bf16 v[70:73], v[118:121], v[158:161], v[70:73]
    v_mfma_f32_16x16x32_bf16 v[74:77], v[122:125], v[146:149], v[74:77]
    v_mfma_f32_16x16x32_bf16 v[78:81], v[122:125], v[150:153], v[78:81]
    v_mfma_f32_16x16x32_bf16 v[82:85], v[122:125], v[154:157], v[82:85]
    v_mfma_f32_16x16x32_bf16 v[86:89], v[122:125], v[158:161], v[86:89]
    s_cmp_ge_u32 s4, 2
    s_nop 0
    s_cbranch_scc1 L_g2skip_74
    s_waitcnt vmcnt(0)
    v_mfma_f32_16x16x32_bf16 v[10:13], v[126:129], v[162:165], v[10:13]
    v_mfma_f32_16x16x32_bf16 v[14:17], v[126:129], v[166:169], v[14:17]
    v_mfma_f32_16x16x32_bf16 v[18:21], v[126:129], v[170:173], v[18:21]
    v_mfma_f32_16x16x32_bf16 v[22:25], v[126:129], v[174:177], v[22:25]
    v_mfma_f32_16x16x32_bf16 v[26:29], v[130:133], v[162:165], v[26:29]
    v_mfma_f32_16x16x32_bf16 v[30:33], v[130:133], v[166:169], v[30:33]
    v_mfma_f32_16x16x32_bf16 v[34:37], v[130:133], v[170:173], v[34:37]
    v_mfma_f32_16x16x32_bf16 v[38:41], v[130:133], v[174:177], v[38:41]
    v_mfma_f32_16x16x32_bf16 v[42:45], v[134:137], v[162:165], v[42:45]
    v_mfma_f32_16x16x32_bf16 v[46:49], v[134:137], v[166:169], v[46:49]
    v_mfma_f32_16x16x32_bf16 v[50:53], v[134:137], v[170:173], v[50:53]
    v_mfma_f32_16x16x32_bf16 v[54:57], v[134:137], v[174:177], v[54:57]
    v_mfma_f32_16x16x32_bf16 v[58:61], v[138:141], v[162:165], v[58:61]
    v_mfma_f32_16x16x32_bf16 v[62:65], v[138:141], v[166:169], v[62:65]
    v_mfma_f32_16x16x32_bf16 v[66:69], v[138:141], v[170:173], v[66:69]
    v_mfma_f32_16x16x32_bf16 v[70:73], v[138:141], v[174:177], v[70:73]
    v_mfma_f32_16x16x32_bf16 v[74:77], v[142:145], v[162:165], v[74:77]
    v_mfma_f32_16x16x32_bf16 v[78:81], v[142:145], v[166:169], v[78:81]
    v_mfma_f32_16x16x32_bf16 v[82:85], v[142:145], v[170:173], v[82:85]
    v_mfma_f32_16x16x32_bf16 v[86:89], v[142:145], v[174:177], v[86:89]
L_g2skip_74:
    v_lshrrev_b32 v7, 4, v1
    v_lshlrev_b32 v2, 4, v7
    s_mul_i32 s5, s55, 320
    s_add_u32 s5, s5, 5308416
    buffer_load_dwordx4 v[220:223], v2, s[8:11], s5 offen offset:0 sc1
    buffer_load_dwordx4 v[224:227], v2, s[8:11], s5 offen offset:64 sc1
    buffer_load_dwordx4 v[228:231], v2, s[8:11], s5 offen offset:128 sc1
    buffer_load_dwordx4 v[232:235], v2, s[8:11], s5 offen offset:192 sc1
    buffer_load_dwordx4 v[236:239], v2, s[8:11], s5 offen offset:256 sc1
    v_and_b32_e64 v8, 15, v1
    v_lshlrev_b32 v3, 8, v7
    v_lshl_add_u32 v3, v8, 4, v3
    s_lshl_b32 s5, s54, 1
    s_lshr_b32 s6, s4, 1
    s_add_u32 s5, s5, s6
    s_mul_i32 s5, s5, 40960
    s_mul_i32 s6, s55, 5120
    s_add_u32 s5, s5, s6
    s_and_b32 s6, s4, 1
    s_lshl_b32 s6, s6, 3
    s_add_u32 s5, s5, s6
    s_add_u32 s5, s5, 2621440
    buffer_load_dwordx2 v[210:211], v3, s[8:11], s5 offen offset:0 sc1
    buffer_load_dwordx2 v[212:213], v3, s[8:11], s5 offen offset:1024 sc1
    buffer_load_dwordx2 v[214:215], v3, s[8:11], s5 offen offset:2048 sc1
    buffer_load_dwordx2 v[216:217], v3, s[8:11], s5 offen offset:3072 sc1
    s_add_u32 s5, s5, 4096
    buffer_load_dwordx2 v[218:219], v3, s[8:11], s5 offen offset:0 sc1
    s_add_u32 s5, s4, 1
    s_and_b32 s5, s5, 3
    s_lshl_b32 s5, s5, 2
    s_add_u32 s5, s5, s4
    s_mul_i32 s5, s5, 5120
    v_add_u32_e64 v245, s5, v6
    s_add_u32 s5, s4, 2
    s_and_b32 s5, s5, 3
    s_lshl_b32 s5, s5, 2
    s_add_u32 s5, s5, s4
    s_mul_i32 s5, s5, 5120
    v_add_u32_e64 v246, s5, v6
    s_add_u32 s5, s4, 3
    s_and_b32 s5, s5, 3
    s_lshl_b32 s5, s5, 2
    s_add_u32 s5, s5, s4
    s_mul_i32 s5, s5, 5120
    v_add_u32_e64 v247, s5, v6
    ds_write_b128 v245, v[14:17] offset:0
    ds_write_b128 v245, v[30:33] offset:1024
    ds_write_b128 v245, v[46:49] offset:2048
    ds_write_b128 v245, v[62:65] offset:3072
    ds_write_b128 v245, v[78:81] offset:4096
    ds_write_b128 v246, v[18:21] offset:0
    ds_write_b128 v246, v[34:37] offset:1024
    ds_write_b128 v246, v[50:53] offset:2048
    ds_write_b128 v246, v[66:69] offset:3072
    ds_write_b128 v246, v[82:85] offset:4096
    ds_write_b128 v247, v[22:25] offset:0
    ds_write_b128 v247, v[38:41] offset:1024
    ds_write_b128 v247, v[54:57] offset:2048
    ds_write_b128 v247, v[70:73] offset:3072
    ds_write_b128 v247, v[86:89] offset:4096
    s_add_u32 s5, s4, 1
    s_and_b32 s5, s5, 3
    s_lshl_b32 s6, s4, 2
    s_add_u32 s5, s5, s6
    s_mul_i32 s5, s5, 5120
    v_add_u32_e64 v241, s5, v6
    s_add_u32 s5, s4, 2
    s_and_b32 s5, s5, 3
    s_lshl_b32 s6, s4, 2
    s_add_u32 s5, s5, s6
    s_mul_i32 s5, s5, 5120
    v_add_u32_e64 v242, s5, v6
    s_add_u32 s5, s4, 3
    s_and_b32 s5, s5, 3
    s_lshl_b32 s6, s4, 2
    s_add_u32 s5, s5, s6
    s_mul_i32 s5, s5, 5120
    v_add_u32 v243, s5, v6
    v_mul_u32_u24 v5, 1280, v8
    v_lshl_add_u32 v5, v7, 3, v5
    s_lshl_b32 s3, s54, 2
    s_add_u32 s3, s3, s4
    s_mul_i32 s3, s3, 20480
    s_mul_i32 s6, s55, 160
    s_add_u32 s3, s3, s6
    s_waitcnt lgkmcnt(0)
    s_barrier
    ds_read_b128 v[90:93], v241 offset:0
    ds_read_b128 v[94:97], v242 offset:0
    ds_read_b128 v[98:101], v243 offset:0
    ds_read_b128 v[102:105], v241 offset:1024
    ds_read_b128 v[106:109], v242 offset:1024
    ds_read_b128 v[110:113], v243 offset:1024
    ds_read_b128 v[114:117], v241 offset:2048
    ds_read_b128 v[118:121], v242 offset:2048
    ds_read_b128 v[122:125], v243 offset:2048
    ds_read_b128 v[126:129], v241 offset:3072
    ds_read_b128 v[130:133], v242 offset:3072
    ds_read_b128 v[134:137], v243 offset:3072
    ds_read_b128 v[138:141], v241 offset:4096
    ds_read_b128 v[142:145], v242 offset:4096
    ds_read_b128 v[146:149], v243 offset:4096
    s_waitcnt vmcnt(0)
    s_waitcnt lgkmcnt(12)
    v_pk_add_f32 v[90:91], v[90:91], v[94:95]
    v_pk_add_f32 v[10:11], v[10:11], v[98:99]
    v_pk_add_f32 v[92:93], v[92:93], v[96:97]
    v_pk_add_f32 v[12:13], v[12:13], v[100:101]
    v_pk_add_f32 v[10:11], v[10:11], v[90:91]
    v_pk_add_f32 v[12:13], v[12:13], v[92:93]
    v_lshlrev_b32_e64 v170, 16, v210
    v_and_b32 v171, 0xffff0000, v210
    v_lshlrev_b32_e64 v172, 16, v211
    v_and_b32 v173, 0xffff0000, v211
    v_pk_fma_f32 v[170:171], v[220:221], v[10:11], v[170:171]
    v_pk_fma_f32 v[172:173], v[222:223], v[12:13], v[172:173]
    v_cvt_pk_bf16_f32 v90, v170, v171
    v_cvt_pk_bf16_f32 v91, v172, v173
    buffer_store_dwordx2 v[90:91], v5, s[16:19], s3 offen offset:0
    s_waitcnt lgkmcnt(9)
    s_nop 0
    v_pk_add_f32 v[102:103], v[102:103], v[106:107]
    v_pk_add_f32 v[26:27], v[26:27], v[110:111]
    v_pk_add_f32 v[104:105], v[104:105], v[108:109]
    v_pk_add_f32 v[28:29], v[28:29], v[112:113]
    v_pk_add_f32 v[26:27], v[26:27], v[102:103]
    v_pk_add_f32 v[28:29], v[28:29], v[104:105]
    v_lshlrev_b32_e64 v170, 16, v212
    v_and_b32 v171, 0xffff0000, v212
    v_lshlrev_b32_e64 v172, 16, v213
    v_and_b32 v173, 0xffff0000, v213
    v_pk_fma_f32 v[170:171], v[224:225], v[26:27], v[170:171]
    v_pk_fma_f32 v[172:173], v[226:227], v[28:29], v[172:173]
    v_cvt_pk_bf16_f32 v102, v170, v171
    v_cvt_pk_bf16_f32 v103, v172, v173
    buffer_store_dwordx2 v[102:103], v5, s[16:19], s3 offen offset:32
    s_waitcnt lgkmcnt(6)
    s_nop 0
    v_pk_add_f32 v[114:115], v[114:115], v[118:119]
    v_pk_add_f32 v[42:43], v[42:43], v[122:123]
    v_pk_add_f32 v[116:117], v[116:117], v[120:121]
    v_pk_add_f32 v[44:45], v[44:45], v[124:125]
    v_pk_add_f32 v[42:43], v[42:43], v[114:115]
    v_pk_add_f32 v[44:45], v[44:45], v[116:117]
    v_lshlrev_b32_e64 v170, 16, v214
    v_and_b32 v171, 0xffff0000, v214
    v_lshlrev_b32_e64 v172, 16, v215
    v_and_b32 v173, 0xffff0000, v215
    v_pk_fma_f32 v[170:171], v[228:229], v[42:43], v[170:171]
    v_pk_fma_f32 v[172:173], v[230:231], v[44:45], v[172:173]
    v_cvt_pk_bf16_f32 v114, v170, v171
    v_cvt_pk_bf16_f32 v115, v172, v173
    buffer_store_dwordx2 v[114:115], v5, s[16:19], s3 offen offset:64
    s_waitcnt lgkmcnt(3)
    s_nop 0
    v_pk_add_f32 v[126:127], v[126:127], v[130:131]
    v_pk_add_f32 v[58:59], v[58:59], v[134:135]
    v_pk_add_f32 v[128:129], v[128:129], v[132:133]
    v_pk_add_f32 v[60:61], v[60:61], v[136:137]
    v_pk_add_f32 v[58:59], v[58:59], v[126:127]
    v_pk_add_f32 v[60:61], v[60:61], v[128:129]
    v_lshlrev_b32_e64 v170, 16, v216
    v_and_b32 v171, 0xffff0000, v216
    v_lshlrev_b32_e64 v172, 16, v217
    v_and_b32 v173, 0xffff0000, v217
    v_pk_fma_f32 v[170:171], v[232:233], v[58:59], v[170:171]
    v_pk_fma_f32 v[172:173], v[234:235], v[60:61], v[172:173]
    v_cvt_pk_bf16_f32 v126, v170, v171
    v_cvt_pk_bf16_f32 v127, v172, v173
    buffer_store_dwordx2 v[126:127], v5, s[16:19], s3 offen offset:96
    s_waitcnt lgkmcnt(0)
    s_nop 0
    v_pk_add_f32 v[138:139], v[138:139], v[142:143]
    v_pk_add_f32 v[74:75], v[74:75], v[146:147]
    v_pk_add_f32 v[140:141], v[140:141], v[144:145]
    v_pk_add_f32 v[76:77], v[76:77], v[148:149]
    v_pk_add_f32 v[74:75], v[74:75], v[138:139]
    v_pk_add_f32 v[76:77], v[76:77], v[140:141]
    v_lshlrev_b32_e64 v170, 16, v218
    v_and_b32 v171, 0xffff0000, v218
    v_lshlrev_b32_e64 v172, 16, v219
    v_and_b32 v173, 0xffff0000, v219
    v_pk_fma_f32 v[170:171], v[236:237], v[74:75], v[170:171]
    v_pk_fma_f32 v[172:173], v[238:239], v[76:77], v[172:173]
    v_cvt_pk_bf16_f32 v138, v170, v171
    v_cvt_pk_bf16_f32 v139, v172, v173
    buffer_store_dwordx2 v[138:139], v5, s[16:19], s3 offen offset:128
    s_waitcnt vmcnt(0) lgkmcnt(0)
L_exit:
    s_endpgm
L_codeend:

.section .rodata,"a"
.p2align 6
.amdhsa_kernel adaLN_cond__ssm_conv_s4d__glu_gated_geglu__prompt_kernel
  .amdhsa_next_free_vgpr 512
  .amdhsa_next_free_sgpr 102
  .amdhsa_accum_offset 256
  .amdhsa_group_segment_fixed_size 0
  .amdhsa_kernarg_size 128
  .amdhsa_user_sgpr_count 2
  .amdhsa_user_sgpr_kernarg_segment_ptr 1
  .amdhsa_system_sgpr_workgroup_id_x 1
.end_amdhsa_kernel
```
